```python
import torch

def _softmax(x, axis=-1):
    return torch.softmax(x, dim=axis)
def _gelu(x):
    return torch.nn.functional.gelu(x, approximate="tanh")
def _silu(x):
    return torch.nn.functional.silu(x)
def _sigmoid(x):
    return torch.sigmoid(x)
def _layernorm(x, axis=-1, eps=1e-5):
    m = x.mean(dim=axis, keepdim=True)
    v = x.var(dim=axis, keepdim=True, unbiased=False)
    return (x - m) / torch.sqrt(v + eps)
def _scatter_add(tgt, idx, src, axis=0):
    return tgt.clone().index_add_(axis, idx, src)
def _segment_sum(src, seg, n):
    out = torch.zeros((n,) + src.shape[1:], dtype=src.dtype)
    return out.index_add_(0, seg, src)
def _pad(x, pw):
    flat = tuple(v for pair in reversed(pw) for v in pair)
    return torch.nn.functional.pad(x, flat)

kernel_name = 'standalone__gqa_softmax__near_ridge'

def setup_inputs():

    _w = (lambda a: (lambda t: t.to(torch.bfloat16) if t.is_floating_point() else t)(torch.as_tensor(a)))
    B, Hq, Hkv, Sq, Sk, D = 8, 32, 8, 512, 512, 128
    return {
        "q": _w((lambda *s: torch.randn(*s, dtype=torch.bfloat16) * 0.8)(B, Hq, Sq, D)),
        "k": _w((lambda *s: torch.randn(*s, dtype=torch.bfloat16) * 0.8)(B, Hkv, Sk, D)),
        "v": _w((lambda *s: torch.randn(*s, dtype=torch.bfloat16) * 0.05)(B, Hkv, Sk, D)),
    }

def reference(q, k, v):
    B, Hq, Sq, D = q.shape
    Hkv = k.shape[1]
    rep = Hq // Hkv
    k = (lambda x, n, axis: torch.repeat_interleave(x, n, dim=axis))(k, rep, axis=1)
    v = (lambda x, n, axis: torch.repeat_interleave(x, n, dim=axis))(v, rep, axis=1)
    scale = D ** -0.5
    scores = torch.einsum("bhqd,bhkd->bhqk", q, k) * scale
    p = _softmax(scores, axis=-1)
    return torch.einsum("bhqk,bhkd->bhqd", p, v)
```

```asm
; @launch grid=(256,1,1) block=(256,1,1) lds=163328
.amdgcn_target "amdgcn-amd-amdhsa--gfx950"
.text
.globl standalone__gqa_softmax__near_ridge_kernel
.p2align 8
.type standalone__gqa_softmax__near_ridge_kernel,@function
standalone__gqa_softmax__near_ridge_kernel:
    s_cmp_ge_u32 s2, 256
    s_cbranch_scc1 L_end
    s_load_dwordx8 s[4:11], s[0:1], 0
    s_getpc_b64 s[14:15]
L_pc:
    s_bfe_u32 s3, s2, 0x30003
    s_mul_i32 s3, s3, 48
    v_mul_u32_u24 v30, 3, v0
    v_lshrrev_b32 v30, 4, v30
    v_add_lshl_u32 v30, v30, s3, 7
    v_min_u32 v30, L_fallback-L_pc+384, v30
    v_mov_b32 v31, s15
    v_add_co_u32 v30, vcc, s14, v30
    s_nop 1
    v_addc_co_u32 v31, vcc, 0, v31, vcc
    global_load_dword v218, v[30:31], off
    v_lshrrev_b32 v20, 6, v0
    v_and_b32 v0, 63, v0
    s_and_b32 s3, s2, 7
    v_readfirstlane_b32 s32, v20
    s_lshr_b32 s2, s2, 3
    s_lshl_b32 s3, s3, 5
    s_add_u32 s2, s2, s3
    s_lshr_b32 s38, s2, 2
    s_lshl_b32 s2, s2, 17
    s_lshl_b32 s38, s38, 17
    v_lshrrev_b32 v21, 4, v0
    v_and_b32 v22, 15, v0
    v_xor_b32 v23, v22, v21
    v_lshlrev_b32 v23, 4, v23
    v_lshl_add_u32 v23, v21, 8, v23
    v_lshl_add_u32 v3, v20, 11, v23
    v_lshl_add_u32 v5, v20, 15, v23
    v_lshlrev_b32 v23, 4, v22
    v_lshl_add_u32 v23, v21, 11, v23
    v_lshl_add_u32 v4, v20, 9, v23
    v_lshrrev_b32 v23, 1, v21
    v_lshlrev_b32 v24, 1, v21
    v_and_or_b32 v24, v24, 2, v23
    s_mul_i32 s33, s32, 2176
    s_mul_i32 s34, s32, 2112
    s_mul_i32 s3, s32, 8704
    s_add_u32 s34, s34, 60928
    s_add_u32 s3, s3, 128512
    s_mov_b32 s40, 0
    s_mov_b32 s41, 4096
    s_mov_b32 s42, 8192
    s_mov_b32 s43, 12288
    s_mov_b32 s44, 16384
    s_mov_b32 s45, 20480
    s_mov_b32 s46, 24576
    s_mov_b32 s47, 28672
    s_mov_b32 s50, 0
    s_mov_b32 s51, 8192
    s_mov_b32 s52, 16384
    s_mov_b32 s53, 24576
    s_mov_b32 s54, 32768
    s_mov_b32 s55, 40960
    s_mov_b32 s56, 49152
    s_mov_b32 s57, 57344
    s_mov_b32 s58, 65536
    s_mov_b32 s59, 73728
    s_mov_b32 s60, 81920
    s_mov_b32 s61, 90112
    s_mov_b32 s62, 98304
    s_mov_b32 s63, 106496
    s_mov_b32 s64, 114688
    s_mov_b32 s65, 122880
    s_mov_b32 s18, 0x20000
    s_mov_b32 s19, 0x20000
    s_mov_b32 s22, 0x20000
    s_mov_b32 s23, 0x20000
    s_mov_b32 s26, 0x20000
    s_mov_b32 s27, 0x20000
    s_mov_b32 s30, 0x20000
    s_mov_b32 s31, 0x20000
    v_and_b32 v25, 3, v22
    v_lshrrev_b32 v26, 2, v22
    v_mul_u32_u24 v26, 1088, v26
    v_lshl_add_u32 v26, v25, 8, v26
    v_xor_b32 v27, v24, v25
    v_lshl_add_u32 v1, v27, 4, v26
    v_add_u32 v6, s3, v1
    v_add_u32 v26, s3, v26
    v_and_b32 v27, 1, v21
    v_lshl_add_u32 v26, v27, 3, v26
    v_xor_b32 v27, v23, v25
    v_lshl_add_u32 v28, v27, 4, v26
    v_accvgpr_write_b32 a121, v28
    v_xor_b32 v27, 2, v27
    v_lshl_add_u32 v28, v27, 4, v26
    v_accvgpr_write_b32 a122, v28
    v_lshl_add_u32 v28, v0, 4, s3
    v_accvgpr_write_b32 a120, v28
    v_bfe_u32 v26, v0, 2, 3
    v_mul_u32_u24 v26, 1056, v26
    v_lshl_add_u32 v26, v23, 8, v26
    v_lshl_add_u32 v26, v25, 3, v26
    v_add_u32 v2, 60928, v26
    v_mov_b32 v254, v0
    v_lshl_add_u32 v26, v20, 7, v22
    v_lshlrev_b32 v26, 8, v26
    v_lshl_add_u32 v0, v24, 4, v26
    s_mov_b32 s35, 0x5f800000
    s_mov_b64 s[36:37], 0
    s_waitcnt lgkmcnt(0)
    s_add_u32 s20, s6, s38
    s_addc_u32 s21, s7, 0
    s_add_u32 s16, s4, s2
    s_addc_u32 s17, s5, 0
    s_add_u32 s24, s8, s38
    s_addc_u32 s25, s9, 0
    s_add_u32 s28, s10, s2
    s_addc_u32 s29, s11, 0
    s_add_u32 m0, s33, 0
    v_and_b32 v250, 3, v254
    buffer_load_dwordx4 v3, s[20:23], s50 offen offset:0 lds
    s_add_u32 m0, s33, 64
    v_cmp_eq_u32 vcc, 0, v250
    v_mov_b32 v251, 0x3f803f80
    s_nop 0
    v_cndmask_b32 v251, 0, v251, vcc
    buffer_load_dwordx4 v3, s[20:23], s50 offen offset:1024 lds
    s_add_u32 m0, s3, 0
    v_accvgpr_write_b32 a128, v251
    buffer_load_dwordx4 v5, s[16:19], s40 offen offset:0 nt lds
    s_add_u32 m0, s3, 64
    v_accvgpr_write_b32 a129, v251
    buffer_load_dwordx4 v5, s[16:19], s40 offen offset:1024 nt lds
    s_add_u32 m0, s3, 128
    v_accvgpr_write_b32 a130, v251
    buffer_load_dwordx4 v5, s[16:19], s40 offen offset:2048 nt lds
    s_add_u32 m0, s3, 192
    v_accvgpr_write_b32 a131, v251
    buffer_load_dwordx4 v5, s[16:19], s40 offen offset:3072 nt lds
    s_add_u32 m0, s3, 4352
    v_cmp_eq_u32 vcc, 2, v250
    v_mov_b32 v251, 0x3f803f80
    s_nop 0
    v_cndmask_b32 v251, 0, v251, vcc
    buffer_load_dwordx4 v5, s[16:19], s41 offen offset:0 nt lds
    s_add_u32 m0, s3, 4416
    v_accvgpr_write_b32 a112, v251
    buffer_load_dwordx4 v5, s[16:19], s41 offen offset:1024 nt lds
    s_add_u32 m0, s3, 4480
    v_accvgpr_write_b32 a113, v251
    buffer_load_dwordx4 v5, s[16:19], s41 offen offset:2048 nt lds
    s_add_u32 m0, s3, 4544
    v_accvgpr_write_b32 a114, v251
    buffer_load_dwordx4 v5, s[16:19], s41 offen offset:3072 nt lds
    s_add_u32 m0, s34, 0
    v_accvgpr_write_b32 a115, v251
    buffer_load_dwordx4 v4, s[24:27], s50 offen offset:0 lds
    s_add_u32 m0, s34, 800
    v_lshrrev_b32 v250, 4, v254
    v_xor_b32 v250, v250, v254
    v_and_b32 v250, 2, v250
    buffer_load_dwordx4 v4, s[24:27], s50 offen offset:256 lds
    s_add_u32 m0, s33, 8704
    v_cmp_eq_u32 vcc, 0, v250
    v_mov_b32 v251, 0x3f803f80
    s_nop 0
    v_cndmask_b32 v251, 0, v251, vcc
    buffer_load_dwordx4 v3, s[20:23], s51 offen offset:0 lds
    s_add_u32 m0, s33, 8768
    v_accvgpr_write_b32 a116, v251
    buffer_load_dwordx4 v3, s[20:23], s51 offen offset:1024 lds
    v_accvgpr_write_b32 a117, v251
    v_accvgpr_write_b32 a118, v251
    v_accvgpr_write_b32 a119, v251
    v_and_b32 v7, 1, v254
    v_mul_u32_u24 v7, 0xaaaa, v7
    v_add_u32 v7, 0x4444, v7
    v_accvgpr_write_b32 a96, 0
    v_accvgpr_write_b32 a97, 0
    v_accvgpr_write_b32 a98, 0
    v_accvgpr_write_b32 a99, 0
    v_accvgpr_write_b32 a100, 0
    v_accvgpr_write_b32 a101, 0
    v_accvgpr_write_b32 a102, 0
    v_accvgpr_write_b32 a103, 0
    v_accvgpr_write_b32 a104, 0
    v_accvgpr_write_b32 a105, 0
    v_accvgpr_write_b32 a106, 0
    v_accvgpr_write_b32 a107, 0
    v_accvgpr_write_b32 a108, 0
    v_accvgpr_write_b32 a109, 0
    v_accvgpr_write_b32 a110, 0
    v_accvgpr_write_b32 a111, 0
    v_bfe_u32 v252, v254, 1, 3
    v_lshrrev_b32 v253, 4, v254
    v_lshlrev_b32 v253, 1, v253
    v_sub_u32 v252, v252, v253
    v_and_b32 v253, 1, v254
    v_lshlrev_b32 v253, 4, v253
    v_accvgpr_write_b32 a132, 0
    v_accvgpr_write_b32 a133, 0
    v_accvgpr_write_b32 a136, 0
    v_accvgpr_write_b32 a137, 0
    v_accvgpr_write_b32 a142, 0
    v_accvgpr_write_b32 a143, 0
    v_mov_b32 v250, 15875
    v_lshlrev_b32 v250, v253, v250
    v_cmp_eq_u32 vcc, 0, v252
    s_nop 1
    v_cndmask_b32 v251, 0, v250, vcc
    v_accvgpr_write_b32 a138, v251
    v_accvgpr_write_b32 a134, v251
    v_cmp_eq_u32 vcc, 1, v252
    s_nop 1
    v_cndmask_b32 v251, 0, v250, vcc
    v_accvgpr_write_b32 a139, v251
    v_accvgpr_write_b32 a135, v251
    v_mov_b32 v250, 47576
    v_lshlrev_b32 v250, v253, v250
    v_cmp_eq_u32 vcc, 0, v252
    s_nop 1
    v_cndmask_b32 v251, 0, v250, vcc
    v_accvgpr_write_b32 a140, v251
    v_accvgpr_write_b32 a144, v251
    v_cmp_eq_u32 vcc, 1, v252
    s_nop 1
    v_cndmask_b32 v251, 0, v250, vcc
    v_accvgpr_write_b32 a141, v251
    v_accvgpr_write_b32 a145, v251
    s_nop 0
    s_mov_b64 vcc, -1
    s_cmp_eq_u32 s32, 0
    s_cbranch_scc1 L_pad1
    s_cmp_eq_u32 s32, 1
    s_cbranch_scc1 L_pad2
    s_cmp_eq_u32 s32, 2
    s_cbranch_scc1 L_pad3
    s_branch L_pad4
.p2align 12
L_warm:
    s_mov_b64 vcc, 0
    s_waitcnt vmcnt(12)
    s_barrier
    s_add_u32 m0, s34, 8448
    s_waitcnt vmcnt(8)
    ds_read_b128 a[64:67], v6 offset:0
    ds_read_b128 a[68:71], v6 offset:64
    s_waitcnt lgkmcnt(1)
    v_mfma_f32_16x16x32_bf16 v[90:93], a[134:137], a[64:67], 0
    ds_read_b128 a[72:75], v6 offset:128
    ds_read_b128 a[76:79], v6 offset:192
    v_mfma_f32_16x16x32_bf16 v[90:93], a[140:143], a[64:67], v[90:93]
    ds_read_b128 a[148:151], v1 offset:0
    ds_read_b128 a[152:155], v1 offset:64
    v_mfma_f32_16x16x32_bf16 v[94:97], a[132:135], a[64:67], 0
    buffer_load_dwordx4 v4, s[24:27], s51 offen offset:0 lds
    v_mfma_f32_16x16x32_bf16 v[94:97], a[142:145], a[64:67], v[94:97]
    s_waitcnt lgkmcnt(4)
    ds_read_b128 a[156:159], v1 offset:128
    ds_read_b128 a[160:163], v1 offset:192
    v_mfma_f32_16x16x32_bf16 v[98:101], a[134:137], a[68:71], 0
    s_add_u32 m0, s34, 9248
    v_cvt_pk_bf16_f32 v26, v90, v91
    v_cvt_pk_bf16_f32 v27, v92, v93
    v_mfma_f32_16x16x32_bf16 v[98:101], a[140:143], a[68:71], v[98:101]
    v_cvt_pk_bf16_f32 v28, v94, v95
    v_cvt_pk_bf16_f32 v29, v96, v97
    v_mfma_f32_16x16x32_bf16 v[102:105], a[132:135], a[68:71], 0
    ds_read_b128 a[164:167], v1 offset:4352
    ds_read_b128 a[168:171], v1 offset:4416
    v_mfma_f32_16x16x32_bf16 v[102:105], a[142:145], a[68:71], v[102:105]
    s_waitcnt lgkmcnt(7)
    buffer_load_dwordx4 v4, s[24:27], s51 offen offset:256 lds
    v_mfma_f32_16x16x32_bf16 v[106:109], a[134:137], a[72:75], 0
    s_add_u32 m0, s33, 17408
    v_cvt_pk_bf16_f32 v30, v98, v99
    v_cvt_pk_bf16_f32 v31, v100, v101
    v_mfma_f32_16x16x32_bf16 v[106:109], a[140:143], a[72:75], v[106:109]
    s_waitcnt vmcnt(6)
    ds_read_b128 a[80:83], v6 offset:4352
    v_mfma_f32_16x16x32_bf16 v[110:113], a[132:135], a[72:75], 0
    v_cvt_pk_bf16_f32 v32, v102, v103
    v_cvt_pk_bf16_f32 v33, v104, v105
    v_mfma_f32_16x16x32_bf16 v[110:113], a[142:145], a[72:75], v[110:113]
    s_waitcnt lgkmcnt(3)
    ds_read_b128 a[84:87], v6 offset:4416
    v_cvt_pk_bf16_f32 v34, v106, v107
    v_mfma_f32_16x16x32_bf16 v[114:117], a[134:137], a[76:79], 0
    buffer_load_dwordx4 v3, s[20:23], s52 offen offset:0 lds
    v_mfma_f32_16x16x32_bf16 v[114:117], a[140:143], a[76:79], v[114:117]
    s_add_u32 m0, s33, 17472
    ds_read_b128 a[88:91], v6 offset:4480
    v_cvt_pk_bf16_f32 v35, v108, v109
    v_mfma_f32_16x16x32_bf16 v[118:121], a[132:135], a[76:79], 0
    v_cvt_pk_bf16_f32 v36, v110, v111
    v_cvt_pk_bf16_f32 v37, v112, v113
    v_mfma_f32_16x16x32_bf16 v[118:121], a[142:145], a[76:79], v[118:121]
    ds_read_b128 a[92:95], v6 offset:4544
    v_cvt_pk_bf16_f32 v38, v114, v115
    v_mfma_f32_16x16x32_bf16 v[90:93], a[148:151], v[26:29], 0
    ds_read_b128 a[172:175], v1 offset:4480
    v_cvt_pk_bf16_f32 v39, v116, v117
    v_mfma_f32_16x16x32_bf16 v[90:93], a[152:155], v[30:33], v[90:93]
    buffer_load_dwordx4 v3, s[20:23], s52 offen offset:1024 lds
    v_mfma_f32_16x16x32_bf16 v[90:93], a[156:159], v[34:37], v[90:93]
    s_add_u32 m0, s3, 0
    v_cvt_pk_bf16_f32 v40, v118, v119
    v_cvt_pk_bf16_f32 v41, v120, v121
    s_nop 1
    v_mfma_f32_16x16x32_bf16 v[90:93], a[160:163], v[38:41], v[90:93]
    s_waitcnt lgkmcnt(3)
    ds_read_b128 a[176:179], v1 offset:4544
    v_mfma_f32_16x16x32_bf16 v[122:125], a[134:137], a[80:83], 0
    v_mfma_f32_16x16x32_bf16 v[122:125], a[140:143], a[80:83], v[122:125]
    v_mfma_f32_16x16x32_bf16 v[126:129], a[132:135], a[80:83], 0
    buffer_load_dwordx4 v5, s[16:19], s42 offen offset:0 nt lds
    v_mfma_f32_16x16x32_bf16 v[126:129], a[142:145], a[80:83], v[126:129]
    s_add_u32 m0, s3, 64
    v_max3_f32 v12, v90, v91, v92
    v_max_f32 v10, v12, v93
    v_mfma_f32_16x16x32_bf16 v[130:133], a[134:137], a[84:87], 0
    v_max_f32 v11, v12, v93
    v_cvt_pk_bf16_f32 v42, v122, v123
    v_mfma_f32_16x16x32_bf16 v[130:133], a[140:143], a[84:87], v[130:133]
    v_cvt_pk_bf16_f32 v43, v124, v125
    v_cvt_pk_bf16_f32 v44, v126, v127
    v_mfma_f32_16x16x32_bf16 v[134:137], a[132:135], a[84:87], 0
    v_cvt_pk_bf16_f32 v45, v128, v129
    v_mfma_f32_16x16x32_bf16 v[134:137], a[142:145], a[84:87], v[134:137]
    s_waitcnt lgkmcnt(0)
    v_permlane16_swap_b32 v10, v11
    v_mfma_f32_16x16x32_bf16 v[138:141], a[134:137], a[88:91], 0
    v_cvt_pk_bf16_f32 v46, v130, v131
    v_cvt_pk_bf16_f32 v47, v132, v133
    v_mfma_f32_16x16x32_bf16 v[138:141], a[140:143], a[88:91], v[138:141]
    buffer_load_dwordx4 v5, s[16:19], s42 offen offset:1024 nt lds
    v_mfma_f32_16x16x32_bf16 v[142:145], a[132:135], a[88:91], 0
    s_add_u32 m0, s3, 128
    v_cvt_pk_bf16_f32 v48, v134, v135
    v_cvt_pk_bf16_f32 v49, v136, v137
    v_mfma_f32_16x16x32_bf16 v[142:145], a[142:145], a[88:91], v[142:145]
    v_max_f32 v12, v10, v11
    v_max_f32 v13, v10, v11
    v_mfma_f32_16x16x32_bf16 v[146:149], a[134:137], a[92:95], 0
    v_cvt_pk_bf16_f32 v50, v138, v139
    v_cvt_pk_bf16_f32 v51, v140, v141
    v_mfma_f32_16x16x32_bf16 v[146:149], a[140:143], a[92:95], v[146:149]
    v_permlane32_swap_b32 v12, v13
    v_mfma_f32_16x16x32_bf16 v[150:153], a[132:135], a[92:95], 0
    buffer_load_dwordx4 v5, s[16:19], s42 offen offset:2048 nt lds
    v_mfma_f32_16x16x32_bf16 v[150:153], a[142:145], a[92:95], v[150:153]
    s_add_u32 m0, s3, 192
    v_cvt_pk_bf16_f32 v52, v142, v143
    v_cvt_pk_bf16_f32 v53, v144, v145
    v_mfma_f32_16x16x32_bf16 v[122:125], a[148:151], v[42:45], 0
    v_cvt_pk_bf16_f32 v54, v146, v147
    v_cvt_pk_bf16_f32 v55, v148, v149
    v_mfma_f32_16x16x32_bf16 v[122:125], a[152:155], v[46:49], v[122:125]
    v_min_f32_e64 v10, -v12, -v13
    v_cvt_pk_bf16_f32 v56, v150, v151
    v_mfma_f32_16x16x32_bf16 v[122:125], a[156:159], v[50:53], v[122:125]
    v_cvt_pk_bf16_f32 v57, v152, v153
    v_min_f32_e64 v11, -v12, -v13
    s_nop 0
    v_mfma_f32_16x16x32_bf16 v[122:125], a[160:163], v[54:57], v[122:125]
    buffer_load_dwordx4 v5, s[16:19], s42 offen offset:3072 nt lds
    v_mov_b32 v12, v10
    v_mov_b32 v13, v10
    v_add_f32 v90, v90, v10
    s_nop 0
    v_mfma_f32_16x16x32_bf16 v[218:221], a[164:167], v[26:29], v[10:13]
    s_add_u32 m0, s34, 16896
    v_add_f32 v91, v91, v10
    v_exp_f32 v90, v90
    v_max3_f32 v16, v122, v123, v124
    v_max_f32 v14, v16, v125
    v_max_f32 v15, v16, v125
    v_mfma_f32_16x16x32_bf16 v[218:221], a[168:171], v[30:33], v[218:221]
    v_add_f32 v92, v92, v10
    v_exp_f32 v91, v91
    v_permlane16_swap_b32 v14, v15
    v_max_f32 v16, v14, v15
    v_max_f32 v17, v14, v15
    v_mfma_f32_16x16x32_bf16 v[218:221], a[172:175], v[34:37], v[218:221]
    v_add_f32 v93, v93, v10
    v_exp_f32 v92, v92
    v_mfma_f32_16x16x32_bf16 v[218:221], a[176:179], v[38:41], v[218:221]
    v_permlane32_swap_b32 v16, v17
    v_min_f32_e64 v14, -v16, -v17
    v_min_f32_e64 v15, -v16, -v17
    s_waitcnt vmcnt(8)
    s_barrier
    ds_read_b64_tr_b16 a[200:201], v2 offset:0
    ds_read_b64_tr_b16 a[202:203], v2 offset:512
    ds_read_b64_tr_b16 a[204:205], v2 offset:32
    ds_read_b64_tr_b16 a[206:207], v2 offset:544
    ds_read_b64_tr_b16 a[208:209], v2 offset:64
    ds_read_b64_tr_b16 a[210:211], v2 offset:576
    ds_read_b64_tr_b16 a[212:213], v2 offset:96
    ds_read_b64_tr_b16 a[214:215], v2 offset:608
    buffer_load_dwordx4 v4, s[24:27], s52 offen offset:0 lds
    v_mov_b32 v16, v14
    v_mov_b32 v17, v14
    v_exp_f32 v93, v93
    s_nop 0
    v_mfma_f32_16x16x32_bf16 v[222:225], a[164:167], v[42:45], v[14:17]
    s_add_u32 m0, s34, 17696
    ds_read_b64_tr_b16 a[216:217], v2 offset:128
    ds_read_b64_tr_b16 a[218:219], v2 offset:640
    v_mfma_f32_16x16x32_bf16 v[222:225], a[168:171], v[46:49], v[222:225]
    ds_read_b64_tr_b16 a[220:221], v2 offset:160
    ds_read_b64_tr_b16 a[222:223], v2 offset:672
    v_mfma_f32_16x16x32_bf16 v[222:225], a[172:175], v[50:53], v[222:225]
    ds_read_b64_tr_b16 a[224:225], v2 offset:192
    ds_read_b64_tr_b16 a[226:227], v2 offset:704
    v_exp_f32 v218, v218
    v_exp_f32 v219, v219
    v_exp_f32 v220, v220
    v_exp_f32 v221, v221
    v_mfma_f32_16x16x32_bf16 v[222:225], a[176:179], v[54:57], v[222:225]
    s_waitcnt lgkmcnt(12)
    ds_read_b64_tr_b16 a[228:229], v2 offset:224
    ds_read_b64_tr_b16 a[230:231], v2 offset:736
    v_cvt_pk_bf16_f32 v234, v90, v91
    v_cvt_pk_bf16_f32 v235, v92, v93
    v_cvt_pk_bf16_f32 v236, v218, v219
    v_cvt_pk_bf16_f32 v237, v220, v221
    v_add_f32 v122, v122, v14
    s_nop 0
    v_mfma_f32_16x16x32_bf16 v[90:93], a[200:203], v[234:237], 0
    s_waitcnt lgkmcnt(12)
    buffer_load_dwordx4 v4, s[24:27], s52 offen offset:256 lds
    v_mfma_f32_16x16x32_bf16 v[94:97], a[204:207], v[234:237], 0
    s_waitcnt lgkmcnt(10)
    ds_read_b128 a[180:183], v1 offset:8704
    ds_read_b128 a[184:187], v1 offset:8768
    v_mfma_f32_16x16x32_bf16 v[98:101], a[208:211], v[234:237], 0
    s_waitcnt lgkmcnt(10)
    ds_read_b128 a[188:191], v1 offset:8832
    ds_read_b128 a[192:195], v1 offset:8896
    v_mfma_f32_16x16x32_bf16 v[102:105], a[212:215], v[234:237], 0
    s_waitcnt lgkmcnt(10)
    ds_read_b128 a[196:199], v1 offset:13056
    ds_read_b128 a[148:151], v1 offset:13120
    v_mfma_f32_16x16x32_bf16 v[106:109], a[216:219], v[234:237], 0
    s_waitcnt lgkmcnt(10)
    ds_read_b128 a[152:155], v1 offset:13184
    v_add_f32 v123, v123, v14
    s_add_u32 m0, s33, 26112
    v_mfma_f32_16x16x32_bf16 v[110:113], a[220:223], v[234:237], 0
    s_waitcnt lgkmcnt(9)
    buffer_load_dwordx4 v3, s[20:23], s53 offen offset:0 lds
    v_mfma_f32_16x16x32_bf16 v[114:117], a[224:227], v[234:237], 0
    s_waitcnt lgkmcnt(7)
    v_exp_f32 v122, v122
    v_mfma_f32_16x16x32_bf16 v[118:121], a[228:231], v[234:237], 0
    s_add_u32 m0, s33, 26176
    ds_read_b128 a[156:159], v1 offset:13248
    v_add_f32 v124, v124, v14
    s_waitcnt vmcnt(7)
    s_barrier
    s_waitcnt lgkmcnt(7)
    v_exp_f32 v123, v123
    v_mfma_f32_16x16x32_bf16 v[226:229], a[180:183], v[26:29], v[10:13]
    s_waitcnt lgkmcnt(6)
    v_exp_f32 v124, v124
    v_mfma_f32_16x16x32_bf16 v[226:229], a[184:187], v[30:33], v[226:229]
    s_waitcnt lgkmcnt(4)
    buffer_load_dwordx4 v3, s[20:23], s53 offen offset:1024 lds
    v_mfma_f32_16x16x32_bf16 v[226:229], a[188:191], v[34:37], v[226:229]
    s_add_u32 m0, s34, 25344
    v_add_f32 v125, v125, v14
    v_exp_f32 v125, v125
    v_mfma_f32_16x16x32_bf16 v[226:229], a[192:195], v[38:41], v[226:229]
    s_waitcnt lgkmcnt(1)
    v_exp_f32 v222, v222
    v_mfma_f32_16x16x32_bf16 v[230:233], a[196:199], v[26:29], v[10:13]
    v_exp_f32 v223, v223
    v_mfma_f32_16x16x32_bf16 v[230:233], a[148:151], v[30:33], v[230:233]
    v_exp_f32 v224, v224
    v_mfma_f32_16x16x32_bf16 v[230:233], a[152:155], v[34:37], v[230:233]
    s_waitcnt lgkmcnt(0)
    buffer_load_dwordx4 v4, s[24:27], s53 offen offset:0 lds
    v_exp_f32 v225, v225
    v_mfma_f32_16x16x32_bf16 v[230:233], a[156:159], v[38:41], v[230:233]
    s_add_u32 m0, s34, 26144
    v_cvt_pk_bf16_f32 v238, v122, v123
    v_cvt_pk_bf16_f32 v239, v124, v125
    v_cvt_pk_bf16_f32 v240, v222, v223
    v_cvt_pk_bf16_f32 v241, v224, v225
    v_exp_f32 v226, v226
    s_nop 0
    v_smfmac_f32_16x16x64_bf16 a[96:99], a[116:119], v[234:241], v7
    ds_read_b64_tr_b16 a[232:233], v2 offset:8448
    v_mfma_f32_16x16x32_bf16 v[122:125], a[200:203], v[238:241], 0
    buffer_load_dwordx4 v4, s[24:27], s53 offen offset:256 lds
    v_mfma_f32_16x16x32_bf16 v[126:129], a[204:207], v[238:241], 0
    s_add_u32 m0, s33, 34816
    v_exp_f32 v227, v227
    v_mfma_f32_16x16x32_bf16 v[130:133], a[208:211], v[238:241], 0
    ds_read_b64_tr_b16 a[234:235], v2 offset:8960
    ds_read_b64_tr_b16 a[236:237], v2 offset:8480
    v_mfma_f32_16x16x32_bf16 v[134:137], a[212:215], v[238:241], 0
    v_exp_f32 v228, v228
    v_mfma_f32_16x16x32_bf16 v[138:141], a[216:219], v[238:241], 0
    ds_read_b64_tr_b16 a[238:239], v2 offset:8992
    ds_read_b64_tr_b16 a[240:241], v2 offset:8512
    v_mfma_f32_16x16x32_bf16 v[142:145], a[220:223], v[238:241], 0
    buffer_load_dwordx4 v3, s[20:23], s54 offen offset:0 lds
    v_mfma_f32_16x16x32_bf16 v[146:149], a[224:227], v[238:241], 0
    s_add_u32 m0, s33, 34880
    v_exp_f32 v229, v229
    v_mfma_f32_16x16x32_bf16 v[150:153], a[228:231], v[238:241], 0
    ds_read_b64_tr_b16 a[242:243], v2 offset:9024
    ds_read_b64_tr_b16 a[244:245], v2 offset:8544
    v_mfma_f32_16x16x32_bf16 v[218:221], a[180:183], v[42:45], v[14:17]
    v_exp_f32 v230, v230
    v_mfma_f32_16x16x32_bf16 v[218:221], a[184:187], v[46:49], v[218:221]
    ds_read_b64_tr_b16 a[246:247], v2 offset:9056
    ds_read_b64_tr_b16 a[248:249], v2 offset:8576
    v_mfma_f32_16x16x32_bf16 v[218:221], a[188:191], v[50:53], v[218:221]
    v_exp_f32 v231, v231
    v_mfma_f32_16x16x32_bf16 v[218:221], a[192:195], v[54:57], v[218:221]
    buffer_load_dwordx4 v3, s[20:23], s54 offen offset:1024 lds
    v_mfma_f32_16x16x32_bf16 v[222:225], a[196:199], v[42:45], v[14:17]
    s_add_u32 m0, s3, 4352
    ds_read_b64_tr_b16 a[250:251], v2 offset:9088
    v_exp_f32 v232, v232
    v_mfma_f32_16x16x32_bf16 v[222:225], a[148:151], v[46:49], v[222:225]
    ds_read_b64_tr_b16 a[252:253], v2 offset:8608
    ds_read_b64_tr_b16 a[254:255], v2 offset:9120
    v_mfma_f32_16x16x32_bf16 v[222:225], a[152:155], v[50:53], v[222:225]
    ds_read_b64_tr_b16 a[200:201], v2 offset:8640
    ds_read_b64_tr_b16 a[202:203], v2 offset:9152
    v_exp_f32 v233, v233
    v_mfma_f32_16x16x32_bf16 v[222:225], a[156:159], v[54:57], v[222:225]
    s_waitcnt lgkmcnt(7)
    ds_read_b64_tr_b16 a[204:205], v2 offset:8672
    ds_read_b64_tr_b16 a[206:207], v2 offset:9184
    v_cvt_pk_bf16_f32 v242, v226, v227
    v_cvt_pk_bf16_f32 v243, v228, v229
    v_cvt_pk_bf16_f32 v244, v230, v231
    v_cvt_pk_bf16_f32 v245, v232, v233
    v_exp_f32 v218, v218
    s_nop 0
    v_mfma_f32_16x16x32_bf16 v[90:93], a[232:235], v[242:245], v[90:93]
    buffer_load_dwordx4 v5, s[16:19], s43 offen offset:0 nt lds
    v_mfma_f32_16x16x32_bf16 v[94:97], a[236:239], v[242:245], v[94:97]
    s_add_u32 m0, s3, 4416
    ds_read_b128 a[160:163], v1 offset:17408
    ds_read_b128 a[164:167], v1 offset:17472
    v_mfma_f32_16x16x32_bf16 v[98:101], a[240:243], v[242:245], v[98:101]
    s_waitcnt lgkmcnt(9)
    ds_read_b128 a[168:171], v1 offset:17536
    ds_read_b128 a[172:175], v1 offset:17600
    v_mfma_f32_16x16x32_bf16 v[102:105], a[244:247], v[242:245], v[102:105]
    s_waitcnt lgkmcnt(10)
    ds_read_b128 a[176:179], v1 offset:21760
    ds_read_b128 a[180:183], v1 offset:21824
    v_mfma_f32_16x16x32_bf16 v[106:109], a[248:251], v[242:245], v[106:109]
    s_waitcnt lgkmcnt(10)
    buffer_load_dwordx4 v5, s[16:19], s43 offen offset:1024 nt lds
    v_mfma_f32_16x16x32_bf16 v[110:113], a[252:255], v[242:245], v[110:113]
    s_waitcnt lgkmcnt(8)
    ds_read_b128 a[184:187], v1 offset:21888
    ds_read_b128 a[188:191], v1 offset:21952
    v_mfma_f32_16x16x32_bf16 v[114:117], a[200:203], v[242:245], v[114:117]
    s_waitcnt lgkmcnt(8)
    v_exp_f32 v219, v219
    v_mfma_f32_16x16x32_bf16 v[118:121], a[204:207], v[242:245], v[118:121]
    s_add_u32 m0, s3, 4480
    v_exp_f32 v220, v220
    s_waitcnt vmcnt(6)
    s_barrier
    s_waitcnt lgkmcnt(7)
    v_exp_f32 v221, v221
    v_mfma_f32_16x16x32_bf16 v[226:229], a[160:163], v[26:29], v[10:13]
    s_waitcnt lgkmcnt(6)
    buffer_load_dwordx4 v5, s[16:19], s43 offen offset:2048 nt lds
    v_mfma_f32_16x16x32_bf16 v[226:229], a[164:167], v[30:33], v[226:229]
    s_waitcnt lgkmcnt(4)
    v_exp_f32 v222, v222
    v_mfma_f32_16x16x32_bf16 v[226:229], a[168:171], v[34:37], v[226:229]
    s_add_u32 m0, s3, 4544
    v_exp_f32 v223, v223
    v_mfma_f32_16x16x32_bf16 v[226:229], a[172:175], v[38:41], v[226:229]
    s_waitcnt lgkmcnt(2)
    v_exp_f32 v224, v224
    v_mfma_f32_16x16x32_bf16 v[230:233], a[176:179], v[26:29], v[10:13]
    v_cvt_pk_bf16_f32 v246, v218, v219
    v_cvt_pk_bf16_f32 v247, v220, v221
    v_mfma_f32_16x16x32_bf16 v[230:233], a[180:183], v[30:33], v[230:233]
    s_waitcnt lgkmcnt(0)
    v_exp_f32 v225, v225
    v_mfma_f32_16x16x32_bf16 v[230:233], a[184:187], v[34:37], v[230:233]
    v_cvt_pk_bf16_f32 v248, v222, v223
    v_cvt_pk_bf16_f32 v249, v224, v225
    v_mfma_f32_16x16x32_bf16 v[230:233], a[188:191], v[38:41], v[230:233]
    buffer_load_dwordx4 v5, s[16:19], s43 offen offset:3072 nt lds
    v_smfmac_f32_16x16x64_bf16 a[96:99], a[116:119], v[242:249], v7
    s_add_u32 m0, s34, 33792
    ds_read_b64_tr_b16 a[208:209], v2 offset:16896
    v_mfma_f32_16x16x32_bf16 v[122:125], a[232:235], v[246:249], v[122:125]
    v_exp_f32 v226, v226
    v_mfma_f32_16x16x32_bf16 v[126:129], a[236:239], v[246:249], v[126:129]
    buffer_load_dwordx4 v4, s[24:27], s54 offen offset:0 lds
    v_mfma_f32_16x16x32_bf16 v[130:133], a[240:243], v[246:249], v[130:133]
    s_add_u32 m0, s34, 34592
    v_exp_f32 v227, v227
    v_mfma_f32_16x16x32_bf16 v[134:137], a[244:247], v[246:249], v[134:137]
    ds_read_b64_tr_b16 a[210:211], v2 offset:17408
    ds_read_b64_tr_b16 a[212:213], v2 offset:16928
    v_mfma_f32_16x16x32_bf16 v[138:141], a[248:251], v[246:249], v[138:141]
    v_exp_f32 v228, v228
    v_mfma_f32_16x16x32_bf16 v[142:145], a[252:255], v[246:249], v[142:145]
    ds_read_b64_tr_b16 a[214:215], v2 offset:17440
    ds_read_b64_tr_b16 a[216:217], v2 offset:16960
    v_mfma_f32_16x16x32_bf16 v[146:149], a[200:203], v[246:249], v[146:149]
    buffer_load_dwordx4 v4, s[24:27], s54 offen offset:256 lds
    v_mfma_f32_16x16x32_bf16 v[150:153], a[204:207], v[246:249], v[150:153]
    s_add_u32 m0, s33, 43520
    v_exp_f32 v229, v229
    v_mfma_f32_16x16x32_bf16 v[218:221], a[160:163], v[42:45], v[14:17]
    ds_read_b64_tr_b16 a[218:219], v2 offset:17472
    ds_read_b64_tr_b16 a[220:221], v2 offset:16992
    v_mfma_f32_16x16x32_bf16 v[218:221], a[164:167], v[46:49], v[218:221]
    v_exp_f32 v230, v230
    v_mfma_f32_16x16x32_bf16 v[218:221], a[168:171], v[50:53], v[218:221]
    ds_read_b64_tr_b16 a[222:223], v2 offset:17504
    ds_read_b64_tr_b16 a[224:225], v2 offset:17024
    v_mfma_f32_16x16x32_bf16 v[218:221], a[172:175], v[54:57], v[218:221]
    v_exp_f32 v231, v231
    v_mfma_f32_16x16x32_bf16 v[222:225], a[176:179], v[42:45], v[14:17]
    ds_read_b64_tr_b16 a[226:227], v2 offset:17536
    v_exp_f32 v232, v232
    v_mfma_f32_16x16x32_bf16 v[222:225], a[180:183], v[46:49], v[222:225]
    ds_read_b64_tr_b16 a[228:229], v2 offset:17056
    ds_read_b64_tr_b16 a[230:231], v2 offset:17568
    buffer_load_dwordx4 v3, s[20:23], s55 offen offset:0 lds
    v_mfma_f32_16x16x32_bf16 v[222:225], a[184:187], v[50:53], v[222:225]
    s_add_u32 m0, s33, 43584
    ds_read_b64_tr_b16 a[232:233], v2 offset:17088
    ds_read_b64_tr_b16 a[234:235], v2 offset:17600
    v_exp_f32 v233, v233
    v_mfma_f32_16x16x32_bf16 v[222:225], a[188:191], v[54:57], v[222:225]
    s_waitcnt lgkmcnt(9)
    ds_read_b64_tr_b16 a[236:237], v2 offset:17120
    ds_read_b64_tr_b16 a[238:239], v2 offset:17632
    v_cvt_pk_bf16_f32 v234, v226, v227
    v_cvt_pk_bf16_f32 v235, v228, v229
    v_cvt_pk_bf16_f32 v236, v230, v231
    v_cvt_pk_bf16_f32 v237, v232, v233
    v_exp_f32 v218, v218
    s_nop 0
    v_mfma_f32_16x16x32_bf16 v[90:93], a[208:211], v[234:237], v[90:93]
    ds_read_b128 a[64:67], v6 offset:0
    ds_read_b128 a[192:195], v1 offset:26112
    v_mfma_f32_16x16x32_bf16 v[94:97], a[212:215], v[234:237], v[94:97]
    s_waitcnt lgkmcnt(11)
    buffer_load_dwordx4 v3, s[20:23], s55 offen offset:1024 lds
    v_mfma_f32_16x16x32_bf16 v[98:101], a[216:219], v[234:237], v[98:101]
    s_waitcnt lgkmcnt(9)
    ds_read_b128 a[68:71], v6 offset:64
    ds_read_b128 a[196:199], v1 offset:26176
    v_mfma_f32_16x16x32_bf16 v[102:105], a[220:223], v[234:237], v[102:105]
    s_waitcnt lgkmcnt(10)
    ds_read_b128 a[148:151], v1 offset:26240
    ds_read_b128 a[152:155], v1 offset:26304
    v_mfma_f32_16x16x32_bf16 v[106:109], a[224:227], v[234:237], v[106:109]
    s_waitcnt lgkmcnt(10)
    ds_read_b128 a[156:159], v1 offset:30464
    ds_read_b128 a[160:163], v1 offset:30528
    v_mfma_f32_16x16x32_bf16 v[110:113], a[228:231], v[234:237], v[110:113]
    s_waitcnt lgkmcnt(10)
    ds_read_b128 a[72:75], v6 offset:128
    ds_read_b128 a[164:167], v1 offset:30592
    v_mfma_f32_16x16x32_bf16 v[114:117], a[232:235], v[234:237], v[114:117]
    s_waitcnt lgkmcnt(10)
    ds_read_b128 a[168:171], v1 offset:30656
    s_add_u32 m0, s34, 42240
    v_mfma_f32_16x16x32_bf16 v[118:121], a[236:239], v[234:237], v[118:121]
    s_waitcnt lgkmcnt(10)
    buffer_load_dwordx4 v4, s[24:27], s55 offen offset:0 lds
    v_mfma_f32_16x16x32_bf16 v[154:157], a[134:137], a[64:67], 0
    s_add_u32 m0, s34, 43040
    v_exp_f32 v219, v219
    v_mfma_f32_16x16x32_bf16 v[154:157], a[140:143], a[64:67], v[154:157]
    ds_read_b128 a[76:79], v6 offset:192
    v_cvt_pk_bf16_f32 v238, v218, v219
    v_mfma_f32_16x16x32_bf16 v[158:161], a[132:135], a[64:67], 0
    buffer_load_dwordx4 v4, s[24:27], s55 offen offset:256 lds
    v_mfma_f32_16x16x32_bf16 v[158:161], a[142:145], a[64:67], v[158:161]
    s_waitcnt lgkmcnt(6)
    v_exp_f32 v220, v220
    v_mfma_f32_16x16x32_bf16 v[162:165], a[134:137], a[68:71], 0
    s_add_u32 m0, s33, 52224
    v_cvt_pk_bf16_f32 v58, v154, v155
    v_cvt_pk_bf16_f32 v59, v156, v157
    v_mfma_f32_16x16x32_bf16 v[162:165], a[140:143], a[68:71], v[162:165]
    v_exp_f32 v221, v221
    v_mfma_f32_16x16x32_bf16 v[166:169], a[132:135], a[68:71], 0
    v_cvt_pk_bf16_f32 v60, v158, v159
    v_cvt_pk_bf16_f32 v61, v160, v161
    v_mfma_f32_16x16x32_bf16 v[166:169], a[142:145], a[68:71], v[166:169]
    s_waitcnt lgkmcnt(1)
    buffer_load_dwordx4 v3, s[20:23], s56 offen offset:0 lds
    v_mfma_f32_16x16x32_bf16 v[170:173], a[134:137], a[72:75], 0
    s_add_u32 m0, s33, 52288
    v_cvt_pk_bf16_f32 v62, v162, v163
    v_cvt_pk_bf16_f32 v63, v164, v165
    v_mfma_f32_16x16x32_bf16 v[170:173], a[140:143], a[72:75], v[170:173]
    v_exp_f32 v222, v222
    v_mfma_f32_16x16x32_bf16 v[174:177], a[132:135], a[72:75], 0
    v_cvt_pk_bf16_f32 v64, v166, v167
    v_cvt_pk_bf16_f32 v65, v168, v169
    v_mfma_f32_16x16x32_bf16 v[174:177], a[142:145], a[72:75], v[174:177]
    s_waitcnt lgkmcnt(0)
    v_exp_f32 v223, v223
    v_mfma_f32_16x16x32_bf16 v[178:181], a[134:137], a[76:79], 0
    buffer_load_dwordx4 v3, s[20:23], s56 offen offset:1024 lds
    v_mfma_f32_16x16x32_bf16 v[178:181], a[140:143], a[76:79], v[178:181]
    s_add_u32 m0, s34, 50688
    v_cvt_pk_bf16_f32 v66, v170, v171
    v_cvt_pk_bf16_f32 v67, v172, v173
    v_mfma_f32_16x16x32_bf16 v[182:185], a[132:135], a[76:79], 0
    v_cvt_pk_bf16_f32 v68, v174, v175
    v_cvt_pk_bf16_f32 v69, v176, v177
    v_mfma_f32_16x16x32_bf16 v[182:185], a[142:145], a[76:79], v[182:185]
    v_exp_f32 v224, v224
    s_waitcnt vmcnt(12)
    s_barrier
    v_cvt_pk_bf16_f32 v70, v178, v179
    v_cvt_pk_bf16_f32 v71, v180, v181
    v_mfma_f32_16x16x32_bf16 v[154:157], a[192:195], v[58:61], 0
    buffer_load_dwordx4 v4, s[24:27], s56 offen offset:0 lds
    v_mfma_f32_16x16x32_bf16 v[154:157], a[196:199], v[62:65], v[154:157]
    s_add_u32 m0, s34, 51488
    v_cvt_pk_bf16_f32 v72, v182, v183
    v_cvt_pk_bf16_f32 v73, v184, v185
    v_mfma_f32_16x16x32_bf16 v[154:157], a[148:151], v[66:69], v[154:157]
    v_cvt_pk_bf16_f32 v239, v220, v221
    v_cvt_pk_bf16_f32 v240, v222, v223
    v_mfma_f32_16x16x32_bf16 v[154:157], a[152:155], v[70:73], v[154:157]
    v_exp_f32 v225, v225
    v_mfma_f32_16x16x32_bf16 v[226:229], a[192:195], v[26:29], v[10:13]
    ds_read_b64_tr_b16 a[240:241], v2 offset:25344
    v_cvt_pk_bf16_f32 v241, v224, v225
    v_mfma_f32_16x16x32_bf16 v[226:229], a[196:199], v[30:33], v[226:229]
    buffer_load_dwordx4 v4, s[24:27], s56 offen offset:256 lds
    v_mfma_f32_16x16x32_bf16 v[226:229], a[148:151], v[34:37], v[226:229]
    s_add_u32 m0, s33, 0
    ds_read_b64_tr_b16 a[242:243], v2 offset:25856
    ds_read_b64_tr_b16 a[244:245], v2 offset:25376
    v_mfma_f32_16x16x32_bf16 v[226:229], a[152:155], v[38:41], v[226:229]
    ds_read_b64_tr_b16 a[246:247], v2 offset:25888
    ds_read_b64_tr_b16 a[248:249], v2 offset:25408
    v_mfma_f32_16x16x32_bf16 v[230:233], a[156:159], v[26:29], v[10:13]
    ds_read_b64_tr_b16 a[250:251], v2 offset:25920
    ds_read_b64_tr_b16 a[252:253], v2 offset:25440
    v_mfma_f32_16x16x32_bf16 v[230:233], a[160:163], v[30:33], v[230:233]
    ds_read_b64_tr_b16 a[254:255], v2 offset:25952
    ds_read_b64_tr_b16 a[200:201], v2 offset:25472
    v_mfma_f32_16x16x32_bf16 v[230:233], a[164:167], v[34:37], v[230:233]
    buffer_load_dwordx4 v3, s[20:23], s57 offen offset:0 lds
    v_mfma_f32_16x16x32_bf16 v[230:233], a[168:171], v[38:41], v[230:233]
    s_add_u32 m0, s33, 64
    v_exp_f32 v226, v226
    v_smfmac_f32_16x16x64_bf16 a[96:99], a[116:119], v[234:241], v7
    ds_read_b64_tr_b16 a[202:203], v2 offset:25984
    v_mfma_f32_16x16x32_bf16 v[122:125], a[208:211], v[238:241], v[122:125]
    v_exp_f32 v227, v227
    v_mfma_f32_16x16x32_bf16 v[126:129], a[212:215], v[238:241], v[126:129]
    v_exp_f32 v228, v228
    v_mfma_f32_16x16x32_bf16 v[130:133], a[216:219], v[238:241], v[130:133]
    buffer_load_dwordx4 v3, s[20:23], s57 offen offset:1024 lds
    v_mfma_f32_16x16x32_bf16 v[134:137], a[220:223], v[238:241], v[134:137]
    s_add_u32 m0, s34, 59136
    v_exp_f32 v229, v229
    v_mfma_f32_16x16x32_bf16 v[138:141], a[224:227], v[238:241], v[138:141]
    v_exp_f32 v230, v230
    v_mfma_f32_16x16x32_bf16 v[142:145], a[228:231], v[238:241], v[142:145]
    v_exp_f32 v231, v231
    v_mfma_f32_16x16x32_bf16 v[146:149], a[232:235], v[238:241], v[146:149]
    v_exp_f32 v232, v232
    v_mfma_f32_16x16x32_bf16 v[150:153], a[236:239], v[238:241], v[150:153]
    buffer_load_dwordx4 v4, s[24:27], s57 offen offset:0 lds
    v_mfma_f32_16x16x32_bf16 v[218:221], a[192:195], v[42:45], v[14:17]
    s_add_u32 m0, s34, 59936
    ds_read_b64_tr_b16 a[204:205], v2 offset:25504
    v_cvt_pk_bf16_f32 v242, v226, v227
    v_mfma_f32_16x16x32_bf16 v[218:221], a[196:199], v[46:49], v[218:221]
    ds_read_b64_tr_b16 a[206:207], v2 offset:26016
    v_cvt_pk_bf16_f32 v243, v228, v229
    v_mfma_f32_16x16x32_bf16 v[218:221], a[148:151], v[50:53], v[218:221]
    v_exp_f32 v233, v233
    v_mfma_f32_16x16x32_bf16 v[218:221], a[152:155], v[54:57], v[218:221]
    ds_read_b64_tr_b16 a[208:209], v2 offset:25536
    v_cvt_pk_bf16_f32 v244, v230, v231
    v_mfma_f32_16x16x32_bf16 v[222:225], a[156:159], v[42:45], v[14:17]
    buffer_load_dwordx4 v4, s[24:27], s57 offen offset:256 lds
    v_mfma_f32_16x16x32_bf16 v[222:225], a[160:163], v[46:49], v[222:225]
    s_add_u32 m0, s33, 8704
    ds_read_b64_tr_b16 a[210:211], v2 offset:26048
    v_cvt_pk_bf16_f32 v245, v232, v233
    v_mfma_f32_16x16x32_bf16 v[222:225], a[164:167], v[50:53], v[222:225]
    ds_read_b64_tr_b16 a[212:213], v2 offset:25568
    ds_read_b64_tr_b16 a[214:215], v2 offset:26080
    v_mfma_f32_16x16x32_bf16 v[222:225], a[168:171], v[54:57], v[222:225]
    s_waitcnt lgkmcnt(6)
    s_waitcnt vmcnt(14)
    ds_read_b128 a[80:83], v6 offset:4352
    v_mfma_f32_16x16x32_bf16 v[90:93], a[240:243], v[242:245], v[90:93]
    ds_read_b128 a[172:175], v1 offset:34816
    v_max3_f32 v20, v154, v155, v156
    v_mfma_f32_16x16x32_bf16 v[94:97], a[244:247], v[242:245], v[94:97]
    buffer_load_dwordx4 v3, s[20:23], s58 offen offset:0 lds
    v_mfma_f32_16x16x32_bf16 v[98:101], a[248:251], v[242:245], v[98:101]
    s_add_u32 m0, s33, 8768
    ds_read_b128 a[84:87], v6 offset:4416
    v_max_f32 v18, v20, v157
    v_mfma_f32_16x16x32_bf16 v[102:105], a[252:255], v[242:245], v[102:105]
    ds_read_b128 a[176:179], v1 offset:34880
    v_max_f32 v19, v20, v157
    v_mfma_f32_16x16x32_bf16 v[106:109], a[200:203], v[242:245], v[106:109]
    s_waitcnt lgkmcnt(7)
    v_permlane16_swap_b32 v18, v19
    v_mfma_f32_16x16x32_bf16 v[110:113], a[204:207], v[242:245], v[110:113]
    s_waitcnt lgkmcnt(6)
    ds_read_b128 a[88:91], v6 offset:4480
    v_max_f32 v20, v18, v19
    v_mfma_f32_16x16x32_bf16 v[114:117], a[208:211], v[242:245], v[114:117]
    s_waitcnt lgkmcnt(5)
    buffer_load_dwordx4 v3, s[20:23], s58 offen offset:1024 lds
    v_mfma_f32_16x16x32_bf16 v[118:121], a[212:215], v[242:245], v[118:121]
    s_waitcnt lgkmcnt(4)
    v_exp_f32 v218, v218
    v_mfma_f32_16x16x32_bf16 v[186:189], a[134:137], a[80:83], 0
L_pad1:
    s_cbranch_vccnz L_pad5
    s_add_u32 m0, s34, 0
    ds_read_b128 a[180:183], v1 offset:34944
    v_max_f32 v21, v18, v19
    v_mfma_f32_16x16x32_bf16 v[186:189], a[140:143], a[80:83], v[186:189]
    ds_read_b128 a[92:95], v6 offset:4544
    ds_read_b128 a[184:187], v1 offset:35008
    v_mfma_f32_16x16x32_bf16 v[190:193], a[132:135], a[80:83], 0
    v_exp_f32 v219, v219
    v_mfma_f32_16x16x32_bf16 v[190:193], a[142:145], a[80:83], v[190:193]
    s_waitcnt lgkmcnt(4)
    buffer_load_dwordx4 v4, s[24:27], s58 offen offset:0 lds
    v_mfma_f32_16x16x32_bf16 v[194:197], a[134:137], a[84:87], 0
    s_add_u32 m0, s34, 800
    v_permlane32_swap_b32 v20, v21
    v_mfma_f32_16x16x32_bf16 v[194:197], a[140:143], a[84:87], v[194:197]
    v_exp_f32 v220, v220
    v_mfma_f32_16x16x32_bf16 v[198:201], a[132:135], a[84:87], 0
    v_min_f32_e64 v18, -v20, -v21
    v_min_f32_e64 v19, -v20, -v21
    v_mfma_f32_16x16x32_bf16 v[198:201], a[142:145], a[84:87], v[198:201]
    s_waitcnt lgkmcnt(3)
    v_exp_f32 v221, v221
    v_mfma_f32_16x16x32_bf16 v[202:205], a[134:137], a[88:91], 0
    buffer_load_dwordx4 v4, s[24:27], s58 offen offset:256 lds
    v_mfma_f32_16x16x32_bf16 v[202:205], a[140:143], a[88:91], v[202:205]
    s_add_u32 m0, s33, 17408
    v_mov_b32 v20, v18
    v_mov_b32 v21, v18
    v_mfma_f32_16x16x32_bf16 v[206:209], a[132:135], a[88:91], 0
    v_exp_f32 v222, v222
    v_mfma_f32_16x16x32_bf16 v[206:209], a[142:145], a[88:91], v[206:209]
    s_waitcnt lgkmcnt(0)
    v_exp_f32 v223, v223
    v_mfma_f32_16x16x32_bf16 v[210:213], a[134:137], a[92:95], 0
    v_exp_f32 v224, v224
    v_mfma_f32_16x16x32_bf16 v[210:213], a[140:143], a[92:95], v[210:213]
    buffer_load_dwordx4 v3, s[20:23], s59 offen offset:0 lds
    v_mfma_f32_16x16x32_bf16 v[214:217], a[132:135], a[92:95], 0
    s_add_u32 m0, s33, 17472
    v_cvt_pk_bf16_f32 v246, v218, v219
    v_cvt_pk_bf16_f32 v247, v220, v221
    v_mfma_f32_16x16x32_bf16 v[214:217], a[142:145], a[92:95], v[214:217]
    v_exp_f32 v225, v225
    v_mfma_f32_16x16x32_bf16 v[226:229], a[156:159], v[58:61], v[18:21]
    v_cvt_pk_bf16_f32 v248, v222, v223
    v_cvt_pk_bf16_f32 v249, v224, v225
    v_mfma_f32_16x16x32_bf16 v[226:229], a[160:163], v[62:65], v[226:229]
    v_cvt_pk_bf16_f32 v74, v186, v187
    v_cvt_pk_bf16_f32 v75, v188, v189
    v_mfma_f32_16x16x32_bf16 v[226:229], a[164:167], v[66:69], v[226:229]
    buffer_load_dwordx4 v3, s[20:23], s59 offen offset:1024 lds
    v_mfma_f32_16x16x32_bf16 v[226:229], a[168:171], v[70:73], v[226:229]
    s_add_u32 m0, s34, 8448
    v_cvt_pk_bf16_f32 v76, v190, v191
    v_cvt_pk_bf16_f32 v77, v192, v193
    v_smfmac_f32_16x16x64_bf16 a[96:99], a[116:119], v[242:249], v7
    v_cvt_pk_bf16_f32 v78, v194, v195
    v_mfma_f32_16x16x32_bf16 v[122:125], a[240:243], v[246:249], v[122:125]
    v_cvt_pk_bf16_f32 v79, v196, v197
    v_cvt_pk_bf16_f32 v80, v198, v199
    v_mfma_f32_16x16x32_bf16 v[126:129], a[244:247], v[246:249], v[126:129]
    v_cvt_pk_bf16_f32 v81, v200, v201
    v_cvt_pk_bf16_f32 v82, v202, v203
    v_mfma_f32_16x16x32_bf16 v[130:133], a[248:251], v[246:249], v[130:133]
    buffer_load_dwordx4 v4, s[24:27], s59 offen offset:0 lds
    v_mfma_f32_16x16x32_bf16 v[134:137], a[252:255], v[246:249], v[134:137]
    s_add_u32 m0, s34, 9248
    v_cvt_pk_bf16_f32 v83, v204, v205
    v_cvt_pk_bf16_f32 v84, v206, v207
    v_mfma_f32_16x16x32_bf16 v[138:141], a[200:203], v[246:249], v[138:141]
    v_cvt_pk_bf16_f32 v85, v208, v209
    v_cvt_pk_bf16_f32 v86, v210, v211
    v_mfma_f32_16x16x32_bf16 v[142:145], a[204:207], v[246:249], v[142:145]
    ds_read_b128 a[188:191], v1 offset:39168
    v_cvt_pk_bf16_f32 v87, v212, v213
    v_mfma_f32_16x16x32_bf16 v[146:149], a[208:211], v[246:249], v[146:149]
    ds_read_b128 a[192:195], v1 offset:39232
    v_cvt_pk_bf16_f32 v88, v214, v215
    v_mfma_f32_16x16x32_bf16 v[150:153], a[212:215], v[246:249], v[150:153]
    buffer_load_dwordx4 v4, s[24:27], s59 offen offset:256 lds
    s_waitcnt vmcnt(10)
    s_barrier
    s_add_u32 m0, s33, 26112
    v_cvt_pk_bf16_f32 v89, v216, v217
    v_add_f32 v154, v154, v18
    v_mfma_f32_16x16x32_bf16 v[186:189], a[172:175], v[74:77], 0
    ds_read_b128 a[196:199], v1 offset:39296
    v_add_f32 v155, v155, v18
    v_mfma_f32_16x16x32_bf16 v[186:189], a[176:179], v[78:81], v[186:189]
    v_exp_f32 v154, v154
    v_mfma_f32_16x16x32_bf16 v[186:189], a[180:183], v[82:85], v[186:189]
    ds_read_b128 a[148:151], v1 offset:39360
    v_add_f32 v156, v156, v18
    v_mfma_f32_16x16x32_bf16 v[186:189], a[184:187], v[86:89], v[186:189]
    v_exp_f32 v155, v155
    v_mfma_f32_16x16x32_bf16 v[230:233], a[172:175], v[26:29], v[10:13]
    v_exp_f32 v156, v156
    v_mfma_f32_16x16x32_bf16 v[230:233], a[176:179], v[30:33], v[230:233]
    buffer_load_dwordx4 v3, s[20:23], s60 offen offset:0 lds
    v_mfma_f32_16x16x32_bf16 v[230:233], a[180:183], v[34:37], v[230:233]
    s_add_u32 m0, s33, 26176
    v_add_f32 v157, v157, v18
    v_exp_f32 v157, v157
    v_mfma_f32_16x16x32_bf16 v[230:233], a[184:187], v[38:41], v[230:233]
    s_waitcnt lgkmcnt(2)
    v_exp_f32 v226, v226
    v_mfma_f32_16x16x32_bf16 v[218:221], a[188:191], v[26:29], v[10:13]
    v_exp_f32 v227, v227
    v_mfma_f32_16x16x32_bf16 v[218:221], a[192:195], v[30:33], v[218:221]
    s_waitcnt lgkmcnt(1)
    v_exp_f32 v228, v228
    v_mfma_f32_16x16x32_bf16 v[218:221], a[196:199], v[34:37], v[218:221]
    s_waitcnt lgkmcnt(0)
    v_cvt_pk_bf16_f32 v234, v154, v155
    v_exp_f32 v229, v229
    v_mfma_f32_16x16x32_bf16 v[218:221], a[148:151], v[38:41], v[218:221]
    buffer_load_dwordx4 v3, s[20:23], s60 offen offset:1024 lds
    v_cvt_pk_bf16_f32 v235, v156, v157
    v_cvt_pk_bf16_f32 v236, v226, v227
    v_cvt_pk_bf16_f32 v237, v228, v229
    s_add_u32 m0, s34, 16896
    s_nop 0
    v_mfma_f32_16x16x32_bf16 a[100:103], a[128:131], v[234:237], a[100:103]
    v_exp_f32 v230, v230
    v_mfma_f32_16x16x32_bf16 a[0:3], a[240:243], v[234:237], 0
    v_exp_f32 v231, v231
    v_mfma_f32_16x16x32_bf16 a[4:7], a[244:247], v[234:237], 0
    ds_read_b64_tr_b16 a[216:217], v2 offset:33792
    ds_read_b64_tr_b16 a[218:219], v2 offset:34304
    v_mfma_f32_16x16x32_bf16 a[8:11], a[248:251], v[234:237], 0
    buffer_load_dwordx4 v4, s[24:27], s60 offen offset:0 lds
    v_mfma_f32_16x16x32_bf16 a[12:15], a[252:255], v[234:237], 0
    s_add_u32 m0, s34, 17696
    v_exp_f32 v232, v232
    v_mfma_f32_16x16x32_bf16 a[16:19], a[200:203], v[234:237], 0
    ds_read_b64_tr_b16 a[220:221], v2 offset:33824
    ds_read_b64_tr_b16 a[222:223], v2 offset:34336
    v_mfma_f32_16x16x32_bf16 a[20:23], a[204:207], v[234:237], 0
    v_exp_f32 v233, v233
    v_mfma_f32_16x16x32_bf16 a[24:27], a[208:211], v[234:237], 0
    ds_read_b64_tr_b16 a[224:225], v2 offset:33856
    ds_read_b64_tr_b16 a[226:227], v2 offset:34368
    v_mfma_f32_16x16x32_bf16 a[28:31], a[212:215], v[234:237], 0
    v_exp_f32 v218, v218
    v_mfma_f32_16x16x32_bf16 v[222:225], a[172:175], v[42:45], v[14:17]
    buffer_load_dwordx4 v4, s[24:27], s60 offen offset:256 lds
    v_mfma_f32_16x16x32_bf16 v[222:225], a[176:179], v[46:49], v[222:225]
    s_add_u32 m0, s3, 0
    ds_read_b64_tr_b16 a[228:229], v2 offset:33888
    ds_read_b64_tr_b16 a[230:231], v2 offset:34400
    v_mfma_f32_16x16x32_bf16 v[222:225], a[180:183], v[50:53], v[222:225]
    v_exp_f32 v219, v219
    v_mfma_f32_16x16x32_bf16 v[222:225], a[184:187], v[54:57], v[222:225]
    ds_read_b64_tr_b16 a[232:233], v2 offset:33920
    ds_read_b64_tr_b16 a[234:235], v2 offset:34432
    v_mfma_f32_16x16x32_bf16 v[226:229], a[188:191], v[42:45], v[14:17]
    v_exp_f32 v220, v220
    v_mfma_f32_16x16x32_bf16 v[226:229], a[192:195], v[46:49], v[226:229]
    ds_read_b64_tr_b16 a[236:237], v2 offset:33952
    ds_read_b64_tr_b16 a[238:239], v2 offset:34464
    v_mfma_f32_16x16x32_bf16 v[226:229], a[196:199], v[50:53], v[226:229]
    ds_read_b64_tr_b16 a[240:241], v2 offset:33984
    ds_read_b64_tr_b16 a[242:243], v2 offset:34496
    v_exp_f32 v221, v221
    v_mfma_f32_16x16x32_bf16 v[226:229], a[148:151], v[54:57], v[226:229]
    s_waitcnt lgkmcnt(8)
    ds_read_b64_tr_b16 a[244:245], v2 offset:34016
    ds_read_b64_tr_b16 a[246:247], v2 offset:34528
    v_cvt_pk_bf16_f32 v242, v230, v231
    v_cvt_pk_bf16_f32 v243, v232, v233
    v_cvt_pk_bf16_f32 v244, v218, v219
    v_cvt_pk_bf16_f32 v245, v220, v221
    v_exp_f32 v222, v222
    s_nop 0
    v_mfma_f32_16x16x32_bf16 v[90:93], a[216:219], v[242:245], v[90:93]
    buffer_load_dwordx4 v5, s[16:19], s44 offen offset:0 nt lds
    v_mfma_f32_16x16x32_bf16 v[94:97], a[220:223], v[242:245], v[94:97]
    s_add_u32 m0, s3, 64
    v_exp_f32 v223, v223
    v_mfma_f32_16x16x32_bf16 v[98:101], a[224:227], v[242:245], v[98:101]
    s_waitcnt lgkmcnt(8)
    v_exp_f32 v224, v224
    v_mfma_f32_16x16x32_bf16 v[102:105], a[228:231], v[242:245], v[102:105]
    s_waitcnt lgkmcnt(6)
    v_exp_f32 v225, v225
    v_mfma_f32_16x16x32_bf16 v[106:109], a[232:235], v[242:245], v[106:109]
    s_waitcnt lgkmcnt(4)
    v_exp_f32 v226, v226
    v_mfma_f32_16x16x32_bf16 v[110:113], a[236:239], v[242:245], v[110:113]
    s_waitcnt lgkmcnt(2)
    v_exp_f32 v227, v227
    v_mfma_f32_16x16x32_bf16 v[114:117], a[240:243], v[242:245], v[114:117]
    s_waitcnt lgkmcnt(0)
    v_exp_f32 v228, v228
    v_mfma_f32_16x16x32_bf16 v[118:121], a[244:247], v[242:245], v[118:121]
    v_cvt_pk_bf16_f32 v246, v222, v223
    v_cvt_pk_bf16_f32 v247, v224, v225
    v_mfma_f32_16x16x32_bf16 v[230:233], a[172:175], v[58:61], v[18:21]
    v_exp_f32 v229, v229
    v_mfma_f32_16x16x32_bf16 v[230:233], a[176:179], v[62:65], v[230:233]
    v_cvt_pk_bf16_f32 v248, v226, v227
    v_cvt_pk_bf16_f32 v249, v228, v229
    v_mfma_f32_16x16x32_bf16 v[230:233], a[180:183], v[66:69], v[230:233]
    buffer_load_dwordx4 v5, s[16:19], s44 offen offset:1024 nt lds
    v_mfma_f32_16x16x32_bf16 v[230:233], a[184:187], v[70:73], v[230:233]
    s_add_u32 m0, s3, 128
    ds_read_b128 a[152:155], v1 offset:43520
    v_max3_f32 v24, v186, v187, v188
    v_mfma_f32_16x16x32_bf16 v[218:221], a[188:191], v[58:61], v[18:21]
    v_max_f32 v22, v24, v189
    v_max_f32 v23, v24, v189
    v_mfma_f32_16x16x32_bf16 v[218:221], a[192:195], v[62:65], v[218:221]
    ds_read_b128 a[156:159], v1 offset:43584
    ds_read_b128 a[160:163], v1 offset:43648
    v_mfma_f32_16x16x32_bf16 v[218:221], a[196:199], v[66:69], v[218:221]
    v_permlane16_swap_b32 v22, v23
    v_mfma_f32_16x16x32_bf16 v[218:221], a[148:151], v[70:73], v[218:221]
    v_max_f32 v24, v22, v23
    v_max_f32 v25, v22, v23
    v_smfmac_f32_16x16x64_bf16 a[96:99], a[116:119], v[242:249], v7
    ds_read_b128 a[164:167], v1 offset:43712
    v_mfma_f32_16x16x32_bf16 v[122:125], a[216:219], v[246:249], v[122:125]
    v_exp_f32 v230, v230
    v_mfma_f32_16x16x32_bf16 v[126:129], a[220:223], v[246:249], v[126:129]
    v_exp_f32 v231, v231
    v_mfma_f32_16x16x32_bf16 v[130:133], a[224:227], v[246:249], v[130:133]
    v_permlane32_swap_b32 v24, v25
    v_mfma_f32_16x16x32_bf16 v[134:137], a[228:231], v[246:249], v[134:137]
    v_exp_f32 v232, v232
    v_mfma_f32_16x16x32_bf16 v[138:141], a[232:235], v[246:249], v[138:141]
    v_min_f32_e64 v22, -v24, -v25
    v_min_f32_e64 v23, -v24, -v25
    v_mfma_f32_16x16x32_bf16 v[142:145], a[236:239], v[246:249], v[142:145]
    v_exp_f32 v233, v233
    v_mfma_f32_16x16x32_bf16 v[146:149], a[240:243], v[246:249], v[146:149]
    v_mov_b32 v24, v22
    v_exp_f32 v218, v218
    v_mfma_f32_16x16x32_bf16 v[150:153], a[244:247], v[246:249], v[150:153]
    buffer_load_dwordx4 v5, s[16:19], s44 offen offset:2048 nt lds
    v_mov_b32 v25, v22
    v_exp_f32 v219, v219
    s_nop 0
    v_mfma_f32_16x16x32_bf16 v[222:225], a[188:191], v[74:77], v[22:25]
    s_add_u32 m0, s3, 192
    v_exp_f32 v220, v220
    v_mfma_f32_16x16x32_bf16 v[222:225], a[192:195], v[78:81], v[222:225]
    v_cvt_pk_bf16_f32 v234, v230, v231
    v_exp_f32 v221, v221
    v_mfma_f32_16x16x32_bf16 v[222:225], a[196:199], v[82:85], v[222:225]
    v_cvt_pk_bf16_f32 v235, v232, v233
    v_cvt_pk_bf16_f32 v236, v218, v219
    v_mfma_f32_16x16x32_bf16 v[222:225], a[148:151], v[86:89], v[222:225]
    ds_read_b128 a[168:171], v1 offset:47872
    v_cvt_pk_bf16_f32 v237, v220, v221
    v_add_f32 v186, v186, v22
    s_nop 0
    v_mfma_f32_16x16x32_bf16 a[0:3], a[216:219], v[234:237], a[0:3]
    ds_read_b128 a[172:175], v1 offset:47936
    ds_read_b128 a[176:179], v1 offset:48000
    v_mfma_f32_16x16x32_bf16 a[4:7], a[220:223], v[234:237], a[4:7]
    v_exp_f32 v186, v186
    v_mfma_f32_16x16x32_bf16 a[8:11], a[224:227], v[234:237], a[8:11]
    ds_read_b128 a[180:183], v1 offset:48064
    v_add_f32 v187, v187, v22
    v_mfma_f32_16x16x32_bf16 a[12:15], a[228:231], v[234:237], a[12:15]
    v_exp_f32 v187, v187
    v_mfma_f32_16x16x32_bf16 a[16:19], a[232:235], v[234:237], a[16:19]
    v_add_f32 v188, v188, v22
    v_add_f32 v189, v189, v22
    v_mfma_f32_16x16x32_bf16 a[20:23], a[236:239], v[234:237], a[20:23]
    buffer_load_dwordx4 v5, s[16:19], s44 offen offset:3072 nt lds
    v_mfma_f32_16x16x32_bf16 a[24:27], a[240:243], v[234:237], a[24:27]
    v_exp_f32 v188, v188
    v_mfma_f32_16x16x32_bf16 a[28:31], a[244:247], v[234:237], a[28:31]
    s_waitcnt lgkmcnt(3)
    v_exp_f32 v189, v189
    v_mfma_f32_16x16x32_bf16 v[226:229], a[152:155], v[26:29], v[10:13]
    v_exp_f32 v222, v222
    v_mfma_f32_16x16x32_bf16 v[226:229], a[156:159], v[30:33], v[226:229]
    v_exp_f32 v223, v223
    v_mfma_f32_16x16x32_bf16 v[226:229], a[160:163], v[34:37], v[226:229]
    v_exp_f32 v224, v224
    v_mfma_f32_16x16x32_bf16 v[226:229], a[164:167], v[38:41], v[226:229]
    v_cvt_pk_bf16_f32 v238, v186, v187
    v_cvt_pk_bf16_f32 v239, v188, v189
    v_mfma_f32_16x16x32_bf16 v[230:233], a[168:171], v[26:29], v[10:13]
    s_waitcnt lgkmcnt(0)
    v_exp_f32 v225, v225
    v_mfma_f32_16x16x32_bf16 v[230:233], a[172:175], v[30:33], v[230:233]
    v_cvt_pk_bf16_f32 v240, v222, v223
    v_cvt_pk_bf16_f32 v241, v224, v225
    v_mfma_f32_16x16x32_bf16 v[230:233], a[176:179], v[34:37], v[230:233]
    v_exp_f32 v226, v226
    v_mfma_f32_16x16x32_bf16 v[230:233], a[180:183], v[38:41], v[230:233]
    v_exp_f32 v227, v227
    v_smfmac_f32_16x16x64_bf16 a[100:103], a[116:119], v[234:241], v7
    ds_read_b64_tr_b16 a[248:249], v2 offset:42240
    v_mfma_f32_16x16x32_bf16 a[32:35], a[216:219], v[238:241], 0
    ds_read_b64_tr_b16 a[250:251], v2 offset:42752
    ds_read_b64_tr_b16 a[252:253], v2 offset:42272
    v_mfma_f32_16x16x32_bf16 a[36:39], a[220:223], v[238:241], 0
    v_exp_f32 v228, v228
    v_mfma_f32_16x16x32_bf16 a[40:43], a[224:227], v[238:241], 0
    ds_read_b64_tr_b16 a[254:255], v2 offset:42784
    ds_read_b64_tr_b16 a[200:201], v2 offset:42304
    v_mfma_f32_16x16x32_bf16 a[44:47], a[228:231], v[238:241], 0
    v_exp_f32 v229, v229
    v_mfma_f32_16x16x32_bf16 a[48:51], a[232:235], v[238:241], 0
    ds_read_b64_tr_b16 a[202:203], v2 offset:42816
    ds_read_b64_tr_b16 a[204:205], v2 offset:42336
    v_mfma_f32_16x16x32_bf16 a[52:55], a[236:239], v[238:241], 0
    v_exp_f32 v230, v230
    v_mfma_f32_16x16x32_bf16 a[56:59], a[240:243], v[238:241], 0
    ds_read_b64_tr_b16 a[206:207], v2 offset:42848
    ds_read_b64_tr_b16 a[208:209], v2 offset:42368
    v_mfma_f32_16x16x32_bf16 a[60:63], a[244:247], v[238:241], 0
    v_exp_f32 v231, v231
    v_mfma_f32_16x16x32_bf16 v[218:221], a[152:155], v[42:45], v[14:17]
    ds_read_b64_tr_b16 a[210:211], v2 offset:42880
    ds_read_b64_tr_b16 a[212:213], v2 offset:42400
    v_mfma_f32_16x16x32_bf16 v[218:221], a[156:159], v[46:49], v[218:221]
    v_exp_f32 v232, v232
    v_mfma_f32_16x16x32_bf16 v[218:221], a[160:163], v[50:53], v[218:221]
    ds_read_b64_tr_b16 a[214:215], v2 offset:42912
    v_cvt_pk_bf16_f32 v242, v226, v227
    v_mfma_f32_16x16x32_bf16 v[218:221], a[164:167], v[54:57], v[218:221]
    ds_read_b64_tr_b16 a[216:217], v2 offset:42432
    v_cvt_pk_bf16_f32 v243, v228, v229
    v_mfma_f32_16x16x32_bf16 v[222:225], a[168:171], v[42:45], v[14:17]
    v_exp_f32 v233, v233
    v_mfma_f32_16x16x32_bf16 v[222:225], a[172:175], v[46:49], v[222:225]
    ds_read_b64_tr_b16 a[218:219], v2 offset:42944
    v_cvt_pk_bf16_f32 v244, v230, v231
    v_mfma_f32_16x16x32_bf16 v[222:225], a[176:179], v[50:53], v[222:225]
    ds_read_b64_tr_b16 a[220:221], v2 offset:42464
    v_cvt_pk_bf16_f32 v245, v232, v233
    v_mfma_f32_16x16x32_bf16 v[222:225], a[180:183], v[54:57], v[222:225]
    s_waitcnt lgkmcnt(6)
    ds_read_b64_tr_b16 a[222:223], v2 offset:42976
    ds_read_b128 a[184:187], v1 offset:52224
    v_mfma_f32_16x16x32_bf16 v[90:93], a[248:251], v[242:245], v[90:93]
    v_exp_f32 v218, v218
    v_mfma_f32_16x16x32_bf16 v[94:97], a[252:255], v[242:245], v[94:97]
    v_exp_f32 v219, v219
    v_mfma_f32_16x16x32_bf16 v[98:101], a[200:203], v[242:245], v[98:101]
    v_exp_f32 v220, v220
    v_mfma_f32_16x16x32_bf16 v[102:105], a[204:207], v[242:245], v[102:105]
    s_waitcnt lgkmcnt(4)
    v_exp_f32 v221, v221
    v_mfma_f32_16x16x32_bf16 v[106:109], a[208:211], v[242:245], v[106:109]
    v_exp_f32 v222, v222
    v_mfma_f32_16x16x32_bf16 v[110:113], a[212:215], v[242:245], v[110:113]
    s_waitcnt lgkmcnt(3)
    v_exp_f32 v223, v223
    v_mfma_f32_16x16x32_bf16 v[114:117], a[216:219], v[242:245], v[114:117]
    s_waitcnt lgkmcnt(1)
    v_exp_f32 v224, v224
    v_mfma_f32_16x16x32_bf16 v[118:121], a[220:223], v[242:245], v[118:121]
    v_cvt_pk_bf16_f32 v246, v218, v219
    v_cvt_pk_bf16_f32 v247, v220, v221
    v_mfma_f32_16x16x32_bf16 v[226:229], a[152:155], v[58:61], v[18:21]
    v_exp_f32 v225, v225
    v_mfma_f32_16x16x32_bf16 v[226:229], a[156:159], v[62:65], v[226:229]
    v_cvt_pk_bf16_f32 v248, v222, v223
    v_cvt_pk_bf16_f32 v249, v224, v225
    v_mfma_f32_16x16x32_bf16 v[226:229], a[160:163], v[66:69], v[226:229]
    ds_read_b128 a[188:191], v1 offset:52288
    ds_read_b128 a[192:195], v1 offset:52352
    v_mfma_f32_16x16x32_bf16 v[226:229], a[164:167], v[70:73], v[226:229]
    ds_read_b128 a[196:199], v1 offset:52416
    ds_read_b128 a[148:151], v1 offset:56576
    v_mfma_f32_16x16x32_bf16 v[230:233], a[168:171], v[58:61], v[18:21]
    ds_read_b64_tr_b16 a[224:225], v2 offset:50688
    ds_read_b64_tr_b16 a[226:227], v2 offset:51200
    v_mfma_f32_16x16x32_bf16 v[230:233], a[172:175], v[62:65], v[230:233]
    ds_read_b64_tr_b16 a[228:229], v2 offset:50720
    ds_read_b64_tr_b16 a[230:231], v2 offset:51232
    v_mfma_f32_16x16x32_bf16 v[230:233], a[176:179], v[66:69], v[230:233]
    v_exp_f32 v226, v226
    v_mfma_f32_16x16x32_bf16 v[230:233], a[180:183], v[70:73], v[230:233]
    v_exp_f32 v227, v227
    v_smfmac_f32_16x16x64_bf16 a[96:99], a[116:119], v[242:249], v7
    v_cvt_pk_bf16_f32 v234, v226, v227
    v_mfma_f32_16x16x32_bf16 v[122:125], a[248:251], v[246:249], v[122:125]
    v_exp_f32 v228, v228
    v_mfma_f32_16x16x32_bf16 v[126:129], a[252:255], v[246:249], v[126:129]
    v_exp_f32 v229, v229
    v_mfma_f32_16x16x32_bf16 v[130:133], a[200:203], v[246:249], v[130:133]
    v_exp_f32 v230, v230
    v_mfma_f32_16x16x32_bf16 v[134:137], a[204:207], v[246:249], v[134:137]
    v_exp_f32 v231, v231
    v_mfma_f32_16x16x32_bf16 v[138:141], a[208:211], v[246:249], v[138:141]
    v_exp_f32 v232, v232
    v_mfma_f32_16x16x32_bf16 v[142:145], a[212:215], v[246:249], v[142:145]
    v_cvt_pk_bf16_f32 v235, v228, v229
    v_cvt_pk_bf16_f32 v236, v230, v231
    v_mfma_f32_16x16x32_bf16 v[146:149], a[216:219], v[246:249], v[146:149]
    v_exp_f32 v233, v233
    v_mfma_f32_16x16x32_bf16 v[150:153], a[220:223], v[246:249], v[150:153]
    ds_read_b64_tr_b16 a[232:233], v2 offset:50752
    v_cvt_pk_bf16_f32 v237, v232, v233
    v_mfma_f32_16x16x32_bf16 v[218:221], a[152:155], v[74:77], v[22:25]
    ds_read_b128 a[152:155], v1 offset:56640
    ds_read_b64_tr_b16 a[234:235], v2 offset:51264
    v_mfma_f32_16x16x32_bf16 v[218:221], a[156:159], v[78:81], v[218:221]
    ds_read_b128 a[156:159], v1 offset:56704
    ds_read_b64_tr_b16 a[236:237], v2 offset:50784
    v_mfma_f32_16x16x32_bf16 v[218:221], a[160:163], v[82:85], v[218:221]
    ds_read_b128 a[160:163], v1 offset:56768
    ds_read_b64_tr_b16 a[238:239], v2 offset:51296
    v_mfma_f32_16x16x32_bf16 v[218:221], a[164:167], v[86:89], v[218:221]
    ds_read_b64_tr_b16 a[240:241], v2 offset:50816
    ds_read_b64_tr_b16 a[242:243], v2 offset:51328
    v_mfma_f32_16x16x32_bf16 v[222:225], a[168:171], v[74:77], v[22:25]
    ds_read_b64_tr_b16 a[244:245], v2 offset:50848
    ds_read_b64_tr_b16 a[246:247], v2 offset:51360
    v_mfma_f32_16x16x32_bf16 v[222:225], a[172:175], v[78:81], v[222:225]
    ds_read_b128 a[164:167], v1 offset:0
    ds_read_b128 a[168:171], v1 offset:64
    v_mfma_f32_16x16x32_bf16 v[222:225], a[176:179], v[82:85], v[222:225]
    v_exp_f32 v218, v218
    v_mfma_f32_16x16x32_bf16 v[222:225], a[180:183], v[86:89], v[222:225]
    v_exp_f32 v219, v219
    v_mfma_f32_16x16x32_bf16 a[0:3], a[248:251], v[234:237], a[0:3]
    v_exp_f32 v220, v220
    v_mfma_f32_16x16x32_bf16 a[4:7], a[252:255], v[234:237], a[4:7]
    v_exp_f32 v221, v221
    v_mfma_f32_16x16x32_bf16 a[8:11], a[200:203], v[234:237], a[8:11]
    v_cvt_pk_bf16_f32 v238, v218, v219
    v_cvt_pk_bf16_f32 v239, v220, v221
    v_mfma_f32_16x16x32_bf16 a[12:15], a[204:207], v[234:237], a[12:15]
    v_exp_f32 v222, v222
    v_mfma_f32_16x16x32_bf16 a[16:19], a[208:211], v[234:237], a[16:19]
    v_exp_f32 v223, v223
    v_mfma_f32_16x16x32_bf16 a[20:23], a[212:215], v[234:237], a[20:23]
    v_exp_f32 v224, v224
    v_mfma_f32_16x16x32_bf16 a[24:27], a[216:219], v[234:237], a[24:27]
    v_exp_f32 v225, v225
    v_mfma_f32_16x16x32_bf16 a[28:31], a[220:223], v[234:237], a[28:31]
    s_waitcnt lgkmcnt(0)
    v_cvt_pk_bf16_f32 v240, v222, v223
    v_cvt_pk_bf16_f32 v241, v224, v225
    v_mfma_f32_16x16x32_bf16 v[226:229], a[184:187], v[26:29], v[10:13]
    ds_read_b128 a[172:175], v1 offset:128
    ds_read_b128 a[176:179], v1 offset:192
    v_mfma_f32_16x16x32_bf16 v[226:229], a[188:191], v[30:33], v[226:229]
    ds_read_b128 a[180:183], v1 offset:4352
    v_mfma_f32_16x16x32_bf16 v[226:229], a[192:195], v[34:37], v[226:229]
    v_mfma_f32_16x16x32_bf16 v[226:229], a[196:199], v[38:41], v[226:229]
    v_mfma_f32_16x16x32_bf16 v[230:233], a[148:151], v[26:29], v[10:13]
    v_mfma_f32_16x16x32_bf16 v[230:233], a[152:155], v[30:33], v[230:233]
    v_mfma_f32_16x16x32_bf16 v[230:233], a[156:159], v[34:37], v[230:233]
    v_mfma_f32_16x16x32_bf16 v[230:233], a[160:163], v[38:41], v[230:233]
    v_smfmac_f32_16x16x64_bf16 a[100:103], a[116:119], v[234:241], v7
    v_mfma_f32_16x16x32_bf16 a[32:35], a[248:251], v[238:241], a[32:35]
    ds_read_b64_tr_b16 a[248:249], v2 offset:50880
    ds_read_b64_tr_b16 a[250:251], v2 offset:51392
    v_mfma_f32_16x16x32_bf16 a[36:39], a[252:255], v[238:241], a[36:39]
    v_exp_f32 v226, v226
    v_mfma_f32_16x16x32_bf16 a[40:43], a[200:203], v[238:241], a[40:43]
    v_exp_f32 v227, v227
    v_mfma_f32_16x16x32_bf16 a[44:47], a[204:207], v[238:241], a[44:47]
    v_exp_f32 v228, v228
    v_mfma_f32_16x16x32_bf16 a[48:51], a[208:211], v[238:241], a[48:51]
    v_exp_f32 v229, v229
    v_mfma_f32_16x16x32_bf16 a[52:55], a[212:215], v[238:241], a[52:55]
    v_exp_f32 v230, v230
    v_mfma_f32_16x16x32_bf16 a[56:59], a[216:219], v[238:241], a[56:59]
    v_exp_f32 v231, v231
    v_mfma_f32_16x16x32_bf16 a[60:63], a[220:223], v[238:241], a[60:63]
    v_exp_f32 v232, v232
    v_mfma_f32_16x16x32_bf16 v[218:221], a[184:187], v[42:45], v[14:17]
    v_cvt_pk_bf16_f32 v242, v226, v227
    v_cvt_pk_bf16_f32 v243, v228, v229
    v_mfma_f32_16x16x32_bf16 v[218:221], a[188:191], v[46:49], v[218:221]
    v_exp_f32 v233, v233
    v_mfma_f32_16x16x32_bf16 v[218:221], a[192:195], v[50:53], v[218:221]
    v_cvt_pk_bf16_f32 v244, v230, v231
    v_cvt_pk_bf16_f32 v245, v232, v233
    v_mfma_f32_16x16x32_bf16 v[218:221], a[196:199], v[54:57], v[218:221]
    ds_read_b64_tr_b16 a[252:253], v2 offset:50912
    ds_read_b64_tr_b16 a[254:255], v2 offset:51424
    v_mfma_f32_16x16x32_bf16 v[222:225], a[148:151], v[42:45], v[14:17]
    v_mfma_f32_16x16x32_bf16 v[222:225], a[152:155], v[46:49], v[222:225]
    v_mfma_f32_16x16x32_bf16 v[222:225], a[156:159], v[50:53], v[222:225]
    v_mfma_f32_16x16x32_bf16 v[222:225], a[160:163], v[54:57], v[222:225]
    v_mfma_f32_16x16x32_bf16 v[90:93], a[224:227], v[242:245], v[90:93]
    v_mfma_f32_16x16x32_bf16 v[94:97], a[228:231], v[242:245], v[94:97]
    v_exp_f32 v218, v218
    v_mfma_f32_16x16x32_bf16 v[98:101], a[232:235], v[242:245], v[98:101]
    v_exp_f32 v219, v219
    v_mfma_f32_16x16x32_bf16 v[102:105], a[236:239], v[242:245], v[102:105]
    v_exp_f32 v220, v220
    v_mfma_f32_16x16x32_bf16 v[106:109], a[240:243], v[242:245], v[106:109]
    v_exp_f32 v221, v221
    v_mfma_f32_16x16x32_bf16 v[110:113], a[244:247], v[242:245], v[110:113]
    s_waitcnt lgkmcnt(0)
    v_exp_f32 v222, v222
    v_mfma_f32_16x16x32_bf16 v[114:117], a[248:251], v[242:245], v[114:117]
    v_exp_f32 v223, v223
    v_mfma_f32_16x16x32_bf16 v[118:121], a[252:255], v[242:245], v[118:121]
    v_exp_f32 v224, v224
    v_mfma_f32_16x16x32_bf16 v[226:229], a[184:187], v[58:61], v[18:21]
    v_cvt_pk_bf16_f32 v246, v218, v219
    v_cvt_pk_bf16_f32 v247, v220, v221
    v_mfma_f32_16x16x32_bf16 v[226:229], a[188:191], v[62:65], v[226:229]
    v_exp_f32 v225, v225
    v_mfma_f32_16x16x32_bf16 v[226:229], a[192:195], v[66:69], v[226:229]
    v_cvt_pk_bf16_f32 v248, v222, v223
    v_cvt_pk_bf16_f32 v249, v224, v225
    v_mfma_f32_16x16x32_bf16 v[226:229], a[196:199], v[70:73], v[226:229]
    v_mfma_f32_16x16x32_bf16 v[230:233], a[148:151], v[58:61], v[18:21]
    v_mfma_f32_16x16x32_bf16 v[230:233], a[152:155], v[62:65], v[230:233]
    v_mfma_f32_16x16x32_bf16 v[230:233], a[156:159], v[66:69], v[230:233]
    v_mfma_f32_16x16x32_bf16 v[230:233], a[160:163], v[70:73], v[230:233]
    v_smfmac_f32_16x16x64_bf16 a[96:99], a[116:119], v[242:249], v7
    v_mfma_f32_16x16x32_bf16 v[122:125], a[224:227], v[246:249], v[122:125]
    v_mfma_f32_16x16x32_bf16 v[126:129], a[228:231], v[246:249], v[126:129]
    v_mfma_f32_16x16x32_bf16 v[130:133], a[232:235], v[246:249], v[130:133]
    v_exp_f32 v226, v226
    v_mfma_f32_16x16x32_bf16 v[134:137], a[236:239], v[246:249], v[134:137]
    v_exp_f32 v227, v227
    v_mfma_f32_16x16x32_bf16 v[138:141], a[240:243], v[246:249], v[138:141]
    v_exp_f32 v228, v228
    v_mfma_f32_16x16x32_bf16 v[142:145], a[244:247], v[246:249], v[142:145]
    v_exp_f32 v229, v229
    v_mfma_f32_16x16x32_bf16 v[146:149], a[248:251], v[246:249], v[146:149]
    v_exp_f32 v230, v230
    v_mfma_f32_16x16x32_bf16 v[150:153], a[252:255], v[246:249], v[150:153]
    v_exp_f32 v231, v231
    v_mfma_f32_16x16x32_bf16 v[218:221], a[184:187], v[74:77], v[22:25]
    v_exp_f32 v232, v232
    v_mfma_f32_16x16x32_bf16 v[218:221], a[188:191], v[78:81], v[218:221]
    v_cvt_pk_bf16_f32 v234, v226, v227
    v_cvt_pk_bf16_f32 v235, v228, v229
    v_mfma_f32_16x16x32_bf16 v[218:221], a[192:195], v[82:85], v[218:221]
    v_exp_f32 v233, v233
    v_mfma_f32_16x16x32_bf16 v[218:221], a[196:199], v[86:89], v[218:221]
    v_cvt_pk_bf16_f32 v236, v230, v231
    v_cvt_pk_bf16_f32 v237, v232, v233
    v_mfma_f32_16x16x32_bf16 v[222:225], a[148:151], v[74:77], v[22:25]
    ds_read_b128 a[184:187], v1 offset:4416
    ds_read_b128 a[188:191], v1 offset:4480
    v_mfma_f32_16x16x32_bf16 v[222:225], a[152:155], v[78:81], v[222:225]
    ds_read_b128 a[192:195], v1 offset:4544
    s_waitcnt vmcnt(0)
    ds_read_b128 a[64:67], v6 offset:0
    v_mfma_f32_16x16x32_bf16 v[222:225], a[156:159], v[82:85], v[222:225]
    v_exp_f32 v218, v218
    v_mfma_f32_16x16x32_bf16 v[222:225], a[160:163], v[86:89], v[222:225]
    v_exp_f32 v219, v219
    v_mfma_f32_16x16x32_bf16 a[0:3], a[224:227], v[234:237], a[0:3]
    v_exp_f32 v220, v220
    v_mfma_f32_16x16x32_bf16 a[4:7], a[228:231], v[234:237], a[4:7]
    v_exp_f32 v221, v221
    v_mfma_f32_16x16x32_bf16 a[8:11], a[232:235], v[234:237], a[8:11]
    v_cvt_pk_bf16_f32 v238, v218, v219
    v_cvt_pk_bf16_f32 v239, v220, v221
    v_mfma_f32_16x16x32_bf16 a[12:15], a[236:239], v[234:237], a[12:15]
    v_exp_f32 v222, v222
    v_mfma_f32_16x16x32_bf16 a[16:19], a[240:243], v[234:237], a[16:19]
    v_exp_f32 v223, v223
    v_mfma_f32_16x16x32_bf16 a[20:23], a[244:247], v[234:237], a[20:23]
    v_exp_f32 v224, v224
    v_mfma_f32_16x16x32_bf16 a[24:27], a[248:251], v[234:237], a[24:27]
    v_exp_f32 v225, v225
    v_mfma_f32_16x16x32_bf16 a[28:31], a[252:255], v[234:237], a[28:31]
    v_cvt_pk_bf16_f32 v240, v222, v223
    v_cvt_pk_bf16_f32 v241, v224, v225
    s_barrier
    s_add_u32 m0, s33, 34816
    ds_read_b64_tr_b16 a[200:201], v2 offset:59136
    ds_read_b64_tr_b16 a[202:203], v2 offset:59648
    v_mfma_f32_16x16x32_bf16 v[226:229], a[164:167], v[26:29], v[10:13]
    ds_read_b64_tr_b16 a[204:205], v2 offset:59168
    ds_read_b64_tr_b16 a[206:207], v2 offset:59680
    v_mfma_f32_16x16x32_bf16 v[226:229], a[168:171], v[30:33], v[226:229]
    buffer_load_dwordx4 v3, s[20:23], s61 offen offset:0 lds
    v_mfma_f32_16x16x32_bf16 v[226:229], a[172:175], v[34:37], v[226:229]
    s_add_u32 m0, s33, 34880
    ds_read_b64_tr_b16 a[208:209], v2 offset:59200
    ds_read_b64_tr_b16 a[210:211], v2 offset:59712
    v_mfma_f32_16x16x32_bf16 v[226:229], a[176:179], v[38:41], v[226:229]
    ds_read_b64_tr_b16 a[212:213], v2 offset:59232
    ds_read_b64_tr_b16 a[214:215], v2 offset:59744
    v_mfma_f32_16x16x32_bf16 v[230:233], a[180:183], v[26:29], v[10:13]
    s_waitcnt lgkmcnt(8)
    ds_read_b64_tr_b16 a[216:217], v2 offset:59264
    ds_read_b64_tr_b16 a[218:219], v2 offset:59776
    v_mfma_f32_16x16x32_bf16 v[230:233], a[184:187], v[30:33], v[230:233]
L_pad2:
    s_cbranch_vccnz L_pad6
    ds_read_b64_tr_b16 a[220:221], v2 offset:59296
    ds_read_b64_tr_b16 a[222:223], v2 offset:59808
    v_mfma_f32_16x16x32_bf16 v[230:233], a[188:191], v[34:37], v[230:233]
    v_exp_f32 v226, v226
    v_mfma_f32_16x16x32_bf16 v[230:233], a[192:195], v[38:41], v[230:233]
    buffer_load_dwordx4 v3, s[20:23], s61 offen offset:1024 lds
    v_smfmac_f32_16x16x64_bf16 a[100:103], a[116:119], v[234:241], v7
    s_add_u32 m0, s34, 25344
    ds_read_b128 a[196:199], v1 offset:8704
    v_mfma_f32_16x16x32_bf16 a[32:35], a[224:227], v[238:241], a[32:35]
    v_exp_f32 v227, v227
    v_mfma_f32_16x16x32_bf16 a[36:39], a[228:231], v[238:241], a[36:39]
    v_exp_f32 v228, v228
    v_mfma_f32_16x16x32_bf16 a[40:43], a[232:235], v[238:241], a[40:43]
    v_exp_f32 v229, v229
    v_mfma_f32_16x16x32_bf16 a[44:47], a[236:239], v[238:241], a[44:47]
    v_exp_f32 v230, v230
    v_mfma_f32_16x16x32_bf16 a[48:51], a[240:243], v[238:241], a[48:51]
    buffer_load_dwordx4 v4, s[24:27], s61 offen offset:0 lds
    v_mfma_f32_16x16x32_bf16 a[52:55], a[244:247], v[238:241], a[52:55]
    s_add_u32 m0, s34, 26144
    v_exp_f32 v231, v231
    v_mfma_f32_16x16x32_bf16 a[56:59], a[248:251], v[238:241], a[56:59]
    v_exp_f32 v232, v232
    v_mfma_f32_16x16x32_bf16 a[60:63], a[252:255], v[238:241], a[60:63]
    v_cvt_pk_bf16_f32 v242, v226, v227
    v_cvt_pk_bf16_f32 v243, v228, v229
    v_mfma_f32_16x16x32_bf16 v[218:221], a[164:167], v[42:45], v[14:17]
    v_exp_f32 v233, v233
    v_mfma_f32_16x16x32_bf16 v[218:221], a[168:171], v[46:49], v[218:221]
    ds_read_b64_tr_b16 a[224:225], v2 offset:59328
    v_cvt_pk_bf16_f32 v244, v230, v231
    v_mfma_f32_16x16x32_bf16 v[218:221], a[172:175], v[50:53], v[218:221]
    buffer_load_dwordx4 v4, s[24:27], s61 offen offset:256 lds
    v_mfma_f32_16x16x32_bf16 v[218:221], a[176:179], v[54:57], v[218:221]
    s_add_u32 m0, s33, 43520
    ds_read_b64_tr_b16 a[226:227], v2 offset:59840
    v_cvt_pk_bf16_f32 v245, v232, v233
    v_mfma_f32_16x16x32_bf16 v[222:225], a[180:183], v[42:45], v[14:17]
    ds_read_b64_tr_b16 a[228:229], v2 offset:59360
    ds_read_b64_tr_b16 a[230:231], v2 offset:59872
    v_mfma_f32_16x16x32_bf16 v[222:225], a[184:187], v[46:49], v[222:225]
    ds_read_b128 a[148:151], v1 offset:8768
    ds_read_b128 a[152:155], v1 offset:8832
    v_mfma_f32_16x16x32_bf16 v[222:225], a[188:191], v[50:53], v[222:225]
    v_exp_f32 v218, v218
    v_mfma_f32_16x16x32_bf16 v[222:225], a[192:195], v[54:57], v[222:225]
    s_waitcnt lgkmcnt(6)
    v_exp_f32 v219, v219
    v_mfma_f32_16x16x32_bf16 v[90:93], a[200:203], v[242:245], v[90:93]
    buffer_load_dwordx4 v3, s[20:23], s62 offen offset:0 lds
    v_mfma_f32_16x16x32_bf16 v[94:97], a[204:207], v[242:245], v[94:97]
    s_add_u32 m0, s33, 43584
    v_exp_f32 v220, v220
    v_mfma_f32_16x16x32_bf16 v[98:101], a[208:211], v[242:245], v[98:101]
    v_exp_f32 v221, v221
    v_mfma_f32_16x16x32_bf16 v[102:105], a[212:215], v[242:245], v[102:105]
    v_exp_f32 v222, v222
    v_mfma_f32_16x16x32_bf16 v[106:109], a[216:219], v[242:245], v[106:109]
    v_exp_f32 v223, v223
    v_mfma_f32_16x16x32_bf16 v[110:113], a[220:223], v[242:245], v[110:113]
    s_waitcnt lgkmcnt(0)
    v_exp_f32 v224, v224
    v_mfma_f32_16x16x32_bf16 v[114:117], a[224:227], v[242:245], v[114:117]
    buffer_load_dwordx4 v3, s[20:23], s62 offen offset:1024 lds
    v_mfma_f32_16x16x32_bf16 v[118:121], a[228:231], v[242:245], v[118:121]
    s_add_u32 m0, s34, 33792
    v_cvt_pk_bf16_f32 v246, v218, v219
    v_cvt_pk_bf16_f32 v247, v220, v221
    v_mfma_f32_16x16x32_bf16 v[226:229], a[164:167], v[58:61], v[18:21]
    v_exp_f32 v225, v225
    v_mfma_f32_16x16x32_bf16 v[226:229], a[168:171], v[62:65], v[226:229]
    v_cvt_pk_bf16_f32 v248, v222, v223
    v_cvt_pk_bf16_f32 v249, v224, v225
    v_mfma_f32_16x16x32_bf16 v[226:229], a[172:175], v[66:69], v[226:229]
    ds_read_b128 a[156:159], v1 offset:8896
    ds_read_b128 a[160:163], v1 offset:13056
    v_mfma_f32_16x16x32_bf16 v[226:229], a[176:179], v[70:73], v[226:229]
    ds_read_b64_tr_b16 a[232:233], v2 offset:0
    ds_read_b64_tr_b16 a[234:235], v2 offset:512
    v_mfma_f32_16x16x32_bf16 v[230:233], a[180:183], v[58:61], v[18:21]
    buffer_load_dwordx4 v4, s[24:27], s62 offen offset:0 lds
    v_mfma_f32_16x16x32_bf16 v[230:233], a[184:187], v[62:65], v[230:233]
    s_add_u32 m0, s34, 34592
    ds_read_b64_tr_b16 a[236:237], v2 offset:32
    ds_read_b64_tr_b16 a[238:239], v2 offset:544
    v_mfma_f32_16x16x32_bf16 v[230:233], a[188:191], v[66:69], v[230:233]
    v_exp_f32 v226, v226
    v_mfma_f32_16x16x32_bf16 v[230:233], a[192:195], v[70:73], v[230:233]
    v_exp_f32 v227, v227
    v_smfmac_f32_16x16x64_bf16 a[96:99], a[116:119], v[242:249], v7
    v_cvt_pk_bf16_f32 v234, v226, v227
    v_mfma_f32_16x16x32_bf16 v[122:125], a[200:203], v[246:249], v[122:125]
    v_exp_f32 v228, v228
    v_mfma_f32_16x16x32_bf16 v[126:129], a[204:207], v[246:249], v[126:129]
    buffer_load_dwordx4 v4, s[24:27], s62 offen offset:256 lds
    v_mfma_f32_16x16x32_bf16 v[130:133], a[208:211], v[246:249], v[130:133]
    s_add_u32 m0, s33, 52224
    v_exp_f32 v229, v229
    v_mfma_f32_16x16x32_bf16 v[134:137], a[212:215], v[246:249], v[134:137]
    v_exp_f32 v230, v230
    v_mfma_f32_16x16x32_bf16 v[138:141], a[216:219], v[246:249], v[138:141]
    v_exp_f32 v231, v231
    v_mfma_f32_16x16x32_bf16 v[142:145], a[220:223], v[246:249], v[142:145]
    v_exp_f32 v232, v232
    v_mfma_f32_16x16x32_bf16 v[146:149], a[224:227], v[246:249], v[146:149]
    v_cvt_pk_bf16_f32 v235, v228, v229
    v_cvt_pk_bf16_f32 v236, v230, v231
    v_mfma_f32_16x16x32_bf16 v[150:153], a[228:231], v[246:249], v[150:153]
    buffer_load_dwordx4 v3, s[20:23], s63 offen offset:0 lds
    v_mfma_f32_16x16x32_bf16 v[218:221], a[164:167], v[74:77], v[22:25]
    s_add_u32 m0, s33, 52288
    v_exp_f32 v233, v233
    v_mfma_f32_16x16x32_bf16 v[218:221], a[168:171], v[78:81], v[218:221]
    ds_read_b128 a[164:167], v1 offset:13120
    v_cvt_pk_bf16_f32 v237, v232, v233
    v_mfma_f32_16x16x32_bf16 v[218:221], a[172:175], v[82:85], v[218:221]
    ds_read_b128 a[168:171], v1 offset:13184
    ds_read_b128 a[172:175], v1 offset:13248
    v_mfma_f32_16x16x32_bf16 v[218:221], a[176:179], v[86:89], v[218:221]
    ds_read_b64_tr_b16 a[240:241], v2 offset:64
    ds_read_b64_tr_b16 a[242:243], v2 offset:576
    v_mfma_f32_16x16x32_bf16 v[222:225], a[180:183], v[74:77], v[22:25]
    ds_read_b64_tr_b16 a[244:245], v2 offset:96
    ds_read_b64_tr_b16 a[246:247], v2 offset:608
    v_mfma_f32_16x16x32_bf16 v[222:225], a[184:187], v[78:81], v[222:225]
    buffer_load_dwordx4 v3, s[20:23], s63 offen offset:1024 lds
    v_mfma_f32_16x16x32_bf16 v[222:225], a[188:191], v[82:85], v[222:225]
    s_add_u32 m0, s34, 42240
    v_exp_f32 v218, v218
    v_mfma_f32_16x16x32_bf16 v[222:225], a[192:195], v[86:89], v[222:225]
    v_exp_f32 v219, v219
    v_mfma_f32_16x16x32_bf16 a[0:3], a[200:203], v[234:237], a[0:3]
    v_exp_f32 v220, v220
    v_mfma_f32_16x16x32_bf16 a[4:7], a[204:207], v[234:237], a[4:7]
    v_exp_f32 v221, v221
    v_mfma_f32_16x16x32_bf16 a[8:11], a[208:211], v[234:237], a[8:11]
    v_cvt_pk_bf16_f32 v238, v218, v219
    v_cvt_pk_bf16_f32 v239, v220, v221
    v_mfma_f32_16x16x32_bf16 a[12:15], a[212:215], v[234:237], a[12:15]
    buffer_load_dwordx4 v4, s[24:27], s63 offen offset:0 lds
    v_mfma_f32_16x16x32_bf16 a[16:19], a[216:219], v[234:237], a[16:19]
    s_add_u32 m0, s34, 43040
    v_exp_f32 v222, v222
    v_mfma_f32_16x16x32_bf16 a[20:23], a[220:223], v[234:237], a[20:23]
    v_exp_f32 v223, v223
    v_mfma_f32_16x16x32_bf16 a[24:27], a[224:227], v[234:237], a[24:27]
    v_exp_f32 v224, v224
    v_mfma_f32_16x16x32_bf16 a[28:31], a[228:231], v[234:237], a[28:31]
    v_exp_f32 v225, v225
    v_mfma_f32_16x16x32_bf16 v[226:229], a[196:199], v[26:29], v[10:13]
    v_cvt_pk_bf16_f32 v240, v222, v223
    v_cvt_pk_bf16_f32 v241, v224, v225
    v_mfma_f32_16x16x32_bf16 v[226:229], a[148:151], v[30:33], v[226:229]
    buffer_load_dwordx4 v4, s[24:27], s63 offen offset:256 lds
    v_mfma_f32_16x16x32_bf16 v[226:229], a[152:155], v[34:37], v[226:229]
    s_waitcnt lgkmcnt(0)
    ds_read_b64_tr_b16 a[248:249], v2 offset:128
    ds_read_b64_tr_b16 a[250:251], v2 offset:640
    v_mfma_f32_16x16x32_bf16 v[226:229], a[156:159], v[38:41], v[226:229]
    s_add_u32 m0, s3, 4352
    ds_read_b64_tr_b16 a[252:253], v2 offset:160
    ds_read_b64_tr_b16 a[254:255], v2 offset:672
    v_mfma_f32_16x16x32_bf16 v[230:233], a[160:163], v[26:29], v[10:13]
    ds_read_b128 a[176:179], v1 offset:17408
    ds_read_b128 a[180:183], v1 offset:17472
    v_mfma_f32_16x16x32_bf16 v[230:233], a[164:167], v[30:33], v[230:233]
    ds_read_b128 a[184:187], v1 offset:17536
    ds_read_b128 a[188:191], v1 offset:17600
    v_mfma_f32_16x16x32_bf16 v[230:233], a[168:171], v[34:37], v[230:233]
    v_exp_f32 v226, v226
    v_mfma_f32_16x16x32_bf16 v[230:233], a[172:175], v[38:41], v[230:233]
    buffer_load_dwordx4 v5, s[16:19], s45 offen offset:0 nt lds
    v_smfmac_f32_16x16x64_bf16 a[100:103], a[116:119], v[234:241], v7
    s_add_u32 m0, s3, 4416
    ds_read_b128 a[192:195], v1 offset:21760
    v_mfma_f32_16x16x32_bf16 a[32:35], a[200:203], v[238:241], a[32:35]
    v_exp_f32 v227, v227
    v_mfma_f32_16x16x32_bf16 a[36:39], a[204:207], v[238:241], a[36:39]
    v_exp_f32 v228, v228
    v_mfma_f32_16x16x32_bf16 a[40:43], a[208:211], v[238:241], a[40:43]
    v_exp_f32 v229, v229
    v_mfma_f32_16x16x32_bf16 a[44:47], a[212:215], v[238:241], a[44:47]
    v_exp_f32 v230, v230
    v_mfma_f32_16x16x32_bf16 a[48:51], a[216:219], v[238:241], a[48:51]
    v_exp_f32 v231, v231
    v_mfma_f32_16x16x32_bf16 a[52:55], a[220:223], v[238:241], a[52:55]
    v_exp_f32 v232, v232
    v_mfma_f32_16x16x32_bf16 a[56:59], a[224:227], v[238:241], a[56:59]
    v_cvt_pk_bf16_f32 v242, v226, v227
    v_cvt_pk_bf16_f32 v243, v228, v229
    v_mfma_f32_16x16x32_bf16 a[60:63], a[228:231], v[238:241], a[60:63]
    v_exp_f32 v233, v233
    v_mfma_f32_16x16x32_bf16 v[218:221], a[196:199], v[42:45], v[14:17]
    ds_read_b64_tr_b16 a[200:201], v2 offset:192
    v_cvt_pk_bf16_f32 v244, v230, v231
    v_mfma_f32_16x16x32_bf16 v[218:221], a[148:151], v[46:49], v[218:221]
    ds_read_b64_tr_b16 a[202:203], v2 offset:704
    v_cvt_pk_bf16_f32 v245, v232, v233
    v_mfma_f32_16x16x32_bf16 v[218:221], a[152:155], v[50:53], v[218:221]
    buffer_load_dwordx4 v5, s[16:19], s45 offen offset:1024 nt lds
    v_mfma_f32_16x16x32_bf16 v[218:221], a[156:159], v[54:57], v[218:221]
    s_add_u32 m0, s3, 4480
    ds_read_b64_tr_b16 a[204:205], v2 offset:224
    ds_read_b64_tr_b16 a[206:207], v2 offset:736
    v_mfma_f32_16x16x32_bf16 v[222:225], a[160:163], v[42:45], v[14:17]
    ds_read_b64_tr_b16 a[208:209], v2 offset:8448
    ds_read_b64_tr_b16 a[210:211], v2 offset:8960
    v_mfma_f32_16x16x32_bf16 v[222:225], a[164:167], v[46:49], v[222:225]
    ds_read_b64_tr_b16 a[212:213], v2 offset:8480
    ds_read_b64_tr_b16 a[214:215], v2 offset:8992
    v_mfma_f32_16x16x32_bf16 v[222:225], a[168:171], v[50:53], v[222:225]
    v_exp_f32 v218, v218
    v_mfma_f32_16x16x32_bf16 v[222:225], a[172:175], v[54:57], v[222:225]
    v_exp_f32 v219, v219
    v_mfma_f32_16x16x32_bf16 v[90:93], a[232:235], v[242:245], v[90:93]
    v_exp_f32 v220, v220
    v_mfma_f32_16x16x32_bf16 v[94:97], a[236:239], v[242:245], v[94:97]
    v_exp_f32 v221, v221
    v_mfma_f32_16x16x32_bf16 v[98:101], a[240:243], v[242:245], v[98:101]
    v_cvt_pk_bf16_f32 v246, v218, v219
    v_cvt_pk_bf16_f32 v247, v220, v221
    v_mfma_f32_16x16x32_bf16 v[102:105], a[244:247], v[242:245], v[102:105]
    s_waitcnt lgkmcnt(4)
    v_exp_f32 v222, v222
    v_mfma_f32_16x16x32_bf16 v[106:109], a[248:251], v[242:245], v[106:109]
    v_exp_f32 v223, v223
    v_mfma_f32_16x16x32_bf16 v[110:113], a[252:255], v[242:245], v[110:113]
    v_exp_f32 v224, v224
    v_mfma_f32_16x16x32_bf16 v[114:117], a[200:203], v[242:245], v[114:117]
    buffer_load_dwordx4 v5, s[16:19], s45 offen offset:2048 nt lds
    v_mfma_f32_16x16x32_bf16 v[118:121], a[204:207], v[242:245], v[118:121]
    s_add_u32 m0, s3, 4544
    v_exp_f32 v225, v225
    v_mfma_f32_16x16x32_bf16 v[226:229], a[196:199], v[58:61], v[18:21]
    v_cvt_pk_bf16_f32 v248, v222, v223
    v_cvt_pk_bf16_f32 v249, v224, v225
    v_mfma_f32_16x16x32_bf16 v[226:229], a[148:151], v[62:65], v[226:229]
    ds_read_b64_tr_b16 a[216:217], v2 offset:8512
    ds_read_b64_tr_b16 a[218:219], v2 offset:9024
    v_mfma_f32_16x16x32_bf16 v[226:229], a[152:155], v[66:69], v[226:229]
    ds_read_b64_tr_b16 a[220:221], v2 offset:8544
    ds_read_b64_tr_b16 a[222:223], v2 offset:9056
    v_mfma_f32_16x16x32_bf16 v[226:229], a[156:159], v[70:73], v[226:229]
    ds_read_b64_tr_b16 a[224:225], v2 offset:8576
    ds_read_b64_tr_b16 a[226:227], v2 offset:9088
    v_mfma_f32_16x16x32_bf16 v[230:233], a[160:163], v[58:61], v[18:21]
    ds_read_b64_tr_b16 a[228:229], v2 offset:8608
    ds_read_b64_tr_b16 a[230:231], v2 offset:9120
    v_mfma_f32_16x16x32_bf16 v[230:233], a[164:167], v[62:65], v[230:233]
    ds_read_b128 a[68:71], v6 offset:64
    ds_read_b128 a[72:75], v6 offset:128
    v_mfma_f32_16x16x32_bf16 v[230:233], a[168:171], v[66:69], v[230:233]
    v_exp_f32 v226, v226
    v_mfma_f32_16x16x32_bf16 v[230:233], a[172:175], v[70:73], v[230:233]
    v_exp_f32 v227, v227
    v_smfmac_f32_16x16x64_bf16 a[96:99], a[116:119], v[242:249], v7
    v_cvt_pk_bf16_f32 v234, v226, v227
    v_mfma_f32_16x16x32_bf16 v[122:125], a[232:235], v[246:249], v[122:125]
    v_exp_f32 v228, v228
    v_mfma_f32_16x16x32_bf16 v[126:129], a[236:239], v[246:249], v[126:129]
    buffer_load_dwordx4 v5, s[16:19], s45 offen offset:3072 nt lds
    v_mfma_f32_16x16x32_bf16 v[130:133], a[240:243], v[246:249], v[130:133]
    v_exp_f32 v229, v229
    v_mfma_f32_16x16x32_bf16 v[134:137], a[244:247], v[246:249], v[134:137]
    v_exp_f32 v230, v230
    v_mfma_f32_16x16x32_bf16 v[138:141], a[248:251], v[246:249], v[138:141]
    v_exp_f32 v231, v231
    v_mfma_f32_16x16x32_bf16 v[142:145], a[252:255], v[246:249], v[142:145]
    v_exp_f32 v232, v232
    v_mfma_f32_16x16x32_bf16 v[146:149], a[200:203], v[246:249], v[146:149]
    v_cvt_pk_bf16_f32 v235, v228, v229
    v_cvt_pk_bf16_f32 v236, v230, v231
    v_mfma_f32_16x16x32_bf16 v[150:153], a[204:207], v[246:249], v[150:153]
    v_exp_f32 v233, v233
    v_mfma_f32_16x16x32_bf16 v[218:221], a[196:199], v[74:77], v[22:25]
    ds_read_b128 a[196:199], v1 offset:21824
    v_cvt_pk_bf16_f32 v237, v232, v233
    v_mfma_f32_16x16x32_bf16 v[218:221], a[148:151], v[78:81], v[218:221]
    ds_read_b128 a[148:151], v1 offset:21888
    ds_read_b128 a[76:79], v6 offset:192
    v_mfma_f32_16x16x32_bf16 v[218:221], a[152:155], v[82:85], v[218:221]
    ds_read_b128 a[152:155], v1 offset:21952
    v_mfma_f32_16x16x32_bf16 v[218:221], a[156:159], v[86:89], v[218:221]
    ds_read_b128 a[156:159], v1 offset:26112
    v_mfma_f32_16x16x32_bf16 v[222:225], a[160:163], v[74:77], v[22:25]
    ds_read_b128 a[160:163], v1 offset:26176
    v_mfma_f32_16x16x32_bf16 v[222:225], a[164:167], v[78:81], v[222:225]
    ds_read_b128 a[164:167], v1 offset:26240
    v_mfma_f32_16x16x32_bf16 v[222:225], a[168:171], v[82:85], v[222:225]
    ds_read_b128 a[168:171], v1 offset:26304
    v_mfma_f32_16x16x32_bf16 v[222:225], a[172:175], v[86:89], v[222:225]
    v_exp_f32 v218, v218
    v_mfma_f32_16x16x32_bf16 a[0:3], a[232:235], v[234:237], a[0:3]
    v_exp_f32 v219, v219
    v_mfma_f32_16x16x32_bf16 a[4:7], a[236:239], v[234:237], a[4:7]
    v_exp_f32 v220, v220
    v_mfma_f32_16x16x32_bf16 a[8:11], a[240:243], v[234:237], a[8:11]
    v_exp_f32 v221, v221
    v_mfma_f32_16x16x32_bf16 a[12:15], a[244:247], v[234:237], a[12:15]
    v_exp_f32 v222, v222
    v_mfma_f32_16x16x32_bf16 a[16:19], a[248:251], v[234:237], a[16:19]
    v_exp_f32 v223, v223
    v_mfma_f32_16x16x32_bf16 a[20:23], a[252:255], v[234:237], a[20:23]
    v_exp_f32 v224, v224
    v_mfma_f32_16x16x32_bf16 a[24:27], a[200:203], v[234:237], a[24:27]
    v_cvt_pk_bf16_f32 v238, v218, v219
    v_cvt_pk_bf16_f32 v239, v220, v221
    v_mfma_f32_16x16x32_bf16 a[28:31], a[204:207], v[234:237], a[28:31]
    v_exp_f32 v225, v225
    v_mfma_f32_16x16x32_bf16 v[226:229], a[176:179], v[26:29], v[10:13]
    v_cvt_pk_bf16_f32 v240, v222, v223
    v_cvt_pk_bf16_f32 v241, v224, v225
    v_mfma_f32_16x16x32_bf16 v[226:229], a[180:183], v[30:33], v[226:229]
    ds_read_b128 a[172:175], v1 offset:30464
    v_mfma_f32_16x16x32_bf16 v[226:229], a[184:187], v[34:37], v[226:229]
    v_mfma_f32_16x16x32_bf16 v[226:229], a[188:191], v[38:41], v[226:229]
    v_mfma_f32_16x16x32_bf16 v[230:233], a[192:195], v[26:29], v[10:13]
    s_waitcnt lgkmcnt(1)
    v_mfma_f32_16x16x32_bf16 v[230:233], a[196:199], v[30:33], v[230:233]
    v_mfma_f32_16x16x32_bf16 v[230:233], a[148:151], v[34:37], v[230:233]
    v_mfma_f32_16x16x32_bf16 v[230:233], a[152:155], v[38:41], v[230:233]
    v_smfmac_f32_16x16x64_bf16 a[100:103], a[116:119], v[234:241], v7
    v_mfma_f32_16x16x32_bf16 a[32:35], a[232:235], v[238:241], a[32:35]
    ds_read_b64_tr_b16 a[232:233], v2 offset:8640
    ds_read_b64_tr_b16 a[234:235], v2 offset:9152
    v_mfma_f32_16x16x32_bf16 a[36:39], a[236:239], v[238:241], a[36:39]
    v_exp_f32 v226, v226
    v_mfma_f32_16x16x32_bf16 a[40:43], a[240:243], v[238:241], a[40:43]
    v_exp_f32 v227, v227
    v_mfma_f32_16x16x32_bf16 a[44:47], a[244:247], v[238:241], a[44:47]
    v_exp_f32 v228, v228
    v_mfma_f32_16x16x32_bf16 a[48:51], a[248:251], v[238:241], a[48:51]
    v_exp_f32 v229, v229
    v_mfma_f32_16x16x32_bf16 a[52:55], a[252:255], v[238:241], a[52:55]
    v_exp_f32 v230, v230
    v_mfma_f32_16x16x32_bf16 a[56:59], a[200:203], v[238:241], a[56:59]
    v_exp_f32 v231, v231
    v_mfma_f32_16x16x32_bf16 a[60:63], a[204:207], v[238:241], a[60:63]
    v_exp_f32 v232, v232
    v_mfma_f32_16x16x32_bf16 v[218:221], a[176:179], v[42:45], v[14:17]
    v_cvt_pk_bf16_f32 v242, v226, v227
    v_cvt_pk_bf16_f32 v243, v228, v229
    v_mfma_f32_16x16x32_bf16 v[218:221], a[180:183], v[46:49], v[218:221]
    v_exp_f32 v233, v233
    v_mfma_f32_16x16x32_bf16 v[218:221], a[184:187], v[50:53], v[218:221]
    v_cvt_pk_bf16_f32 v244, v230, v231
    v_cvt_pk_bf16_f32 v245, v232, v233
    v_mfma_f32_16x16x32_bf16 v[218:221], a[188:191], v[54:57], v[218:221]
    ds_read_b64_tr_b16 a[236:237], v2 offset:8672
    ds_read_b64_tr_b16 a[238:239], v2 offset:9184
    v_mfma_f32_16x16x32_bf16 v[222:225], a[192:195], v[42:45], v[14:17]
    v_mfma_f32_16x16x32_bf16 v[222:225], a[196:199], v[46:49], v[222:225]
    v_mfma_f32_16x16x32_bf16 v[222:225], a[148:151], v[50:53], v[222:225]
    v_mfma_f32_16x16x32_bf16 v[222:225], a[152:155], v[54:57], v[222:225]
    v_mfma_f32_16x16x32_bf16 v[90:93], a[208:211], v[242:245], v[90:93]
    v_mfma_f32_16x16x32_bf16 v[94:97], a[212:215], v[242:245], v[94:97]
    v_exp_f32 v218, v218
    v_mfma_f32_16x16x32_bf16 v[98:101], a[216:219], v[242:245], v[98:101]
    v_exp_f32 v219, v219
    v_mfma_f32_16x16x32_bf16 v[102:105], a[220:223], v[242:245], v[102:105]
    v_exp_f32 v220, v220
    v_mfma_f32_16x16x32_bf16 v[106:109], a[224:227], v[242:245], v[106:109]
    v_exp_f32 v221, v221
    v_mfma_f32_16x16x32_bf16 v[110:113], a[228:231], v[242:245], v[110:113]
    s_waitcnt lgkmcnt(0)
    v_exp_f32 v222, v222
    v_mfma_f32_16x16x32_bf16 v[114:117], a[232:235], v[242:245], v[114:117]
    v_exp_f32 v223, v223
    v_mfma_f32_16x16x32_bf16 v[118:121], a[236:239], v[242:245], v[118:121]
    v_exp_f32 v224, v224
    v_mfma_f32_16x16x32_bf16 v[226:229], a[176:179], v[58:61], v[18:21]
    v_cvt_pk_bf16_f32 v246, v218, v219
    v_cvt_pk_bf16_f32 v247, v220, v221
    v_mfma_f32_16x16x32_bf16 v[226:229], a[180:183], v[62:65], v[226:229]
    v_exp_f32 v225, v225
    v_mfma_f32_16x16x32_bf16 v[226:229], a[184:187], v[66:69], v[226:229]
    v_cvt_pk_bf16_f32 v248, v222, v223
    v_cvt_pk_bf16_f32 v249, v224, v225
    v_mfma_f32_16x16x32_bf16 v[226:229], a[188:191], v[70:73], v[226:229]
    v_mfma_f32_16x16x32_bf16 v[230:233], a[192:195], v[58:61], v[18:21]
    v_mfma_f32_16x16x32_bf16 v[230:233], a[196:199], v[62:65], v[230:233]
    v_mfma_f32_16x16x32_bf16 v[230:233], a[148:151], v[66:69], v[230:233]
    v_mfma_f32_16x16x32_bf16 v[230:233], a[152:155], v[70:73], v[230:233]
    v_smfmac_f32_16x16x64_bf16 a[96:99], a[116:119], v[242:249], v7
    v_mfma_f32_16x16x32_bf16 v[122:125], a[208:211], v[246:249], v[122:125]
    v_mfma_f32_16x16x32_bf16 v[126:129], a[212:215], v[246:249], v[126:129]
    v_mfma_f32_16x16x32_bf16 v[130:133], a[216:219], v[246:249], v[130:133]
    v_exp_f32 v226, v226
    v_mfma_f32_16x16x32_bf16 v[134:137], a[220:223], v[246:249], v[134:137]
    v_exp_f32 v227, v227
    v_mfma_f32_16x16x32_bf16 v[138:141], a[224:227], v[246:249], v[138:141]
    v_exp_f32 v228, v228
    v_mfma_f32_16x16x32_bf16 v[142:145], a[228:231], v[246:249], v[142:145]
    v_exp_f32 v229, v229
    v_mfma_f32_16x16x32_bf16 v[146:149], a[232:235], v[246:249], v[146:149]
    v_exp_f32 v230, v230
    v_mfma_f32_16x16x32_bf16 v[150:153], a[236:239], v[246:249], v[150:153]
    v_exp_f32 v231, v231
    v_mfma_f32_16x16x32_bf16 v[218:221], a[176:179], v[74:77], v[22:25]
    v_exp_f32 v232, v232
    v_mfma_f32_16x16x32_bf16 v[218:221], a[180:183], v[78:81], v[218:221]
    v_cvt_pk_bf16_f32 v234, v226, v227
    v_cvt_pk_bf16_f32 v235, v228, v229
    v_mfma_f32_16x16x32_bf16 v[218:221], a[184:187], v[82:85], v[218:221]
    v_exp_f32 v233, v233
    v_mfma_f32_16x16x32_bf16 v[218:221], a[188:191], v[86:89], v[218:221]
    v_cvt_pk_bf16_f32 v236, v230, v231
    v_cvt_pk_bf16_f32 v237, v232, v233
    v_mfma_f32_16x16x32_bf16 v[222:225], a[192:195], v[74:77], v[22:25]
    ds_read_b128 a[176:179], v1 offset:30528
    ds_read_b128 a[180:183], v1 offset:30592
    v_mfma_f32_16x16x32_bf16 v[222:225], a[196:199], v[78:81], v[222:225]
    ds_read_b128 a[184:187], v1 offset:30656
    v_mfma_f32_16x16x32_bf16 v[222:225], a[148:151], v[82:85], v[222:225]
    v_exp_f32 v218, v218
    v_mfma_f32_16x16x32_bf16 v[222:225], a[152:155], v[86:89], v[222:225]
    v_exp_f32 v219, v219
    v_mfma_f32_16x16x32_bf16 a[0:3], a[208:211], v[234:237], a[0:3]
    v_exp_f32 v220, v220
    v_mfma_f32_16x16x32_bf16 a[4:7], a[212:215], v[234:237], a[4:7]
    v_exp_f32 v221, v221
    v_mfma_f32_16x16x32_bf16 a[8:11], a[216:219], v[234:237], a[8:11]
    v_cvt_pk_bf16_f32 v238, v218, v219
    v_cvt_pk_bf16_f32 v239, v220, v221
    v_mfma_f32_16x16x32_bf16 a[12:15], a[220:223], v[234:237], a[12:15]
    v_exp_f32 v222, v222
    v_mfma_f32_16x16x32_bf16 a[16:19], a[224:227], v[234:237], a[16:19]
    v_exp_f32 v223, v223
    v_mfma_f32_16x16x32_bf16 a[20:23], a[228:231], v[234:237], a[20:23]
    v_exp_f32 v224, v224
    v_mfma_f32_16x16x32_bf16 a[24:27], a[232:235], v[234:237], a[24:27]
    v_exp_f32 v225, v225
    v_mfma_f32_16x16x32_bf16 a[28:31], a[236:239], v[234:237], a[28:31]
    v_cvt_pk_bf16_f32 v240, v222, v223
    v_cvt_pk_bf16_f32 v241, v224, v225
    s_waitcnt vmcnt(6)
    s_barrier
    s_add_u32 m0, s33, 0
    ds_read_b64_tr_b16 a[240:241], v2 offset:16896
    ds_read_b64_tr_b16 a[242:243], v2 offset:17408
    v_mfma_f32_16x16x32_bf16 v[226:229], a[156:159], v[26:29], v[10:13]
    ds_read_b64_tr_b16 a[244:245], v2 offset:16928
    ds_read_b64_tr_b16 a[246:247], v2 offset:17440
    v_mfma_f32_16x16x32_bf16 v[226:229], a[160:163], v[30:33], v[226:229]
    buffer_load_dwordx4 v3, s[20:23], s64 offen offset:0 lds
    v_mfma_f32_16x16x32_bf16 v[226:229], a[164:167], v[34:37], v[226:229]
    s_add_u32 m0, s33, 64
    ds_read_b64_tr_b16 a[248:249], v2 offset:16960
    ds_read_b64_tr_b16 a[250:251], v2 offset:17472
    v_mfma_f32_16x16x32_bf16 v[226:229], a[168:171], v[38:41], v[226:229]
    ds_read_b64_tr_b16 a[252:253], v2 offset:16992
    ds_read_b64_tr_b16 a[254:255], v2 offset:17504
    v_mfma_f32_16x16x32_bf16 v[230:233], a[172:175], v[26:29], v[10:13]
    s_waitcnt lgkmcnt(8)
    ds_read_b64_tr_b16 a[200:201], v2 offset:17024
    ds_read_b64_tr_b16 a[202:203], v2 offset:17536
    v_mfma_f32_16x16x32_bf16 v[230:233], a[176:179], v[30:33], v[230:233]
    ds_read_b64_tr_b16 a[204:205], v2 offset:17056
    ds_read_b64_tr_b16 a[206:207], v2 offset:17568
    v_mfma_f32_16x16x32_bf16 v[230:233], a[180:183], v[34:37], v[230:233]
    v_exp_f32 v226, v226
    v_mfma_f32_16x16x32_bf16 v[230:233], a[184:187], v[38:41], v[230:233]
    buffer_load_dwordx4 v3, s[20:23], s64 offen offset:1024 lds
    v_smfmac_f32_16x16x64_bf16 a[100:103], a[116:119], v[234:241], v7
    s_add_u32 m0, s34, 50688
    ds_read_b128 a[188:191], v1 offset:34816
    v_mfma_f32_16x16x32_bf16 a[32:35], a[208:211], v[238:241], a[32:35]
    v_exp_f32 v227, v227
    v_mfma_f32_16x16x32_bf16 a[36:39], a[212:215], v[238:241], a[36:39]
    v_exp_f32 v228, v228
    v_mfma_f32_16x16x32_bf16 a[40:43], a[216:219], v[238:241], a[40:43]
    v_exp_f32 v229, v229
    v_mfma_f32_16x16x32_bf16 a[44:47], a[220:223], v[238:241], a[44:47]
    v_exp_f32 v230, v230
    v_mfma_f32_16x16x32_bf16 a[48:51], a[224:227], v[238:241], a[48:51]
    buffer_load_dwordx4 v4, s[24:27], s64 offen offset:0 lds
    v_mfma_f32_16x16x32_bf16 a[52:55], a[228:231], v[238:241], a[52:55]
    s_add_u32 m0, s34, 51488
    v_exp_f32 v231, v231
    v_mfma_f32_16x16x32_bf16 a[56:59], a[232:235], v[238:241], a[56:59]
    v_exp_f32 v232, v232
    v_mfma_f32_16x16x32_bf16 a[60:63], a[236:239], v[238:241], a[60:63]
    v_cvt_pk_bf16_f32 v242, v226, v227
    v_cvt_pk_bf16_f32 v243, v228, v229
    v_mfma_f32_16x16x32_bf16 v[218:221], a[156:159], v[42:45], v[14:17]
    v_exp_f32 v233, v233
    v_mfma_f32_16x16x32_bf16 v[218:221], a[160:163], v[46:49], v[218:221]
    ds_read_b64_tr_b16 a[208:209], v2 offset:17088
    v_cvt_pk_bf16_f32 v244, v230, v231
    v_mfma_f32_16x16x32_bf16 v[218:221], a[164:167], v[50:53], v[218:221]
    buffer_load_dwordx4 v4, s[24:27], s64 offen offset:256 lds
    v_mfma_f32_16x16x32_bf16 v[218:221], a[168:171], v[54:57], v[218:221]
    s_add_u32 m0, s33, 8704
    ds_read_b64_tr_b16 a[210:211], v2 offset:17600
    v_cvt_pk_bf16_f32 v245, v232, v233
    v_mfma_f32_16x16x32_bf16 v[222:225], a[172:175], v[42:45], v[14:17]
    ds_read_b64_tr_b16 a[212:213], v2 offset:17120
    ds_read_b64_tr_b16 a[214:215], v2 offset:17632
    v_mfma_f32_16x16x32_bf16 v[222:225], a[176:179], v[46:49], v[222:225]
    ds_read_b128 a[192:195], v1 offset:34880
    ds_read_b128 a[196:199], v1 offset:34944
    v_mfma_f32_16x16x32_bf16 v[222:225], a[180:183], v[50:53], v[222:225]
    v_exp_f32 v218, v218
    v_mfma_f32_16x16x32_bf16 v[222:225], a[184:187], v[54:57], v[222:225]
    s_waitcnt lgkmcnt(6)
    v_exp_f32 v219, v219
    v_mfma_f32_16x16x32_bf16 v[90:93], a[240:243], v[242:245], v[90:93]
    buffer_load_dwordx4 v3, s[20:23], s65 offen offset:0 lds
    v_mfma_f32_16x16x32_bf16 v[94:97], a[244:247], v[242:245], v[94:97]
    s_add_u32 m0, s33, 8768
    v_exp_f32 v220, v220
    v_mfma_f32_16x16x32_bf16 v[98:101], a[248:251], v[242:245], v[98:101]
    v_exp_f32 v221, v221
    v_mfma_f32_16x16x32_bf16 v[102:105], a[252:255], v[242:245], v[102:105]
    v_exp_f32 v222, v222
    v_mfma_f32_16x16x32_bf16 v[106:109], a[200:203], v[242:245], v[106:109]
    v_exp_f32 v223, v223
    v_mfma_f32_16x16x32_bf16 v[110:113], a[204:207], v[242:245], v[110:113]
    s_waitcnt lgkmcnt(0)
    v_exp_f32 v224, v224
    v_mfma_f32_16x16x32_bf16 v[114:117], a[208:211], v[242:245], v[114:117]
    buffer_load_dwordx4 v3, s[20:23], s65 offen offset:1024 lds
    v_mfma_f32_16x16x32_bf16 v[118:121], a[212:215], v[242:245], v[118:121]
    s_add_u32 m0, s34, 59136
    v_cvt_pk_bf16_f32 v246, v218, v219
    v_cvt_pk_bf16_f32 v247, v220, v221
    v_mfma_f32_16x16x32_bf16 v[226:229], a[156:159], v[58:61], v[18:21]
    v_exp_f32 v225, v225
    v_mfma_f32_16x16x32_bf16 v[226:229], a[160:163], v[62:65], v[226:229]
    v_cvt_pk_bf16_f32 v248, v222, v223
    v_cvt_pk_bf16_f32 v249, v224, v225
    v_mfma_f32_16x16x32_bf16 v[226:229], a[164:167], v[66:69], v[226:229]
    ds_read_b128 a[148:151], v1 offset:35008
    ds_read_b128 a[152:155], v1 offset:39168
    v_mfma_f32_16x16x32_bf16 v[226:229], a[168:171], v[70:73], v[226:229]
    ds_read_b64_tr_b16 a[216:217], v2 offset:25344
    ds_read_b64_tr_b16 a[218:219], v2 offset:25856
    v_mfma_f32_16x16x32_bf16 v[230:233], a[172:175], v[58:61], v[18:21]
    buffer_load_dwordx4 v4, s[24:27], s65 offen offset:0 lds
    v_mfma_f32_16x16x32_bf16 v[230:233], a[176:179], v[62:65], v[230:233]
    s_add_u32 m0, s34, 59936
    ds_read_b64_tr_b16 a[220:221], v2 offset:25376
    ds_read_b64_tr_b16 a[222:223], v2 offset:25888
    v_mfma_f32_16x16x32_bf16 v[230:233], a[180:183], v[66:69], v[230:233]
    v_exp_f32 v226, v226
    v_mfma_f32_16x16x32_bf16 v[230:233], a[184:187], v[70:73], v[230:233]
    v_exp_f32 v227, v227
    v_smfmac_f32_16x16x64_bf16 a[96:99], a[116:119], v[242:249], v7
    v_cvt_pk_bf16_f32 v234, v226, v227
    v_mfma_f32_16x16x32_bf16 v[122:125], a[240:243], v[246:249], v[122:125]
    v_exp_f32 v228, v228
    v_mfma_f32_16x16x32_bf16 v[126:129], a[244:247], v[246:249], v[126:129]
    buffer_load_dwordx4 v4, s[24:27], s65 offen offset:256 lds
    v_mfma_f32_16x16x32_bf16 v[130:133], a[248:251], v[246:249], v[130:133]
    s_add_u32 m0, s33, 17408
    v_exp_f32 v229, v229
    v_mfma_f32_16x16x32_bf16 v[134:137], a[252:255], v[246:249], v[134:137]
    v_exp_f32 v230, v230
    v_mfma_f32_16x16x32_bf16 v[138:141], a[200:203], v[246:249], v[138:141]
    v_exp_f32 v231, v231
    v_mfma_f32_16x16x32_bf16 v[142:145], a[204:207], v[246:249], v[142:145]
    v_exp_f32 v232, v232
    v_mfma_f32_16x16x32_bf16 v[146:149], a[208:211], v[246:249], v[146:149]
    v_cvt_pk_bf16_f32 v235, v228, v229
    v_cvt_pk_bf16_f32 v236, v230, v231
    v_mfma_f32_16x16x32_bf16 v[150:153], a[212:215], v[246:249], v[150:153]
    buffer_load_dwordx4 v3, s[20:23], s50 offen offset:0 lds
    v_mfma_f32_16x16x32_bf16 v[218:221], a[156:159], v[74:77], v[22:25]
    s_add_u32 m0, s33, 17472
    v_exp_f32 v233, v233
    v_mfma_f32_16x16x32_bf16 v[218:221], a[160:163], v[78:81], v[218:221]
    ds_read_b128 a[156:159], v1 offset:39232
    v_cvt_pk_bf16_f32 v237, v232, v233
    v_mfma_f32_16x16x32_bf16 v[218:221], a[164:167], v[82:85], v[218:221]
L_pad3:
    s_cbranch_vccnz L_pad7
    ds_read_b128 a[160:163], v1 offset:39296
    ds_read_b128 a[164:167], v1 offset:39360
    v_mfma_f32_16x16x32_bf16 v[218:221], a[168:171], v[86:89], v[218:221]
    ds_read_b64_tr_b16 a[224:225], v2 offset:25408
    ds_read_b64_tr_b16 a[226:227], v2 offset:25920
    v_mfma_f32_16x16x32_bf16 v[222:225], a[172:175], v[74:77], v[22:25]
    ds_read_b64_tr_b16 a[228:229], v2 offset:25440
    ds_read_b64_tr_b16 a[230:231], v2 offset:25952
    v_mfma_f32_16x16x32_bf16 v[222:225], a[176:179], v[78:81], v[222:225]
    buffer_load_dwordx4 v3, s[20:23], s50 offen offset:1024 lds
    v_mfma_f32_16x16x32_bf16 v[222:225], a[180:183], v[82:85], v[222:225]
    s_add_u32 m0, s34, 0
    v_exp_f32 v218, v218
    v_mfma_f32_16x16x32_bf16 v[222:225], a[184:187], v[86:89], v[222:225]
    v_exp_f32 v219, v219
    v_mfma_f32_16x16x32_bf16 a[0:3], a[240:243], v[234:237], a[0:3]
    v_exp_f32 v220, v220
    v_mfma_f32_16x16x32_bf16 a[4:7], a[244:247], v[234:237], a[4:7]
    v_exp_f32 v221, v221
    v_mfma_f32_16x16x32_bf16 a[8:11], a[248:251], v[234:237], a[8:11]
    v_cvt_pk_bf16_f32 v238, v218, v219
    v_cvt_pk_bf16_f32 v239, v220, v221
    v_mfma_f32_16x16x32_bf16 a[12:15], a[252:255], v[234:237], a[12:15]
    buffer_load_dwordx4 v4, s[24:27], s50 offen offset:0 lds
    v_mfma_f32_16x16x32_bf16 a[16:19], a[200:203], v[234:237], a[16:19]
    s_add_u32 m0, s34, 800
    v_exp_f32 v222, v222
    v_mfma_f32_16x16x32_bf16 a[20:23], a[204:207], v[234:237], a[20:23]
    v_exp_f32 v223, v223
    v_mfma_f32_16x16x32_bf16 a[24:27], a[208:211], v[234:237], a[24:27]
    v_exp_f32 v224, v224
    v_mfma_f32_16x16x32_bf16 a[28:31], a[212:215], v[234:237], a[28:31]
    v_exp_f32 v225, v225
    v_mfma_f32_16x16x32_bf16 v[226:229], a[188:191], v[26:29], v[10:13]
    v_cvt_pk_bf16_f32 v240, v222, v223
    v_cvt_pk_bf16_f32 v241, v224, v225
    v_mfma_f32_16x16x32_bf16 v[226:229], a[192:195], v[30:33], v[226:229]
    buffer_load_dwordx4 v4, s[24:27], s50 offen offset:256 lds
    v_mfma_f32_16x16x32_bf16 v[226:229], a[196:199], v[34:37], v[226:229]
    s_waitcnt lgkmcnt(0)
    ds_read_b64_tr_b16 a[232:233], v2 offset:25472
    ds_read_b64_tr_b16 a[234:235], v2 offset:25984
    v_mfma_f32_16x16x32_bf16 v[226:229], a[148:151], v[38:41], v[226:229]
    s_add_u32 m0, s3, 0
    ds_read_b64_tr_b16 a[236:237], v2 offset:25504
    ds_read_b64_tr_b16 a[238:239], v2 offset:26016
    v_mfma_f32_16x16x32_bf16 v[230:233], a[152:155], v[26:29], v[10:13]
    s_waitcnt vmcnt(12)
    ds_read_b128 a[80:83], v6 offset:4352
    v_mfma_f32_16x16x32_bf16 v[230:233], a[156:159], v[30:33], v[230:233]
    ds_read_b128 a[84:87], v6 offset:4416
    ds_read_b128 a[88:91], v6 offset:4480
    v_mfma_f32_16x16x32_bf16 v[230:233], a[160:163], v[34:37], v[230:233]
    v_exp_f32 v226, v226
    v_mfma_f32_16x16x32_bf16 v[230:233], a[164:167], v[38:41], v[230:233]
    buffer_load_dwordx4 v5, s[16:19], s46 offen offset:0 nt lds
    v_smfmac_f32_16x16x64_bf16 a[100:103], a[116:119], v[234:241], v7
    s_add_u32 m0, s3, 64
    ds_read_b128 a[92:95], v6 offset:4544
    v_mfma_f32_16x16x32_bf16 a[32:35], a[240:243], v[238:241], a[32:35]
    v_exp_f32 v227, v227
    v_mfma_f32_16x16x32_bf16 a[36:39], a[244:247], v[238:241], a[36:39]
    v_exp_f32 v228, v228
    v_mfma_f32_16x16x32_bf16 a[40:43], a[248:251], v[238:241], a[40:43]
    v_exp_f32 v229, v229
    v_mfma_f32_16x16x32_bf16 a[44:47], a[252:255], v[238:241], a[44:47]
    v_exp_f32 v230, v230
    v_mfma_f32_16x16x32_bf16 a[48:51], a[200:203], v[238:241], a[48:51]
    v_exp_f32 v231, v231
    v_mfma_f32_16x16x32_bf16 a[52:55], a[204:207], v[238:241], a[52:55]
    v_exp_f32 v232, v232
    v_mfma_f32_16x16x32_bf16 a[56:59], a[208:211], v[238:241], a[56:59]
    v_cvt_pk_bf16_f32 v242, v226, v227
    v_cvt_pk_bf16_f32 v243, v228, v229
    v_mfma_f32_16x16x32_bf16 a[60:63], a[212:215], v[238:241], a[60:63]
    v_exp_f32 v233, v233
    v_mfma_f32_16x16x32_bf16 v[218:221], a[188:191], v[42:45], v[14:17]
    ds_read_b64_tr_b16 a[240:241], v2 offset:25536
    v_cvt_pk_bf16_f32 v244, v230, v231
    v_mfma_f32_16x16x32_bf16 v[218:221], a[192:195], v[46:49], v[218:221]
    ds_read_b64_tr_b16 a[242:243], v2 offset:26048
    v_cvt_pk_bf16_f32 v245, v232, v233
    v_mfma_f32_16x16x32_bf16 v[218:221], a[196:199], v[50:53], v[218:221]
    buffer_load_dwordx4 v5, s[16:19], s46 offen offset:1024 nt lds
    v_mfma_f32_16x16x32_bf16 v[218:221], a[148:151], v[54:57], v[218:221]
    s_add_u32 m0, s3, 128
    ds_read_b64_tr_b16 a[244:245], v2 offset:25568
    ds_read_b64_tr_b16 a[246:247], v2 offset:26080
    v_mfma_f32_16x16x32_bf16 v[222:225], a[152:155], v[42:45], v[14:17]
    ds_read_b128 a[168:171], v1 offset:43520
    ds_read_b128 a[172:175], v1 offset:43584
    v_mfma_f32_16x16x32_bf16 v[222:225], a[156:159], v[46:49], v[222:225]
    ds_read_b128 a[176:179], v1 offset:43648
    ds_read_b128 a[180:183], v1 offset:43712
    v_mfma_f32_16x16x32_bf16 v[222:225], a[160:163], v[50:53], v[222:225]
    v_exp_f32 v218, v218
    v_mfma_f32_16x16x32_bf16 v[222:225], a[164:167], v[54:57], v[222:225]
    v_exp_f32 v219, v219
    v_mfma_f32_16x16x32_bf16 v[90:93], a[216:219], v[242:245], v[90:93]
    v_exp_f32 v220, v220
    v_mfma_f32_16x16x32_bf16 v[94:97], a[220:223], v[242:245], v[94:97]
    v_exp_f32 v221, v221
    v_mfma_f32_16x16x32_bf16 v[98:101], a[224:227], v[242:245], v[98:101]
    v_cvt_pk_bf16_f32 v246, v218, v219
    v_cvt_pk_bf16_f32 v247, v220, v221
    v_mfma_f32_16x16x32_bf16 v[102:105], a[228:231], v[242:245], v[102:105]
    s_waitcnt lgkmcnt(4)
    v_exp_f32 v222, v222
    v_mfma_f32_16x16x32_bf16 v[106:109], a[232:235], v[242:245], v[106:109]
    v_exp_f32 v223, v223
    v_mfma_f32_16x16x32_bf16 v[110:113], a[236:239], v[242:245], v[110:113]
    v_exp_f32 v224, v224
    v_mfma_f32_16x16x32_bf16 v[114:117], a[240:243], v[242:245], v[114:117]
    buffer_load_dwordx4 v5, s[16:19], s46 offen offset:2048 nt lds
    v_mfma_f32_16x16x32_bf16 v[118:121], a[244:247], v[242:245], v[118:121]
    s_add_u32 m0, s3, 192
    v_exp_f32 v225, v225
    v_mfma_f32_16x16x32_bf16 v[226:229], a[188:191], v[58:61], v[18:21]
    v_cvt_pk_bf16_f32 v248, v222, v223
    v_cvt_pk_bf16_f32 v249, v224, v225
    v_mfma_f32_16x16x32_bf16 v[226:229], a[192:195], v[62:65], v[226:229]
    ds_read_b128 a[184:187], v1 offset:47872
    ds_read_b64_tr_b16 a[248:249], v2 offset:33792
    v_mfma_f32_16x16x32_bf16 v[226:229], a[196:199], v[66:69], v[226:229]
    ds_read_b64_tr_b16 a[250:251], v2 offset:34304
    ds_read_b64_tr_b16 a[252:253], v2 offset:33824
    v_mfma_f32_16x16x32_bf16 v[226:229], a[148:151], v[70:73], v[226:229]
    ds_read_b64_tr_b16 a[254:255], v2 offset:34336
    ds_read_b64_tr_b16 a[200:201], v2 offset:33856
    v_mfma_f32_16x16x32_bf16 v[230:233], a[152:155], v[58:61], v[18:21]
    ds_read_b64_tr_b16 a[202:203], v2 offset:34368
    ds_read_b64_tr_b16 a[204:205], v2 offset:33888
    v_mfma_f32_16x16x32_bf16 v[230:233], a[156:159], v[62:65], v[230:233]
    ds_read_b64_tr_b16 a[206:207], v2 offset:34400
    ds_read_b64_tr_b16 a[208:209], v2 offset:33920
    v_mfma_f32_16x16x32_bf16 v[230:233], a[160:163], v[66:69], v[230:233]
    v_exp_f32 v226, v226
    v_mfma_f32_16x16x32_bf16 v[230:233], a[164:167], v[70:73], v[230:233]
    v_exp_f32 v227, v227
    v_smfmac_f32_16x16x64_bf16 a[96:99], a[116:119], v[242:249], v7
    v_cvt_pk_bf16_f32 v234, v226, v227
    v_mfma_f32_16x16x32_bf16 v[122:125], a[216:219], v[246:249], v[122:125]
    v_exp_f32 v228, v228
    v_mfma_f32_16x16x32_bf16 v[126:129], a[220:223], v[246:249], v[126:129]
    buffer_load_dwordx4 v5, s[16:19], s46 offen offset:3072 nt lds
    v_mfma_f32_16x16x32_bf16 v[130:133], a[224:227], v[246:249], v[130:133]
    s_add_u32 m0, s3, 4352
    v_exp_f32 v229, v229
    v_mfma_f32_16x16x32_bf16 v[134:137], a[228:231], v[246:249], v[134:137]
    v_exp_f32 v230, v230
    v_mfma_f32_16x16x32_bf16 v[138:141], a[232:235], v[246:249], v[138:141]
    v_exp_f32 v231, v231
    v_mfma_f32_16x16x32_bf16 v[142:145], a[236:239], v[246:249], v[142:145]
    v_exp_f32 v232, v232
    v_mfma_f32_16x16x32_bf16 v[146:149], a[240:243], v[246:249], v[146:149]
    v_cvt_pk_bf16_f32 v235, v228, v229
    v_cvt_pk_bf16_f32 v236, v230, v231
    v_mfma_f32_16x16x32_bf16 v[150:153], a[244:247], v[246:249], v[150:153]
    v_exp_f32 v233, v233
    v_mfma_f32_16x16x32_bf16 v[218:221], a[188:191], v[74:77], v[22:25]
    ds_read_b128 a[188:191], v1 offset:47936
    v_cvt_pk_bf16_f32 v237, v232, v233
    v_mfma_f32_16x16x32_bf16 v[218:221], a[192:195], v[78:81], v[218:221]
    ds_read_b128 a[192:195], v1 offset:48000
    ds_read_b64_tr_b16 a[210:211], v2 offset:34432
    v_mfma_f32_16x16x32_bf16 v[218:221], a[196:199], v[82:85], v[218:221]
    ds_read_b128 a[196:199], v1 offset:48064
    ds_read_b64_tr_b16 a[212:213], v2 offset:33952
    v_mfma_f32_16x16x32_bf16 v[218:221], a[148:151], v[86:89], v[218:221]
    ds_read_b64_tr_b16 a[214:215], v2 offset:34464
    ds_read_b128 a[148:151], v1 offset:52224
    v_mfma_f32_16x16x32_bf16 v[222:225], a[152:155], v[74:77], v[22:25]
    ds_read_b128 a[152:155], v1 offset:52288
    v_mfma_f32_16x16x32_bf16 v[222:225], a[156:159], v[78:81], v[222:225]
    buffer_load_dwordx4 v5, s[16:19], s47 offen offset:0 nt lds
    v_mfma_f32_16x16x32_bf16 v[222:225], a[160:163], v[82:85], v[222:225]
    s_add_u32 m0, s3, 4416
    v_exp_f32 v218, v218
    v_mfma_f32_16x16x32_bf16 v[222:225], a[164:167], v[86:89], v[222:225]
    v_exp_f32 v219, v219
    v_mfma_f32_16x16x32_bf16 a[0:3], a[216:219], v[234:237], a[0:3]
    v_exp_f32 v220, v220
    v_mfma_f32_16x16x32_bf16 a[4:7], a[220:223], v[234:237], a[4:7]
    v_exp_f32 v221, v221
    v_mfma_f32_16x16x32_bf16 a[8:11], a[224:227], v[234:237], a[8:11]
    v_cvt_pk_bf16_f32 v238, v218, v219
    v_cvt_pk_bf16_f32 v239, v220, v221
    v_mfma_f32_16x16x32_bf16 a[12:15], a[228:231], v[234:237], a[12:15]
    v_exp_f32 v222, v222
    v_mfma_f32_16x16x32_bf16 a[16:19], a[232:235], v[234:237], a[16:19]
    v_exp_f32 v223, v223
    v_mfma_f32_16x16x32_bf16 a[20:23], a[236:239], v[234:237], a[20:23]
    v_exp_f32 v224, v224
    v_mfma_f32_16x16x32_bf16 a[24:27], a[240:243], v[234:237], a[24:27]
    v_exp_f32 v225, v225
    v_mfma_f32_16x16x32_bf16 a[28:31], a[244:247], v[234:237], a[28:31]
    s_waitcnt lgkmcnt(0)
    v_cvt_pk_bf16_f32 v240, v222, v223
    v_cvt_pk_bf16_f32 v241, v224, v225
    v_mfma_f32_16x16x32_bf16 v[226:229], a[168:171], v[26:29], v[10:13]
    ds_read_b128 a[156:159], v1 offset:52352
    ds_read_b128 a[160:163], v1 offset:52416
    v_mfma_f32_16x16x32_bf16 v[226:229], a[172:175], v[30:33], v[226:229]
    buffer_load_dwordx4 v5, s[16:19], s47 offen offset:1024 nt lds
    v_mfma_f32_16x16x32_bf16 v[226:229], a[176:179], v[34:37], v[226:229]
    s_add_u32 m0, s3, 4480
    ds_read_b128 a[164:167], v1 offset:56576
    v_mfma_f32_16x16x32_bf16 v[226:229], a[180:183], v[38:41], v[226:229]
    v_mfma_f32_16x16x32_bf16 v[230:233], a[184:187], v[26:29], v[10:13]
    v_mfma_f32_16x16x32_bf16 v[230:233], a[188:191], v[30:33], v[230:233]
    v_mfma_f32_16x16x32_bf16 v[230:233], a[192:195], v[34:37], v[230:233]
    v_mfma_f32_16x16x32_bf16 v[230:233], a[196:199], v[38:41], v[230:233]
    v_smfmac_f32_16x16x64_bf16 a[100:103], a[116:119], v[234:241], v7
    v_mfma_f32_16x16x32_bf16 a[32:35], a[216:219], v[238:241], a[32:35]
    ds_read_b64_tr_b16 a[216:217], v2 offset:33984
    ds_read_b64_tr_b16 a[218:219], v2 offset:34496
    v_mfma_f32_16x16x32_bf16 a[36:39], a[220:223], v[238:241], a[36:39]
    v_exp_f32 v226, v226
    v_mfma_f32_16x16x32_bf16 a[40:43], a[224:227], v[238:241], a[40:43]
    v_exp_f32 v227, v227
    v_mfma_f32_16x16x32_bf16 a[44:47], a[228:231], v[238:241], a[44:47]
    v_exp_f32 v228, v228
    v_mfma_f32_16x16x32_bf16 a[48:51], a[232:235], v[238:241], a[48:51]
    buffer_load_dwordx4 v5, s[16:19], s47 offen offset:2048 nt lds
    v_mfma_f32_16x16x32_bf16 a[52:55], a[236:239], v[238:241], a[52:55]
    s_add_u32 m0, s3, 4544
    v_exp_f32 v229, v229
    v_mfma_f32_16x16x32_bf16 a[56:59], a[240:243], v[238:241], a[56:59]
    v_exp_f32 v230, v230
    v_mfma_f32_16x16x32_bf16 a[60:63], a[244:247], v[238:241], a[60:63]
    v_exp_f32 v231, v231
    v_mfma_f32_16x16x32_bf16 v[218:221], a[168:171], v[42:45], v[14:17]
    v_exp_f32 v232, v232
    v_mfma_f32_16x16x32_bf16 v[218:221], a[172:175], v[46:49], v[218:221]
    v_cvt_pk_bf16_f32 v242, v226, v227
    v_cvt_pk_bf16_f32 v243, v228, v229
    v_mfma_f32_16x16x32_bf16 v[218:221], a[176:179], v[50:53], v[218:221]
    v_exp_f32 v233, v233
    v_mfma_f32_16x16x32_bf16 v[218:221], a[180:183], v[54:57], v[218:221]
    v_cvt_pk_bf16_f32 v244, v230, v231
    v_cvt_pk_bf16_f32 v245, v232, v233
    v_mfma_f32_16x16x32_bf16 v[222:225], a[184:187], v[42:45], v[14:17]
    ds_read_b64_tr_b16 a[220:221], v2 offset:34016
    ds_read_b64_tr_b16 a[222:223], v2 offset:34528
    v_mfma_f32_16x16x32_bf16 v[222:225], a[188:191], v[46:49], v[222:225]
    v_mfma_f32_16x16x32_bf16 v[222:225], a[192:195], v[50:53], v[222:225]
    v_mfma_f32_16x16x32_bf16 v[222:225], a[196:199], v[54:57], v[222:225]
    v_exp_f32 v218, v218
    v_mfma_f32_16x16x32_bf16 v[90:93], a[248:251], v[242:245], v[90:93]
    buffer_load_dwordx4 v5, s[16:19], s47 offen offset:3072 nt lds
    v_mfma_f32_16x16x32_bf16 v[94:97], a[252:255], v[242:245], v[94:97]
    v_exp_f32 v219, v219
    v_mfma_f32_16x16x32_bf16 v[98:101], a[200:203], v[242:245], v[98:101]
    v_exp_f32 v220, v220
    v_mfma_f32_16x16x32_bf16 v[102:105], a[204:207], v[242:245], v[102:105]
    v_exp_f32 v221, v221
    v_mfma_f32_16x16x32_bf16 v[106:109], a[208:211], v[242:245], v[106:109]
    v_exp_f32 v222, v222
    v_mfma_f32_16x16x32_bf16 v[110:113], a[212:215], v[242:245], v[110:113]
    s_waitcnt lgkmcnt(0)
    v_exp_f32 v223, v223
    v_mfma_f32_16x16x32_bf16 v[114:117], a[216:219], v[242:245], v[114:117]
    v_exp_f32 v224, v224
    v_mfma_f32_16x16x32_bf16 v[118:121], a[220:223], v[242:245], v[118:121]
    v_cvt_pk_bf16_f32 v246, v218, v219
    v_cvt_pk_bf16_f32 v247, v220, v221
    v_mfma_f32_16x16x32_bf16 v[226:229], a[168:171], v[58:61], v[18:21]
    v_exp_f32 v225, v225
    v_mfma_f32_16x16x32_bf16 v[226:229], a[172:175], v[62:65], v[226:229]
    v_cvt_pk_bf16_f32 v248, v222, v223
    v_cvt_pk_bf16_f32 v249, v224, v225
    v_mfma_f32_16x16x32_bf16 v[226:229], a[176:179], v[66:69], v[226:229]
    v_mfma_f32_16x16x32_bf16 v[226:229], a[180:183], v[70:73], v[226:229]
    v_mfma_f32_16x16x32_bf16 v[230:233], a[184:187], v[58:61], v[18:21]
    v_mfma_f32_16x16x32_bf16 v[230:233], a[188:191], v[62:65], v[230:233]
    v_mfma_f32_16x16x32_bf16 v[230:233], a[192:195], v[66:69], v[230:233]
    v_mfma_f32_16x16x32_bf16 v[230:233], a[196:199], v[70:73], v[230:233]
    v_smfmac_f32_16x16x64_bf16 a[96:99], a[116:119], v[242:249], v7
    v_mfma_f32_16x16x32_bf16 v[122:125], a[248:251], v[246:249], v[122:125]
    v_mfma_f32_16x16x32_bf16 v[126:129], a[252:255], v[246:249], v[126:129]
    v_mfma_f32_16x16x32_bf16 v[130:133], a[200:203], v[246:249], v[130:133]
    v_exp_f32 v226, v226
    v_mfma_f32_16x16x32_bf16 v[134:137], a[204:207], v[246:249], v[134:137]
    v_exp_f32 v227, v227
    v_mfma_f32_16x16x32_bf16 v[138:141], a[208:211], v[246:249], v[138:141]
    v_exp_f32 v228, v228
    v_mfma_f32_16x16x32_bf16 v[142:145], a[212:215], v[246:249], v[142:145]
    v_exp_f32 v229, v229
    v_mfma_f32_16x16x32_bf16 v[146:149], a[216:219], v[246:249], v[146:149]
    v_exp_f32 v230, v230
    v_mfma_f32_16x16x32_bf16 v[150:153], a[220:223], v[246:249], v[150:153]
    v_exp_f32 v231, v231
    v_mfma_f32_16x16x32_bf16 v[218:221], a[168:171], v[74:77], v[22:25]
    v_exp_f32 v232, v232
    v_mfma_f32_16x16x32_bf16 v[218:221], a[172:175], v[78:81], v[218:221]
    v_cvt_pk_bf16_f32 v234, v226, v227
    v_cvt_pk_bf16_f32 v235, v228, v229
    v_mfma_f32_16x16x32_bf16 v[218:221], a[176:179], v[82:85], v[218:221]
    v_exp_f32 v233, v233
    v_mfma_f32_16x16x32_bf16 v[218:221], a[180:183], v[86:89], v[218:221]
    v_cvt_pk_bf16_f32 v236, v230, v231
    v_cvt_pk_bf16_f32 v237, v232, v233
    v_mfma_f32_16x16x32_bf16 v[222:225], a[184:187], v[74:77], v[22:25]
    ds_read_b128 a[168:171], v1 offset:56640
    ds_read_b128 a[172:175], v1 offset:56704
    v_mfma_f32_16x16x32_bf16 v[222:225], a[188:191], v[78:81], v[222:225]
    ds_read_b128 a[176:179], v1 offset:56768
    v_mfma_f32_16x16x32_bf16 v[222:225], a[192:195], v[82:85], v[222:225]
    v_exp_f32 v218, v218
    v_mfma_f32_16x16x32_bf16 v[222:225], a[196:199], v[86:89], v[222:225]
    v_exp_f32 v219, v219
    v_mfma_f32_16x16x32_bf16 a[0:3], a[248:251], v[234:237], a[0:3]
    v_exp_f32 v220, v220
    v_mfma_f32_16x16x32_bf16 a[4:7], a[252:255], v[234:237], a[4:7]
    v_exp_f32 v221, v221
    v_mfma_f32_16x16x32_bf16 a[8:11], a[200:203], v[234:237], a[8:11]
    v_cvt_pk_bf16_f32 v238, v218, v219
    v_cvt_pk_bf16_f32 v239, v220, v221
    v_mfma_f32_16x16x32_bf16 a[12:15], a[204:207], v[234:237], a[12:15]
    v_exp_f32 v222, v222
    v_mfma_f32_16x16x32_bf16 a[16:19], a[208:211], v[234:237], a[16:19]
    v_exp_f32 v223, v223
    v_mfma_f32_16x16x32_bf16 a[20:23], a[212:215], v[234:237], a[20:23]
    v_exp_f32 v224, v224
    v_mfma_f32_16x16x32_bf16 a[24:27], a[216:219], v[234:237], a[24:27]
    v_exp_f32 v225, v225
    v_mfma_f32_16x16x32_bf16 a[28:31], a[220:223], v[234:237], a[28:31]
    v_cvt_pk_bf16_f32 v240, v222, v223
    v_cvt_pk_bf16_f32 v241, v224, v225
    s_waitcnt vmcnt(10)
    s_barrier
    s_add_u32 m0, s33, 26112
    ds_read_b64_tr_b16 a[224:225], v2 offset:42240
    ds_read_b64_tr_b16 a[226:227], v2 offset:42752
    v_mfma_f32_16x16x32_bf16 v[226:229], a[148:151], v[26:29], v[10:13]
    ds_read_b64_tr_b16 a[228:229], v2 offset:42272
    ds_read_b64_tr_b16 a[230:231], v2 offset:42784
    v_mfma_f32_16x16x32_bf16 v[226:229], a[152:155], v[30:33], v[226:229]
    buffer_load_dwordx4 v3, s[20:23], s51 offen offset:0 lds
    v_mfma_f32_16x16x32_bf16 v[226:229], a[156:159], v[34:37], v[226:229]
    s_add_u32 m0, s33, 26176
    ds_read_b64_tr_b16 a[232:233], v2 offset:42304
    ds_read_b64_tr_b16 a[234:235], v2 offset:42816
    v_mfma_f32_16x16x32_bf16 v[226:229], a[160:163], v[38:41], v[226:229]
    ds_read_b64_tr_b16 a[236:237], v2 offset:42336
    ds_read_b64_tr_b16 a[238:239], v2 offset:42848
    v_mfma_f32_16x16x32_bf16 v[230:233], a[164:167], v[26:29], v[10:13]
    s_waitcnt lgkmcnt(8)
    ds_read_b64_tr_b16 a[240:241], v2 offset:42368
    ds_read_b64_tr_b16 a[242:243], v2 offset:42880
    v_mfma_f32_16x16x32_bf16 v[230:233], a[168:171], v[30:33], v[230:233]
    ds_read_b64_tr_b16 a[244:245], v2 offset:42400
    ds_read_b64_tr_b16 a[246:247], v2 offset:42912
    v_mfma_f32_16x16x32_bf16 v[230:233], a[172:175], v[34:37], v[230:233]
    v_exp_f32 v226, v226
    v_mfma_f32_16x16x32_bf16 v[230:233], a[176:179], v[38:41], v[230:233]
    buffer_load_dwordx4 v3, s[20:23], s51 offen offset:1024 lds
    v_smfmac_f32_16x16x64_bf16 a[100:103], a[116:119], v[234:241], v7
    s_add_u32 m0, s34, 8448
    ds_read_b128 a[180:183], v1 offset:0
    v_mfma_f32_16x16x32_bf16 a[32:35], a[248:251], v[238:241], a[32:35]
    v_exp_f32 v227, v227
    v_mfma_f32_16x16x32_bf16 a[36:39], a[252:255], v[238:241], a[36:39]
    v_exp_f32 v228, v228
    v_mfma_f32_16x16x32_bf16 a[40:43], a[200:203], v[238:241], a[40:43]
    v_exp_f32 v229, v229
    v_mfma_f32_16x16x32_bf16 a[44:47], a[204:207], v[238:241], a[44:47]
    v_exp_f32 v230, v230
    v_mfma_f32_16x16x32_bf16 a[48:51], a[208:211], v[238:241], a[48:51]
    buffer_load_dwordx4 v4, s[24:27], s51 offen offset:0 lds
    v_mfma_f32_16x16x32_bf16 a[52:55], a[212:215], v[238:241], a[52:55]
    s_add_u32 m0, s34, 9248
    v_exp_f32 v231, v231
    v_mfma_f32_16x16x32_bf16 a[56:59], a[216:219], v[238:241], a[56:59]
    v_exp_f32 v232, v232
    v_mfma_f32_16x16x32_bf16 a[60:63], a[220:223], v[238:241], a[60:63]
    v_cvt_pk_bf16_f32 v242, v226, v227
    v_cvt_pk_bf16_f32 v243, v228, v229
    v_mfma_f32_16x16x32_bf16 v[218:221], a[148:151], v[42:45], v[14:17]
    v_exp_f32 v233, v233
    v_mfma_f32_16x16x32_bf16 v[218:221], a[152:155], v[46:49], v[218:221]
    ds_read_b64_tr_b16 a[248:249], v2 offset:42432
    v_cvt_pk_bf16_f32 v244, v230, v231
    v_mfma_f32_16x16x32_bf16 v[218:221], a[156:159], v[50:53], v[218:221]
    buffer_load_dwordx4 v4, s[24:27], s51 offen offset:256 lds
    v_mfma_f32_16x16x32_bf16 v[218:221], a[160:163], v[54:57], v[218:221]
    s_add_u32 m0, s33, 34816
    ds_read_b64_tr_b16 a[250:251], v2 offset:42944
    v_cvt_pk_bf16_f32 v245, v232, v233
    v_mfma_f32_16x16x32_bf16 v[222:225], a[164:167], v[42:45], v[14:17]
    ds_read_b64_tr_b16 a[252:253], v2 offset:42464
    ds_read_b64_tr_b16 a[254:255], v2 offset:42976
    v_mfma_f32_16x16x32_bf16 v[222:225], a[168:171], v[46:49], v[222:225]
    ds_read_b128 a[184:187], v1 offset:64
    ds_read_b128 a[188:191], v1 offset:128
    v_mfma_f32_16x16x32_bf16 v[222:225], a[172:175], v[50:53], v[222:225]
    v_exp_f32 v218, v218
    v_mfma_f32_16x16x32_bf16 v[222:225], a[176:179], v[54:57], v[222:225]
    s_waitcnt lgkmcnt(6)
    v_exp_f32 v219, v219
    v_mfma_f32_16x16x32_bf16 v[90:93], a[224:227], v[242:245], v[90:93]
    buffer_load_dwordx4 v3, s[20:23], s52 offen offset:0 lds
    v_mfma_f32_16x16x32_bf16 v[94:97], a[228:231], v[242:245], v[94:97]
    s_add_u32 m0, s33, 34880
    v_exp_f32 v220, v220
    v_mfma_f32_16x16x32_bf16 v[98:101], a[232:235], v[242:245], v[98:101]
    v_exp_f32 v221, v221
    v_mfma_f32_16x16x32_bf16 v[102:105], a[236:239], v[242:245], v[102:105]
    v_exp_f32 v222, v222
    v_mfma_f32_16x16x32_bf16 v[106:109], a[240:243], v[242:245], v[106:109]
    v_exp_f32 v223, v223
    v_mfma_f32_16x16x32_bf16 v[110:113], a[244:247], v[242:245], v[110:113]
    s_waitcnt lgkmcnt(0)
    v_exp_f32 v224, v224
    v_mfma_f32_16x16x32_bf16 v[114:117], a[248:251], v[242:245], v[114:117]
    buffer_load_dwordx4 v3, s[20:23], s52 offen offset:1024 lds
    v_mfma_f32_16x16x32_bf16 v[118:121], a[252:255], v[242:245], v[118:121]
    s_add_u32 m0, s34, 16896
    v_cvt_pk_bf16_f32 v246, v218, v219
    v_cvt_pk_bf16_f32 v247, v220, v221
    v_mfma_f32_16x16x32_bf16 v[226:229], a[148:151], v[58:61], v[18:21]
    v_exp_f32 v225, v225
    v_mfma_f32_16x16x32_bf16 v[226:229], a[152:155], v[62:65], v[226:229]
    v_cvt_pk_bf16_f32 v248, v222, v223
    v_cvt_pk_bf16_f32 v249, v224, v225
    v_mfma_f32_16x16x32_bf16 v[226:229], a[156:159], v[66:69], v[226:229]
    ds_read_b128 a[192:195], v1 offset:192
    ds_read_b128 a[196:199], v1 offset:4352
    v_mfma_f32_16x16x32_bf16 v[226:229], a[160:163], v[70:73], v[226:229]
    ds_read_b64_tr_b16 a[200:201], v2 offset:50688
    ds_read_b64_tr_b16 a[202:203], v2 offset:51200
    v_mfma_f32_16x16x32_bf16 v[230:233], a[164:167], v[58:61], v[18:21]
    buffer_load_dwordx4 v4, s[24:27], s52 offen offset:0 lds
    v_mfma_f32_16x16x32_bf16 v[230:233], a[168:171], v[62:65], v[230:233]
    s_add_u32 m0, s34, 17696
    ds_read_b64_tr_b16 a[204:205], v2 offset:50720
    ds_read_b64_tr_b16 a[206:207], v2 offset:51232
    v_mfma_f32_16x16x32_bf16 v[230:233], a[172:175], v[66:69], v[230:233]
    v_exp_f32 v226, v226
    v_mfma_f32_16x16x32_bf16 v[230:233], a[176:179], v[70:73], v[230:233]
    v_exp_f32 v227, v227
    v_smfmac_f32_16x16x64_bf16 a[96:99], a[116:119], v[242:249], v7
    v_cvt_pk_bf16_f32 v234, v226, v227
    v_mfma_f32_16x16x32_bf16 v[122:125], a[224:227], v[246:249], v[122:125]
    v_exp_f32 v228, v228
    v_mfma_f32_16x16x32_bf16 v[126:129], a[228:231], v[246:249], v[126:129]
    buffer_load_dwordx4 v4, s[24:27], s52 offen offset:256 lds
    v_mfma_f32_16x16x32_bf16 v[130:133], a[232:235], v[246:249], v[130:133]
    s_add_u32 m0, s33, 43520
    v_exp_f32 v229, v229
    v_mfma_f32_16x16x32_bf16 v[134:137], a[236:239], v[246:249], v[134:137]
    v_exp_f32 v230, v230
    v_mfma_f32_16x16x32_bf16 v[138:141], a[240:243], v[246:249], v[138:141]
    v_exp_f32 v231, v231
    v_mfma_f32_16x16x32_bf16 v[142:145], a[244:247], v[246:249], v[142:145]
    v_exp_f32 v232, v232
    v_mfma_f32_16x16x32_bf16 v[146:149], a[248:251], v[246:249], v[146:149]
    v_cvt_pk_bf16_f32 v235, v228, v229
    v_cvt_pk_bf16_f32 v236, v230, v231
    v_mfma_f32_16x16x32_bf16 v[150:153], a[252:255], v[246:249], v[150:153]
    buffer_load_dwordx4 v3, s[20:23], s53 offen offset:0 lds
    v_mfma_f32_16x16x32_bf16 v[218:221], a[148:151], v[74:77], v[22:25]
    s_add_u32 m0, s33, 43584
    v_exp_f32 v233, v233
    v_mfma_f32_16x16x32_bf16 v[218:221], a[152:155], v[78:81], v[218:221]
    ds_read_b128 a[148:151], v1 offset:4416
    v_cvt_pk_bf16_f32 v237, v232, v233
    v_mfma_f32_16x16x32_bf16 v[218:221], a[156:159], v[82:85], v[218:221]
    ds_read_b128 a[152:155], v1 offset:4480
    ds_read_b128 a[156:159], v1 offset:4544
    v_mfma_f32_16x16x32_bf16 v[218:221], a[160:163], v[86:89], v[218:221]
    ds_read_b64_tr_b16 a[208:209], v2 offset:50752
    ds_read_b64_tr_b16 a[210:211], v2 offset:51264
    v_mfma_f32_16x16x32_bf16 v[222:225], a[164:167], v[74:77], v[22:25]
    ds_read_b64_tr_b16 a[212:213], v2 offset:50784
    ds_read_b64_tr_b16 a[214:215], v2 offset:51296
    v_mfma_f32_16x16x32_bf16 v[222:225], a[168:171], v[78:81], v[222:225]
    buffer_load_dwordx4 v3, s[20:23], s53 offen offset:1024 lds
    v_mfma_f32_16x16x32_bf16 v[222:225], a[172:175], v[82:85], v[222:225]
    s_add_u32 m0, s34, 25344
    v_exp_f32 v218, v218
    v_mfma_f32_16x16x32_bf16 v[222:225], a[176:179], v[86:89], v[222:225]
    v_exp_f32 v219, v219
    v_mfma_f32_16x16x32_bf16 a[0:3], a[224:227], v[234:237], a[0:3]
    v_exp_f32 v220, v220
    v_mfma_f32_16x16x32_bf16 a[4:7], a[228:231], v[234:237], a[4:7]
    v_exp_f32 v221, v221
    v_mfma_f32_16x16x32_bf16 a[8:11], a[232:235], v[234:237], a[8:11]
    v_cvt_pk_bf16_f32 v238, v218, v219
    v_cvt_pk_bf16_f32 v239, v220, v221
    v_mfma_f32_16x16x32_bf16 a[12:15], a[236:239], v[234:237], a[12:15]
    buffer_load_dwordx4 v4, s[24:27], s53 offen offset:0 lds
    v_mfma_f32_16x16x32_bf16 a[16:19], a[240:243], v[234:237], a[16:19]
    s_add_u32 m0, s34, 26144
    v_exp_f32 v222, v222
    v_mfma_f32_16x16x32_bf16 a[20:23], a[244:247], v[234:237], a[20:23]
    v_exp_f32 v223, v223
    v_mfma_f32_16x16x32_bf16 a[24:27], a[248:251], v[234:237], a[24:27]
    v_exp_f32 v224, v224
    v_mfma_f32_16x16x32_bf16 a[28:31], a[252:255], v[234:237], a[28:31]
    v_exp_f32 v225, v225
    v_mfma_f32_16x16x32_bf16 v[226:229], a[180:183], v[26:29], v[10:13]
    v_cvt_pk_bf16_f32 v240, v222, v223
    v_cvt_pk_bf16_f32 v241, v224, v225
    v_mfma_f32_16x16x32_bf16 v[226:229], a[184:187], v[30:33], v[226:229]
    buffer_load_dwordx4 v4, s[24:27], s53 offen offset:256 lds
    v_mfma_f32_16x16x32_bf16 v[226:229], a[188:191], v[34:37], v[226:229]
    s_waitcnt lgkmcnt(0)
    ds_read_b64_tr_b16 a[216:217], v2 offset:50816
    ds_read_b64_tr_b16 a[218:219], v2 offset:51328
    v_mfma_f32_16x16x32_bf16 v[226:229], a[192:195], v[38:41], v[226:229]
    ds_read_b64_tr_b16 a[220:221], v2 offset:50848
    ds_read_b64_tr_b16 a[222:223], v2 offset:51360
    v_mfma_f32_16x16x32_bf16 v[230:233], a[196:199], v[26:29], v[10:13]
    ds_read_b128 a[160:163], v1 offset:8704
    ds_read_b128 a[164:167], v1 offset:8768
    v_mfma_f32_16x16x32_bf16 v[230:233], a[148:151], v[30:33], v[230:233]
    ds_read_b128 a[168:171], v1 offset:8832
    ds_read_b128 a[172:175], v1 offset:8896
    v_mfma_f32_16x16x32_bf16 v[230:233], a[152:155], v[34:37], v[230:233]
    v_exp_f32 v226, v226
    v_mfma_f32_16x16x32_bf16 v[230:233], a[156:159], v[38:41], v[230:233]
    v_exp_f32 v227, v227
    v_smfmac_f32_16x16x64_bf16 a[100:103], a[116:119], v[234:241], v7
    v_cvt_pk_bf16_f32 v242, v226, v227
    v_mfma_f32_16x16x32_bf16 a[32:35], a[224:227], v[238:241], a[32:35]
    v_exp_f32 v228, v228
    v_mfma_f32_16x16x32_bf16 a[36:39], a[228:231], v[238:241], a[36:39]
    v_exp_f32 v229, v229
    v_mfma_f32_16x16x32_bf16 a[40:43], a[232:235], v[238:241], a[40:43]
    v_exp_f32 v230, v230
    v_mfma_f32_16x16x32_bf16 a[44:47], a[236:239], v[238:241], a[44:47]
    v_exp_f32 v231, v231
    v_mfma_f32_16x16x32_bf16 a[48:51], a[240:243], v[238:241], a[48:51]
    v_exp_f32 v232, v232
    v_mfma_f32_16x16x32_bf16 a[52:55], a[244:247], v[238:241], a[52:55]
    ds_read_b64_tr_b16 a[224:225], v2 offset:50880
    v_cvt_pk_bf16_f32 v243, v228, v229
    v_mfma_f32_16x16x32_bf16 a[56:59], a[248:251], v[238:241], a[56:59]
    v_exp_f32 v233, v233
    v_mfma_f32_16x16x32_bf16 a[60:63], a[252:255], v[238:241], a[60:63]
    ds_read_b64_tr_b16 a[226:227], v2 offset:51392
    v_cvt_pk_bf16_f32 v244, v230, v231
    v_mfma_f32_16x16x32_bf16 v[218:221], a[180:183], v[42:45], v[14:17]
    ds_read_b64_tr_b16 a[228:229], v2 offset:50912
    v_cvt_pk_bf16_f32 v245, v232, v233
    v_mfma_f32_16x16x32_bf16 v[218:221], a[184:187], v[46:49], v[218:221]
    ds_read_b64_tr_b16 a[230:231], v2 offset:51424
    ds_read_b128 a[176:179], v1 offset:13056
    v_mfma_f32_16x16x32_bf16 v[218:221], a[188:191], v[50:53], v[218:221]
    ds_read_b64_tr_b16 a[232:233], v2 offset:59136
    ds_read_b64_tr_b16 a[234:235], v2 offset:59648
    v_mfma_f32_16x16x32_bf16 v[218:221], a[192:195], v[54:57], v[218:221]
    ds_read_b64_tr_b16 a[236:237], v2 offset:59168
    ds_read_b64_tr_b16 a[238:239], v2 offset:59680
    v_mfma_f32_16x16x32_bf16 v[222:225], a[196:199], v[42:45], v[14:17]
    ds_read_b64_tr_b16 a[240:241], v2 offset:59200
    ds_read_b64_tr_b16 a[242:243], v2 offset:59712
    v_mfma_f32_16x16x32_bf16 v[222:225], a[148:151], v[46:49], v[222:225]
    ds_read_b64_tr_b16 a[244:245], v2 offset:59232
    ds_read_b64_tr_b16 a[246:247], v2 offset:59744
    v_mfma_f32_16x16x32_bf16 v[222:225], a[152:155], v[50:53], v[222:225]
    v_exp_f32 v218, v218
    v_mfma_f32_16x16x32_bf16 v[222:225], a[156:159], v[54:57], v[222:225]
    v_exp_f32 v219, v219
    v_mfma_f32_16x16x32_bf16 v[90:93], a[200:203], v[242:245], v[90:93]
    v_exp_f32 v220, v220
    v_mfma_f32_16x16x32_bf16 v[94:97], a[204:207], v[242:245], v[94:97]
    v_exp_f32 v221, v221
    v_mfma_f32_16x16x32_bf16 v[98:101], a[208:211], v[242:245], v[98:101]
    v_cvt_pk_bf16_f32 v246, v218, v219
    v_cvt_pk_bf16_f32 v247, v220, v221
    v_mfma_f32_16x16x32_bf16 v[102:105], a[212:215], v[242:245], v[102:105]
    s_waitcnt lgkmcnt(4)
    v_exp_f32 v222, v222
    v_mfma_f32_16x16x32_bf16 v[106:109], a[216:219], v[242:245], v[106:109]
    v_exp_f32 v223, v223
    v_mfma_f32_16x16x32_bf16 v[110:113], a[220:223], v[242:245], v[110:113]
L_pad4:
    s_cbranch_vccnz L_pad8
    v_exp_f32 v224, v224
    v_mfma_f32_16x16x32_bf16 v[114:117], a[224:227], v[242:245], v[114:117]
    v_exp_f32 v225, v225
    v_mfma_f32_16x16x32_bf16 v[118:121], a[228:231], v[242:245], v[118:121]
    v_cvt_pk_bf16_f32 v248, v222, v223
    v_cvt_pk_bf16_f32 v249, v224, v225
    v_mfma_f32_16x16x32_bf16 v[226:229], a[180:183], v[58:61], v[18:21]
    ds_read_b64_tr_b16 a[248:249], v2 offset:59264
    ds_read_b64_tr_b16 a[250:251], v2 offset:59776
    v_mfma_f32_16x16x32_bf16 v[226:229], a[184:187], v[62:65], v[226:229]
    ds_read_b64_tr_b16 a[252:253], v2 offset:59296
    ds_read_b64_tr_b16 a[254:255], v2 offset:59808
    v_mfma_f32_16x16x32_bf16 v[226:229], a[188:191], v[66:69], v[226:229]
    v_mfma_f32_16x16x32_bf16 v[226:229], a[192:195], v[70:73], v[226:229]
    v_mfma_f32_16x16x32_bf16 v[230:233], a[196:199], v[58:61], v[18:21]
    v_mfma_f32_16x16x32_bf16 v[230:233], a[148:151], v[62:65], v[230:233]
    v_mfma_f32_16x16x32_bf16 v[230:233], a[152:155], v[66:69], v[230:233]
    v_mfma_f32_16x16x32_bf16 v[230:233], a[156:159], v[70:73], v[230:233]
    v_smfmac_f32_16x16x64_bf16 a[96:99], a[116:119], v[242:249], v7
    v_mfma_f32_16x16x32_bf16 v[122:125], a[200:203], v[246:249], v[122:125]
    v_mfma_f32_16x16x32_bf16 v[126:129], a[204:207], v[246:249], v[126:129]
    v_mfma_f32_16x16x32_bf16 v[130:133], a[208:211], v[246:249], v[130:133]
    v_exp_f32 v226, v226
    v_mfma_f32_16x16x32_bf16 v[134:137], a[212:215], v[246:249], v[134:137]
    v_exp_f32 v227, v227
    v_mfma_f32_16x16x32_bf16 v[138:141], a[216:219], v[246:249], v[138:141]
    v_exp_f32 v228, v228
    v_mfma_f32_16x16x32_bf16 v[142:145], a[220:223], v[246:249], v[142:145]
    v_exp_f32 v229, v229
    v_mfma_f32_16x16x32_bf16 v[146:149], a[224:227], v[246:249], v[146:149]
    v_exp_f32 v230, v230
    v_mfma_f32_16x16x32_bf16 v[150:153], a[228:231], v[246:249], v[150:153]
    v_exp_f32 v231, v231
    v_mfma_f32_16x16x32_bf16 v[218:221], a[180:183], v[74:77], v[22:25]
    v_exp_f32 v232, v232
    v_mfma_f32_16x16x32_bf16 v[218:221], a[184:187], v[78:81], v[218:221]
    v_cvt_pk_bf16_f32 v234, v226, v227
    v_cvt_pk_bf16_f32 v235, v228, v229
    v_mfma_f32_16x16x32_bf16 v[218:221], a[188:191], v[82:85], v[218:221]
    v_exp_f32 v233, v233
    v_mfma_f32_16x16x32_bf16 v[218:221], a[192:195], v[86:89], v[218:221]
    v_cvt_pk_bf16_f32 v236, v230, v231
    v_cvt_pk_bf16_f32 v237, v232, v233
    v_mfma_f32_16x16x32_bf16 v[222:225], a[196:199], v[74:77], v[22:25]
    ds_read_b128 a[180:183], v1 offset:13120
    ds_read_b128 a[184:187], v1 offset:13184
    v_mfma_f32_16x16x32_bf16 v[222:225], a[148:151], v[78:81], v[222:225]
    ds_read_b128 a[188:191], v1 offset:13248
    ds_read_b128 a[192:195], v1 offset:17408
    v_mfma_f32_16x16x32_bf16 v[222:225], a[152:155], v[82:85], v[222:225]
    v_exp_f32 v218, v218
    v_mfma_f32_16x16x32_bf16 v[222:225], a[156:159], v[86:89], v[222:225]
    v_exp_f32 v219, v219
    v_mfma_f32_16x16x32_bf16 a[0:3], a[200:203], v[234:237], a[0:3]
    v_exp_f32 v220, v220
    v_mfma_f32_16x16x32_bf16 a[4:7], a[204:207], v[234:237], a[4:7]
    v_exp_f32 v221, v221
    v_mfma_f32_16x16x32_bf16 a[8:11], a[208:211], v[234:237], a[8:11]
    v_cvt_pk_bf16_f32 v238, v218, v219
    v_cvt_pk_bf16_f32 v239, v220, v221
    v_mfma_f32_16x16x32_bf16 a[12:15], a[212:215], v[234:237], a[12:15]
    v_exp_f32 v222, v222
    v_mfma_f32_16x16x32_bf16 a[16:19], a[216:219], v[234:237], a[16:19]
    v_exp_f32 v223, v223
    v_mfma_f32_16x16x32_bf16 a[20:23], a[220:223], v[234:237], a[20:23]
    v_exp_f32 v224, v224
    v_mfma_f32_16x16x32_bf16 a[24:27], a[224:227], v[234:237], a[24:27]
    v_exp_f32 v225, v225
    v_mfma_f32_16x16x32_bf16 a[28:31], a[228:231], v[234:237], a[28:31]
    v_cvt_pk_bf16_f32 v240, v222, v223
    v_cvt_pk_bf16_f32 v241, v224, v225
    v_mfma_f32_16x16x32_bf16 v[226:229], a[160:163], v[26:29], v[10:13]
    ds_read_b128 a[196:199], v1 offset:17472
    ds_read_b128 a[148:151], v1 offset:17536
    v_mfma_f32_16x16x32_bf16 v[226:229], a[164:167], v[30:33], v[226:229]
    ds_read_b128 a[152:155], v1 offset:17600
    ds_read_b128 a[156:159], v1 offset:21760
    v_mfma_f32_16x16x32_bf16 v[226:229], a[168:171], v[34:37], v[226:229]
    v_mfma_f32_16x16x32_bf16 v[226:229], a[172:175], v[38:41], v[226:229]
    v_mfma_f32_16x16x32_bf16 v[230:233], a[176:179], v[26:29], v[10:13]
    s_waitcnt lgkmcnt(4)
    v_mfma_f32_16x16x32_bf16 v[230:233], a[180:183], v[30:33], v[230:233]
    v_mfma_f32_16x16x32_bf16 v[230:233], a[184:187], v[34:37], v[230:233]
    v_mfma_f32_16x16x32_bf16 v[230:233], a[188:191], v[38:41], v[230:233]
    v_smfmac_f32_16x16x64_bf16 a[100:103], a[116:119], v[234:241], v7
    v_mfma_f32_16x16x32_bf16 a[32:35], a[200:203], v[238:241], a[32:35]
    ds_read_b64_tr_b16 a[200:201], v2 offset:59328
    ds_read_b64_tr_b16 a[202:203], v2 offset:59840
    v_mfma_f32_16x16x32_bf16 a[36:39], a[204:207], v[238:241], a[36:39]
    v_exp_f32 v226, v226
    v_mfma_f32_16x16x32_bf16 a[40:43], a[208:211], v[238:241], a[40:43]
    v_exp_f32 v227, v227
    v_mfma_f32_16x16x32_bf16 a[44:47], a[212:215], v[238:241], a[44:47]
    v_exp_f32 v228, v228
    v_mfma_f32_16x16x32_bf16 a[48:51], a[216:219], v[238:241], a[48:51]
    v_exp_f32 v229, v229
    v_mfma_f32_16x16x32_bf16 a[52:55], a[220:223], v[238:241], a[52:55]
    v_exp_f32 v230, v230
    v_mfma_f32_16x16x32_bf16 a[56:59], a[224:227], v[238:241], a[56:59]
    v_exp_f32 v231, v231
    v_mfma_f32_16x16x32_bf16 a[60:63], a[228:231], v[238:241], a[60:63]
    v_exp_f32 v232, v232
    v_mfma_f32_16x16x32_bf16 v[218:221], a[160:163], v[42:45], v[14:17]
    v_cvt_pk_bf16_f32 v242, v226, v227
    v_cvt_pk_bf16_f32 v243, v228, v229
    v_mfma_f32_16x16x32_bf16 v[218:221], a[164:167], v[46:49], v[218:221]
    v_exp_f32 v233, v233
    v_mfma_f32_16x16x32_bf16 v[218:221], a[168:171], v[50:53], v[218:221]
    v_cvt_pk_bf16_f32 v244, v230, v231
    v_cvt_pk_bf16_f32 v245, v232, v233
    v_mfma_f32_16x16x32_bf16 v[218:221], a[172:175], v[54:57], v[218:221]
    ds_read_b64_tr_b16 a[204:205], v2 offset:59360
    ds_read_b64_tr_b16 a[206:207], v2 offset:59872
    v_mfma_f32_16x16x32_bf16 v[222:225], a[176:179], v[42:45], v[14:17]
    v_mfma_f32_16x16x32_bf16 v[222:225], a[180:183], v[46:49], v[222:225]
    v_mfma_f32_16x16x32_bf16 v[222:225], a[184:187], v[50:53], v[222:225]
    v_mfma_f32_16x16x32_bf16 v[222:225], a[188:191], v[54:57], v[222:225]
    v_mfma_f32_16x16x32_bf16 a[96:99], a[128:131], v[242:245], a[96:99]
    v_mfma_f32_16x16x32_bf16 v[90:93], a[232:235], v[242:245], v[90:93]
    v_exp_f32 v218, v218
    v_mfma_f32_16x16x32_bf16 v[94:97], a[236:239], v[242:245], v[94:97]
    v_exp_f32 v219, v219
    v_mfma_f32_16x16x32_bf16 v[98:101], a[240:243], v[242:245], v[98:101]
    v_exp_f32 v220, v220
    v_mfma_f32_16x16x32_bf16 v[102:105], a[244:247], v[242:245], v[102:105]
    v_exp_f32 v221, v221
    v_mfma_f32_16x16x32_bf16 v[106:109], a[248:251], v[242:245], v[106:109]
    v_exp_f32 v222, v222
    v_mfma_f32_16x16x32_bf16 v[110:113], a[252:255], v[242:245], v[110:113]
    s_waitcnt lgkmcnt(0)
    v_exp_f32 v223, v223
    v_mfma_f32_16x16x32_bf16 v[114:117], a[200:203], v[242:245], v[114:117]
    v_exp_f32 v224, v224
    v_mfma_f32_16x16x32_bf16 v[118:121], a[204:207], v[242:245], v[118:121]
    v_cvt_pk_bf16_f32 v246, v218, v219
    v_cvt_pk_bf16_f32 v247, v220, v221
    v_mfma_f32_16x16x32_bf16 v[154:157], a[134:137], a[64:67], 0
    v_exp_f32 v225, v225
    v_mfma_f32_16x16x32_bf16 v[154:157], a[140:143], a[64:67], v[154:157]
    v_cvt_pk_bf16_f32 v248, v222, v223
    v_cvt_pk_bf16_f32 v249, v224, v225
    v_mfma_f32_16x16x32_bf16 v[158:161], a[132:135], a[64:67], 0
    v_accvgpr_read_b32 v8, a96
    v_accvgpr_read_b32 v255, a97
    v_mfma_f32_16x16x32_bf16 v[158:161], a[142:145], a[64:67], v[158:161]
    s_waitcnt vmcnt(16)
    ds_read_b128 a[64:67], v6 offset:0
    v_add_f32 v8, v8, v255
    v_mfma_f32_16x16x32_bf16 v[162:165], a[134:137], a[68:71], 0
    v_cvt_pk_bf16_f32 v26, v154, v155
    v_cvt_pk_bf16_f32 v27, v156, v157
    v_mfma_f32_16x16x32_bf16 v[162:165], a[140:143], a[68:71], v[162:165]
    v_cmp_nle_f32_e64 s[38:39], v8, s35
    v_cvt_pk_bf16_f32 v28, v158, v159
    v_mfma_f32_16x16x32_bf16 v[166:169], a[132:135], a[68:71], 0
    v_cvt_pk_bf16_f32 v29, v160, v161
    v_mfma_f32_16x16x32_bf16 v[166:169], a[142:145], a[68:71], v[166:169]
    s_or_b64 s[36:37], s[36:37], s[38:39]
    v_rcp_f32 v8, v8
    v_mfma_f32_16x16x32_bf16 v[170:173], a[134:137], a[72:75], 0
    v_cvt_pk_bf16_f32 v30, v162, v163
    v_cvt_pk_bf16_f32 v31, v164, v165
    v_mfma_f32_16x16x32_bf16 v[170:173], a[140:143], a[72:75], v[170:173]
    v_mul_f32 v90, v90, v8
    v_mul_f32 v91, v91, v8
    v_mfma_f32_16x16x32_bf16 v[174:177], a[132:135], a[72:75], 0
    v_cvt_pk_bf16_f32 v32, v166, v167
    v_cvt_pk_bf16_f32 v33, v168, v169
    v_mfma_f32_16x16x32_bf16 v[174:177], a[142:145], a[72:75], v[174:177]
    v_mul_f32 v98, v98, v8
    v_mul_f32 v99, v99, v8
    v_mfma_f32_16x16x32_bf16 v[178:181], a[134:137], a[76:79], 0
    v_cvt_pk_bf16_f32 v34, v170, v171
    v_cvt_pk_bf16_f32 v35, v172, v173
    v_mfma_f32_16x16x32_bf16 v[178:181], a[140:143], a[76:79], v[178:181]
    v_mul_f32 v92, v92, v8
    v_mul_f32 v93, v93, v8
    v_mfma_f32_16x16x32_bf16 v[182:185], a[132:135], a[76:79], 0
    v_cvt_pk_bf16_f32 v36, v174, v175
    v_cvt_pk_bf16_f32 v37, v176, v177
    v_mfma_f32_16x16x32_bf16 v[182:185], a[142:145], a[76:79], v[182:185]
    v_cvt_pk_bf16_f32 v90, v90, v91
    v_mul_f32 v100, v100, v8
    v_mfma_f32_16x16x32_bf16 v[226:229], a[160:163], v[58:61], v[18:21]
    v_cvt_pk_bf16_f32 v38, v178, v179
    v_cvt_pk_bf16_f32 v39, v180, v181
    v_mfma_f32_16x16x32_bf16 v[226:229], a[164:167], v[62:65], v[226:229]
    v_mul_f32 v101, v101, v8
    v_cvt_pk_bf16_f32 v98, v98, v99
    v_mfma_f32_16x16x32_bf16 v[226:229], a[168:171], v[66:69], v[226:229]
    v_cvt_pk_bf16_f32 v40, v182, v183
    v_cvt_pk_bf16_f32 v41, v184, v185
    v_mfma_f32_16x16x32_bf16 v[226:229], a[172:175], v[70:73], v[226:229]
    v_mul_f32 v94, v94, v8
    v_mul_f32 v95, v95, v8
    v_mfma_f32_16x16x32_bf16 v[230:233], a[176:179], v[58:61], v[18:21]
    v_mul_f32 v96, v96, v8
    v_mul_f32 v97, v97, v8
    v_mfma_f32_16x16x32_bf16 v[230:233], a[180:183], v[62:65], v[230:233]
    v_cvt_pk_bf16_f32 v91, v92, v93
    v_mul_f32 v102, v102, v8
    v_mfma_f32_16x16x32_bf16 v[230:233], a[184:187], v[66:69], v[230:233]
    v_exp_f32 v226, v226
    v_mfma_f32_16x16x32_bf16 v[230:233], a[188:191], v[70:73], v[230:233]
    v_exp_f32 v227, v227
    v_mfma_f32_16x16x32_bf16 a[96:99], a[112:115], v[246:249], a[96:99]
    v_exp_f32 v228, v228
    v_mfma_f32_16x16x32_bf16 v[122:125], a[232:235], v[246:249], v[122:125]
    v_exp_f32 v229, v229
    v_mfma_f32_16x16x32_bf16 v[126:129], a[236:239], v[246:249], v[126:129]
    v_cvt_pk_bf16_f32 v234, v226, v227
    v_cvt_pk_bf16_f32 v235, v228, v229
    v_mfma_f32_16x16x32_bf16 v[130:133], a[240:243], v[246:249], v[130:133]
    v_exp_f32 v230, v230
    v_mfma_f32_16x16x32_bf16 v[134:137], a[244:247], v[246:249], v[134:137]
    v_exp_f32 v231, v231
    v_mfma_f32_16x16x32_bf16 v[138:141], a[248:251], v[246:249], v[138:141]
    v_exp_f32 v232, v232
    v_mfma_f32_16x16x32_bf16 v[142:145], a[252:255], v[246:249], v[142:145]
    v_exp_f32 v233, v233
    v_mfma_f32_16x16x32_bf16 v[146:149], a[200:203], v[246:249], v[146:149]
    v_cvt_pk_bf16_f32 v236, v230, v231
    v_cvt_pk_bf16_f32 v237, v232, v233
    v_mfma_f32_16x16x32_bf16 v[150:153], a[204:207], v[246:249], v[150:153]
    v_mul_f32 v103, v103, v8
    v_mul_f32 v104, v104, v8
    v_mfma_f32_16x16x32_bf16 v[218:221], a[160:163], v[74:77], v[22:25]
    ds_read_b128 a[160:163], v1 offset:21824
    v_mul_f32 v105, v105, v8
    v_mfma_f32_16x16x32_bf16 v[218:221], a[164:167], v[78:81], v[218:221]
    ds_read_b128 a[164:167], v1 offset:21888
    v_cvt_pk_bf16_f32 v99, v100, v101
    v_mfma_f32_16x16x32_bf16 v[218:221], a[168:171], v[82:85], v[218:221]
    ds_read_b128 a[168:171], v1 offset:21952
    v_cvt_pk_bf16_f32 v92, v94, v95
    v_mfma_f32_16x16x32_bf16 v[218:221], a[172:175], v[86:89], v[218:221]
    v_cvt_pk_bf16_f32 v93, v96, v97
    v_cvt_pk_bf16_f32 v100, v102, v103
    v_mfma_f32_16x16x32_bf16 v[222:225], a[176:179], v[74:77], v[22:25]
    v_cvt_pk_bf16_f32 v101, v104, v105
    v_mul_f32 v106, v106, v8
    v_mfma_f32_16x16x32_bf16 v[222:225], a[180:183], v[78:81], v[222:225]
    v_permlane16_swap_b32 v90, v92
    v_mfma_f32_16x16x32_bf16 v[222:225], a[184:187], v[82:85], v[222:225]
    v_exp_f32 v218, v218
    v_mfma_f32_16x16x32_bf16 v[222:225], a[188:191], v[86:89], v[222:225]
    v_exp_f32 v219, v219
    v_mfma_f32_16x16x32_bf16 a[0:3], a[232:235], v[234:237], a[0:3]
    v_exp_f32 v220, v220
    v_mfma_f32_16x16x32_bf16 a[4:7], a[236:239], v[234:237], a[4:7]
    v_exp_f32 v221, v221
    v_mfma_f32_16x16x32_bf16 a[8:11], a[240:243], v[234:237], a[8:11]
    v_cvt_pk_bf16_f32 v238, v218, v219
    v_cvt_pk_bf16_f32 v239, v220, v221
    v_mfma_f32_16x16x32_bf16 a[12:15], a[244:247], v[234:237], a[12:15]
    v_exp_f32 v222, v222
    v_mfma_f32_16x16x32_bf16 a[16:19], a[248:251], v[234:237], a[16:19]
    v_exp_f32 v223, v223
    v_mfma_f32_16x16x32_bf16 a[20:23], a[252:255], v[234:237], a[20:23]
    v_exp_f32 v224, v224
    v_mfma_f32_16x16x32_bf16 a[24:27], a[200:203], v[234:237], a[24:27]
    v_exp_f32 v225, v225
    v_mfma_f32_16x16x32_bf16 a[28:31], a[204:207], v[234:237], a[28:31]
    v_cvt_pk_bf16_f32 v240, v222, v223
    v_cvt_pk_bf16_f32 v241, v224, v225
    s_waitcnt vmcnt(2)
    s_barrier
    s_add_u32 m0, s33, 52224
    ds_read_b64_tr_b16 a[208:209], v2 offset:0
    ds_read_b64_tr_b16 a[210:211], v2 offset:512
    v_mfma_f32_16x16x32_bf16 v[154:157], a[192:195], v[26:29], 0
    ds_read_b64_tr_b16 a[212:213], v2 offset:32
    ds_read_b64_tr_b16 a[214:215], v2 offset:544
    v_mfma_f32_16x16x32_bf16 v[154:157], a[196:199], v[30:33], v[154:157]
    buffer_load_dwordx4 v3, s[20:23], s54 offen offset:0 lds
    v_mfma_f32_16x16x32_bf16 v[154:157], a[148:151], v[34:37], v[154:157]
    s_add_u32 m0, s33, 52288
    ds_read_b64_tr_b16 a[216:217], v2 offset:64
    ds_read_b64_tr_b16 a[218:219], v2 offset:576
    v_mfma_f32_16x16x32_bf16 v[154:157], a[152:155], v[38:41], v[154:157]
    ds_read_b64_tr_b16 a[220:221], v2 offset:96
    ds_read_b64_tr_b16 a[222:223], v2 offset:608
    v_mfma_f32_16x16x32_bf16 v[226:229], a[192:195], v[58:61], v[18:21]
    ds_read_b64_tr_b16 a[224:225], v2 offset:128
    ds_read_b64_tr_b16 a[226:227], v2 offset:640
    v_mfma_f32_16x16x32_bf16 v[226:229], a[196:199], v[62:65], v[226:229]
    ds_read_b64_tr_b16 a[228:229], v2 offset:160
    ds_read_b64_tr_b16 a[230:231], v2 offset:672
    v_mfma_f32_16x16x32_bf16 v[226:229], a[148:151], v[66:69], v[226:229]
    ds_read_b128 a[172:175], v1 offset:26112
    v_max3_f32 v12, v154, v155, v156
    v_mfma_f32_16x16x32_bf16 v[226:229], a[152:155], v[70:73], v[226:229]
    buffer_load_dwordx4 v3, s[20:23], s54 offen offset:1024 lds
    v_mfma_f32_16x16x32_bf16 v[230:233], a[156:159], v[58:61], v[18:21]
    s_waitcnt lgkmcnt(9)
    v_max_f32 v10, v12, v157
    v_max_f32 v11, v12, v157
    v_mfma_f32_16x16x32_bf16 v[230:233], a[160:163], v[62:65], v[230:233]
    s_add_u32 m0, s34, 33792
    v_permlane16_swap_b32 v10, v11
    v_mfma_f32_16x16x32_bf16 v[230:233], a[164:167], v[66:69], v[230:233]
    v_exp_f32 v226, v226
    v_mfma_f32_16x16x32_bf16 v[230:233], a[168:171], v[70:73], v[230:233]
    v_exp_f32 v227, v227
    v_smfmac_f32_16x16x64_bf16 a[100:103], a[116:119], v[234:241], v7
    v_cvt_pk_bf16_f32 v242, v226, v227
    v_mfma_f32_16x16x32_bf16 a[32:35], a[232:235], v[238:241], a[32:35]
    buffer_load_dwordx4 v4, s[24:27], s54 offen offset:0 lds
    v_mfma_f32_16x16x32_bf16 a[36:39], a[236:239], v[238:241], a[36:39]
    s_add_u32 m0, s34, 34592
    v_exp_f32 v228, v228
    v_mfma_f32_16x16x32_bf16 a[40:43], a[240:243], v[238:241], a[40:43]
    v_exp_f32 v229, v229
    v_mfma_f32_16x16x32_bf16 a[44:47], a[244:247], v[238:241], a[44:47]
    v_exp_f32 v230, v230
    v_mfma_f32_16x16x32_bf16 a[48:51], a[248:251], v[238:241], a[48:51]
    v_exp_f32 v231, v231
    v_mfma_f32_16x16x32_bf16 a[52:55], a[252:255], v[238:241], a[52:55]
    v_exp_f32 v232, v232
    v_mfma_f32_16x16x32_bf16 a[56:59], a[200:203], v[238:241], a[56:59]
    buffer_load_dwordx4 v4, s[24:27], s54 offen offset:256 lds
    v_mfma_f32_16x16x32_bf16 a[60:63], a[204:207], v[238:241], a[60:63]
    s_add_u32 m0, s33, 0
    ds_read_b64_tr_b16 a[232:233], v2 offset:192
    v_cvt_pk_bf16_f32 v243, v228, v229
    v_mfma_f32_16x16x32_bf16 v[218:221], a[192:195], v[74:77], v[22:25]
    v_exp_f32 v233, v233
    v_mfma_f32_16x16x32_bf16 v[218:221], a[196:199], v[78:81], v[218:221]
    ds_read_b64_tr_b16 a[234:235], v2 offset:704
    v_cvt_pk_bf16_f32 v244, v230, v231
    v_mfma_f32_16x16x32_bf16 v[218:221], a[148:151], v[82:85], v[218:221]
    ds_read_b64_tr_b16 a[236:237], v2 offset:224
    v_cvt_pk_bf16_f32 v245, v232, v233
    v_mfma_f32_16x16x32_bf16 v[218:221], a[152:155], v[86:89], v[218:221]
    ds_read_b64_tr_b16 a[238:239], v2 offset:736
    v_max_f32 v12, v10, v11
    v_mfma_f32_16x16x32_bf16 v[222:225], a[156:159], v[74:77], v[22:25]
    buffer_load_dwordx4 v3, s[20:23], s55 offen offset:0 lds
    v_mfma_f32_16x16x32_bf16 v[222:225], a[160:163], v[78:81], v[222:225]
    s_add_u32 m0, s33, 64
    ds_read_b128 a[176:179], v1 offset:26176
    v_max_f32 v13, v10, v11
    v_mfma_f32_16x16x32_bf16 v[222:225], a[164:167], v[82:85], v[222:225]
    v_exp_f32 v218, v218
    v_mfma_f32_16x16x32_bf16 v[222:225], a[168:171], v[86:89], v[222:225]
    v_exp_f32 v219, v219
    v_mfma_f32_16x16x32_bf16 a[0:3], a[208:211], v[242:245], a[0:3]
    v_permlane32_swap_b32 v12, v13
    v_mfma_f32_16x16x32_bf16 a[4:7], a[212:215], v[242:245], a[4:7]
    s_waitcnt lgkmcnt(3)
    v_exp_f32 v220, v220
    v_mfma_f32_16x16x32_bf16 a[8:11], a[216:219], v[242:245], a[8:11]
    buffer_load_dwordx4 v3, s[20:23], s55 offen offset:1024 lds
    v_mfma_f32_16x16x32_bf16 a[12:15], a[220:223], v[242:245], a[12:15]
    s_add_u32 m0, s34, 42240
    v_min_f32_e64 v10, -v12, -v13
    v_min_f32_e64 v11, -v12, -v13
    v_mfma_f32_16x16x32_bf16 a[16:19], a[224:227], v[242:245], a[16:19]
    v_exp_f32 v221, v221
    v_mfma_f32_16x16x32_bf16 a[20:23], a[228:231], v[242:245], a[20:23]
    v_mov_b32 v12, v10
    v_mov_b32 v13, v10
    v_mfma_f32_16x16x32_bf16 a[24:27], a[232:235], v[242:245], a[24:27]
    s_waitcnt lgkmcnt(0)
    v_exp_f32 v222, v222
    v_mfma_f32_16x16x32_bf16 a[28:31], a[236:239], v[242:245], a[28:31]
    v_exp_f32 v223, v223
    v_mfma_f32_16x16x32_bf16 v[226:229], a[156:159], v[26:29], v[10:13]
    v_exp_f32 v224, v224
    v_mfma_f32_16x16x32_bf16 v[226:229], a[160:163], v[30:33], v[226:229]
    v_cvt_pk_bf16_f32 v246, v218, v219
    v_exp_f32 v225, v225
    v_mfma_f32_16x16x32_bf16 v[226:229], a[164:167], v[34:37], v[226:229]
    buffer_load_dwordx4 v4, s[24:27], s55 offen offset:0 lds
    v_mfma_f32_16x16x32_bf16 v[226:229], a[168:171], v[38:41], v[226:229]
    s_add_u32 m0, s34, 43040
    v_cvt_pk_bf16_f32 v247, v220, v221
    v_cvt_pk_bf16_f32 v248, v222, v223
    v_cvt_pk_bf16_f32 v249, v224, v225
    v_add_f32 v154, v154, v10
    s_nop 0
    v_smfmac_f32_16x16x64_bf16 a[100:103], a[116:119], v[242:249], v7
    ds_read_b128 a[180:183], v1 offset:26240
    v_mfma_f32_16x16x32_bf16 a[32:35], a[208:211], v[246:249], a[32:35]
    ds_read_b128 a[184:187], v1 offset:26304
    ds_read_b128 a[188:191], v1 offset:30464
    v_mfma_f32_16x16x32_bf16 a[36:39], a[212:215], v[246:249], a[36:39]
    buffer_load_dwordx4 v4, s[24:27], s55 offen offset:256 lds
    v_mfma_f32_16x16x32_bf16 a[40:43], a[216:219], v[246:249], a[40:43]
    s_add_u32 m0, s33, 8704
    ds_read_b128 a[192:195], v1 offset:30528
    ds_read_b128 a[196:199], v1 offset:30592
    v_mfma_f32_16x16x32_bf16 a[44:47], a[220:223], v[246:249], a[44:47]
    v_exp_f32 v154, v154
    v_mfma_f32_16x16x32_bf16 a[48:51], a[224:227], v[246:249], a[48:51]
    ds_read_b128 a[148:151], v1 offset:30656
    v_add_f32 v155, v155, v10
    v_mfma_f32_16x16x32_bf16 a[52:55], a[228:231], v[246:249], a[52:55]
    v_exp_f32 v155, v155
    v_mfma_f32_16x16x32_bf16 a[56:59], a[232:235], v[246:249], a[56:59]
    v_add_f32 v156, v156, v10
    v_add_f32 v157, v157, v10
    v_mfma_f32_16x16x32_bf16 a[60:63], a[236:239], v[246:249], a[60:63]
    v_exp_f32 v156, v156
    v_mfma_f32_16x16x32_bf16 v[230:233], a[172:175], v[58:61], v[18:21]
    buffer_load_dwordx4 v3, s[20:23], s56 offen offset:0 lds
    v_mfma_f32_16x16x32_bf16 v[230:233], a[176:179], v[62:65], v[230:233]
    s_waitcnt lgkmcnt(3)
    v_exp_f32 v157, v157
    v_mfma_f32_16x16x32_bf16 v[230:233], a[180:183], v[66:69], v[230:233]
    s_add_u32 m0, s33, 8768
    v_exp_f32 v226, v226
    v_mfma_f32_16x16x32_bf16 v[230:233], a[184:187], v[70:73], v[230:233]
    v_exp_f32 v227, v227
    v_mfma_f32_16x16x32_bf16 v[218:221], a[188:191], v[58:61], v[18:21]
    s_waitcnt lgkmcnt(0)
    v_exp_f32 v228, v228
    v_mfma_f32_16x16x32_bf16 v[218:221], a[192:195], v[62:65], v[218:221]
    v_cvt_pk_bf16_f32 v234, v154, v155
    v_exp_f32 v229, v229
    v_mfma_f32_16x16x32_bf16 v[218:221], a[196:199], v[66:69], v[218:221]
    v_cvt_pk_bf16_f32 v235, v156, v157
    v_cvt_pk_bf16_f32 v236, v226, v227
    v_mfma_f32_16x16x32_bf16 v[218:221], a[148:151], v[70:73], v[218:221]
    buffer_load_dwordx4 v3, s[20:23], s56 offen offset:1024 lds
    v_cvt_pk_bf16_f32 v237, v228, v229
    s_add_u32 m0, s34, 50688
    s_nop 0
    v_mfma_f32_16x16x32_bf16 a[104:107], a[128:131], v[234:237], a[104:107]
    v_exp_f32 v230, v230
    v_mfma_f32_16x16x32_bf16 v[154:157], a[208:211], v[234:237], 0
    v_exp_f32 v231, v231
    v_mfma_f32_16x16x32_bf16 v[158:161], a[212:215], v[234:237], 0
    ds_read_b64_tr_b16 a[240:241], v2 offset:8448
    ds_read_b64_tr_b16 a[242:243], v2 offset:8960
    v_mfma_f32_16x16x32_bf16 v[162:165], a[216:219], v[234:237], 0
    buffer_load_dwordx4 v4, s[24:27], s56 offen offset:0 lds
    v_mfma_f32_16x16x32_bf16 v[166:169], a[220:223], v[234:237], 0
    s_add_u32 m0, s34, 51488
    v_exp_f32 v232, v232
    v_mfma_f32_16x16x32_bf16 v[170:173], a[224:227], v[234:237], 0
    ds_read_b64_tr_b16 a[244:245], v2 offset:8480
    ds_read_b64_tr_b16 a[246:247], v2 offset:8992
    v_mfma_f32_16x16x32_bf16 v[174:177], a[228:231], v[234:237], 0
    v_exp_f32 v233, v233
    v_mfma_f32_16x16x32_bf16 v[178:181], a[232:235], v[234:237], 0
    ds_read_b64_tr_b16 a[248:249], v2 offset:8512
    ds_read_b64_tr_b16 a[250:251], v2 offset:9024
    v_mfma_f32_16x16x32_bf16 v[182:185], a[236:239], v[234:237], 0
    v_exp_f32 v218, v218
    v_mfma_f32_16x16x32_bf16 v[222:225], a[172:175], v[74:77], v[22:25]
    buffer_load_dwordx4 v4, s[24:27], s56 offen offset:256 lds
    v_mfma_f32_16x16x32_bf16 v[222:225], a[176:179], v[78:81], v[222:225]
    ds_read_b64_tr_b16 a[252:253], v2 offset:8544
    ds_read_b64_tr_b16 a[254:255], v2 offset:9056
    v_mfma_f32_16x16x32_bf16 v[222:225], a[180:183], v[82:85], v[222:225]
    v_exp_f32 v219, v219
    v_mfma_f32_16x16x32_bf16 v[222:225], a[184:187], v[86:89], v[222:225]
    ds_read_b64_tr_b16 a[200:201], v2 offset:8576
    ds_read_b64_tr_b16 a[202:203], v2 offset:9088
    v_mfma_f32_16x16x32_bf16 v[226:229], a[188:191], v[74:77], v[22:25]
    v_exp_f32 v220, v220
    v_mfma_f32_16x16x32_bf16 v[226:229], a[192:195], v[78:81], v[226:229]
    ds_read_b64_tr_b16 a[204:205], v2 offset:8608
    ds_read_b64_tr_b16 a[206:207], v2 offset:9120
    v_mfma_f32_16x16x32_bf16 v[226:229], a[196:199], v[82:85], v[226:229]
    ds_read_b64_tr_b16 a[208:209], v2 offset:8640
    ds_read_b64_tr_b16 a[210:211], v2 offset:9152
    v_exp_f32 v221, v221
    v_mfma_f32_16x16x32_bf16 v[226:229], a[148:151], v[86:89], v[226:229]
    s_waitcnt lgkmcnt(8)
    ds_read_b64_tr_b16 a[212:213], v2 offset:8672
    ds_read_b64_tr_b16 a[214:215], v2 offset:9184
    v_cvt_pk_bf16_f32 v242, v230, v231
    v_cvt_pk_bf16_f32 v243, v232, v233
    v_cvt_pk_bf16_f32 v244, v218, v219
    v_cvt_pk_bf16_f32 v245, v220, v221
    v_exp_f32 v222, v222
    s_nop 0
    v_mfma_f32_16x16x32_bf16 a[0:3], a[240:243], v[242:245], a[0:3]
    v_exp_f32 v223, v223
    v_mfma_f32_16x16x32_bf16 a[4:7], a[244:247], v[242:245], a[4:7]
    v_exp_f32 v224, v224
    v_mfma_f32_16x16x32_bf16 a[8:11], a[248:251], v[242:245], a[8:11]
    s_waitcnt lgkmcnt(8)
    v_exp_f32 v225, v225
    v_mfma_f32_16x16x32_bf16 a[12:15], a[252:255], v[242:245], a[12:15]
    s_waitcnt lgkmcnt(6)
    v_exp_f32 v226, v226
    v_mfma_f32_16x16x32_bf16 a[16:19], a[200:203], v[242:245], a[16:19]
    s_waitcnt lgkmcnt(4)
    v_exp_f32 v227, v227
    v_mfma_f32_16x16x32_bf16 a[20:23], a[204:207], v[242:245], a[20:23]
    s_waitcnt lgkmcnt(2)
    v_exp_f32 v228, v228
    v_mfma_f32_16x16x32_bf16 a[24:27], a[208:211], v[242:245], a[24:27]
    s_waitcnt lgkmcnt(0)
    v_cvt_pk_bf16_f32 v246, v222, v223
    v_cvt_pk_bf16_f32 v247, v224, v225
    v_mfma_f32_16x16x32_bf16 a[28:31], a[212:215], v[242:245], a[28:31]
    v_exp_f32 v229, v229
    v_mfma_f32_16x16x32_bf16 v[186:189], a[134:137], a[80:83], 0
    v_cvt_pk_bf16_f32 v248, v226, v227
    v_cvt_pk_bf16_f32 v249, v228, v229
    v_mfma_f32_16x16x32_bf16 v[186:189], a[140:143], a[80:83], v[186:189]
    v_permlane16_swap_b32 v91, v93
    v_mfma_f32_16x16x32_bf16 v[190:193], a[132:135], a[80:83], 0
    v_permlane16_swap_b32 v98, v100
    v_mfma_f32_16x16x32_bf16 v[190:193], a[142:145], a[80:83], v[190:193]
    v_permlane16_swap_b32 v99, v101
    v_mfma_f32_16x16x32_bf16 v[194:197], a[134:137], a[84:87], 0
    buffer_store_dwordx4 v[90:93], v0, s[28:31], s40 offen offset:0 sc0 sc1
    v_mul_f32 v107, v107, v8
    v_mfma_f32_16x16x32_bf16 v[194:197], a[140:143], a[84:87], v[194:197]
    buffer_store_dwordx4 v[98:101], v0, s[28:31], s40 offen offset:64 sc0 sc1
    v_cvt_pk_bf16_f32 v42, v186, v187
    v_mfma_f32_16x16x32_bf16 v[198:201], a[132:135], a[84:87], 0
    ds_read_b128 a[152:155], v1 offset:34816
    ds_read_b128 a[156:159], v1 offset:34880
    v_mfma_f32_16x16x32_bf16 v[198:201], a[142:145], a[84:87], v[198:201]
    ds_read_b128 a[160:163], v1 offset:34944
    v_cvt_pk_bf16_f32 v43, v188, v189
    v_mfma_f32_16x16x32_bf16 v[202:205], a[134:137], a[88:91], 0
    ds_read_b128 a[164:167], v1 offset:35008
    v_cvt_pk_bf16_f32 v44, v190, v191
    v_mfma_f32_16x16x32_bf16 v[202:205], a[140:143], a[88:91], v[202:205]
    v_cvt_pk_bf16_f32 v45, v192, v193
    v_cvt_pk_bf16_f32 v46, v194, v195
    v_mfma_f32_16x16x32_bf16 v[206:209], a[132:135], a[88:91], 0
    v_cvt_pk_bf16_f32 v47, v196, v197
    v_cvt_pk_bf16_f32 v48, v198, v199
    v_mfma_f32_16x16x32_bf16 v[206:209], a[142:145], a[88:91], v[206:209]
    ds_read_b128 a[168:171], v1 offset:39168
    v_cvt_pk_bf16_f32 v49, v200, v201
    v_mfma_f32_16x16x32_bf16 v[210:213], a[134:137], a[92:95], 0
    v_cvt_pk_bf16_f32 v50, v202, v203
    v_cvt_pk_bf16_f32 v51, v204, v205
    v_mfma_f32_16x16x32_bf16 v[210:213], a[140:143], a[92:95], v[210:213]
    v_mul_f32 v114, v114, v8
    v_mul_f32 v115, v115, v8
    v_mfma_f32_16x16x32_bf16 v[214:217], a[132:135], a[92:95], 0
    v_cvt_pk_bf16_f32 v52, v206, v207
    v_cvt_pk_bf16_f32 v53, v208, v209
    v_mfma_f32_16x16x32_bf16 v[214:217], a[142:145], a[92:95], v[214:217]
    ds_read_b64_tr_b16 a[216:217], v2 offset:16896
    v_mul_f32 v108, v108, v8
    v_mfma_f32_16x16x32_bf16 v[230:233], a[172:175], v[26:29], v[10:13]
    v_cvt_pk_bf16_f32 v54, v210, v211
    v_cvt_pk_bf16_f32 v55, v212, v213
    v_mfma_f32_16x16x32_bf16 v[230:233], a[176:179], v[30:33], v[230:233]
    ds_read_b128 a[172:175], v1 offset:39232
    ds_read_b128 a[176:179], v1 offset:39296
    v_mfma_f32_16x16x32_bf16 v[230:233], a[180:183], v[34:37], v[230:233]
    v_cvt_pk_bf16_f32 v56, v214, v215
    v_cvt_pk_bf16_f32 v57, v216, v217
    v_mfma_f32_16x16x32_bf16 v[230:233], a[184:187], v[38:41], v[230:233]
    ds_read_b128 a[180:183], v1 offset:39360
    ds_read_b64_tr_b16 a[218:219], v2 offset:17408
    v_mfma_f32_16x16x32_bf16 v[218:221], a[188:191], v[26:29], v[10:13]
    ds_read_b64_tr_b16 a[220:221], v2 offset:16928
    v_mul_f32 v109, v109, v8
    v_mfma_f32_16x16x32_bf16 v[218:221], a[192:195], v[30:33], v[218:221]
    ds_read_b64_tr_b16 a[222:223], v2 offset:17440
    v_cvt_pk_bf16_f32 v106, v106, v107
    v_mfma_f32_16x16x32_bf16 v[218:221], a[196:199], v[34:37], v[218:221]
    v_exp_f32 v230, v230
    v_mfma_f32_16x16x32_bf16 v[218:221], a[148:151], v[38:41], v[218:221]
    v_exp_f32 v231, v231
    v_smfmac_f32_16x16x64_bf16 a[100:103], a[116:119], v[242:249], v7
    v_cvt_pk_bf16_f32 v234, v230, v231
    v_mfma_f32_16x16x32_bf16 a[32:35], a[240:243], v[246:249], a[32:35]
    v_exp_f32 v232, v232
    v_mfma_f32_16x16x32_bf16 a[36:39], a[244:247], v[246:249], a[36:39]
    v_exp_f32 v233, v233
    v_mfma_f32_16x16x32_bf16 a[40:43], a[248:251], v[246:249], a[40:43]
    v_exp_f32 v218, v218
    v_mfma_f32_16x16x32_bf16 a[44:47], a[252:255], v[246:249], a[44:47]
    v_exp_f32 v219, v219
    v_mfma_f32_16x16x32_bf16 a[48:51], a[200:203], v[246:249], a[48:51]
    v_exp_f32 v220, v220
    v_mfma_f32_16x16x32_bf16 a[52:55], a[204:207], v[246:249], a[52:55]
    v_cvt_pk_bf16_f32 v235, v232, v233
    v_cvt_pk_bf16_f32 v236, v218, v219
    v_mfma_f32_16x16x32_bf16 a[56:59], a[208:211], v[246:249], a[56:59]
    v_exp_f32 v221, v221
    v_mfma_f32_16x16x32_bf16 a[60:63], a[212:215], v[246:249], a[60:63]
    s_waitcnt lgkmcnt(0)
    v_cvt_pk_bf16_f32 v237, v220, v221
    v_mul_f32 v116, v116, v8
    v_mfma_f32_16x16x32_bf16 v[186:189], a[152:155], v[42:45], 0
    ds_read_b64_tr_b16 a[224:225], v2 offset:16960
    v_mul_f32 v117, v117, v8
    v_mfma_f32_16x16x32_bf16 v[186:189], a[156:159], v[46:49], v[186:189]
L_pad5:
    s_cbranch_vccnz L_pad9
    ds_read_b64_tr_b16 a[226:227], v2 offset:17472
    v_cvt_pk_bf16_f32 v114, v114, v115
    v_mfma_f32_16x16x32_bf16 v[186:189], a[160:163], v[50:53], v[186:189]
    ds_read_b64_tr_b16 a[228:229], v2 offset:16992
    v_mul_f32 v110, v110, v8
    v_mfma_f32_16x16x32_bf16 v[186:189], a[164:167], v[54:57], v[186:189]
    ds_read_b64_tr_b16 a[230:231], v2 offset:17504
    v_mul_f32 v111, v111, v8
    v_mfma_f32_16x16x32_bf16 v[222:225], a[152:155], v[58:61], v[18:21]
    ds_read_b64_tr_b16 a[232:233], v2 offset:17024
    v_mul_f32 v112, v112, v8
    v_mfma_f32_16x16x32_bf16 v[222:225], a[156:159], v[62:65], v[222:225]
    ds_read_b64_tr_b16 a[234:235], v2 offset:17536
    v_mul_f32 v113, v113, v8
    v_mfma_f32_16x16x32_bf16 v[222:225], a[160:163], v[66:69], v[222:225]
    ds_read_b64_tr_b16 a[236:237], v2 offset:17056
    v_cvt_pk_bf16_f32 v107, v108, v109
    v_mfma_f32_16x16x32_bf16 v[222:225], a[164:167], v[70:73], v[222:225]
    ds_read_b64_tr_b16 a[238:239], v2 offset:17568
    v_mul_f32 v118, v118, v8
    v_mfma_f32_16x16x32_bf16 v[226:229], a[168:171], v[58:61], v[18:21]
    v_mul_f32 v119, v119, v8
    v_mul_f32 v120, v120, v8
    v_mfma_f32_16x16x32_bf16 v[226:229], a[172:175], v[62:65], v[226:229]
    v_mul_f32 v121, v121, v8
    v_cvt_pk_bf16_f32 v115, v116, v117
    v_mfma_f32_16x16x32_bf16 v[226:229], a[176:179], v[66:69], v[226:229]
    v_exp_f32 v222, v222
    v_mfma_f32_16x16x32_bf16 v[226:229], a[180:183], v[70:73], v[226:229]
    v_exp_f32 v223, v223
    v_mfma_f32_16x16x32_bf16 a[104:107], a[128:131], v[234:237], a[104:107]
    v_exp_f32 v224, v224
    v_mfma_f32_16x16x32_bf16 v[154:157], a[240:243], v[234:237], v[154:157]
    v_exp_f32 v225, v225
    v_mfma_f32_16x16x32_bf16 v[158:161], a[244:247], v[234:237], v[158:161]
    v_cvt_pk_bf16_f32 v238, v222, v223
    v_cvt_pk_bf16_f32 v239, v224, v225
    v_mfma_f32_16x16x32_bf16 v[162:165], a[248:251], v[234:237], v[162:165]
    v_exp_f32 v226, v226
    v_mfma_f32_16x16x32_bf16 v[166:169], a[252:255], v[234:237], v[166:169]
    v_exp_f32 v227, v227
    v_mfma_f32_16x16x32_bf16 v[170:173], a[200:203], v[234:237], v[170:173]
    v_exp_f32 v228, v228
    v_mfma_f32_16x16x32_bf16 v[174:177], a[204:207], v[234:237], v[174:177]
    v_exp_f32 v229, v229
    v_mfma_f32_16x16x32_bf16 v[178:181], a[208:211], v[234:237], v[178:181]
    v_cvt_pk_bf16_f32 v240, v226, v227
    v_cvt_pk_bf16_f32 v241, v228, v229
    v_mfma_f32_16x16x32_bf16 v[182:185], a[212:215], v[234:237], v[182:185]
    ds_read_b64_tr_b16 a[240:241], v2 offset:17088
    ds_read_b64_tr_b16 a[242:243], v2 offset:17600
    v_mfma_f32_16x16x32_bf16 v[230:233], a[152:155], v[74:77], v[22:25]
    ds_read_b64_tr_b16 a[244:245], v2 offset:17120
    ds_read_b64_tr_b16 a[246:247], v2 offset:17632
    v_mfma_f32_16x16x32_bf16 v[230:233], a[156:159], v[78:81], v[230:233]
    v_cvt_pk_bf16_f32 v108, v110, v111
    v_cvt_pk_bf16_f32 v109, v112, v113
    v_mfma_f32_16x16x32_bf16 v[230:233], a[160:163], v[82:85], v[230:233]
    v_cvt_pk_bf16_f32 v116, v118, v119
    v_cvt_pk_bf16_f32 v117, v120, v121
    v_mfma_f32_16x16x32_bf16 v[230:233], a[164:167], v[86:89], v[230:233]
    v_permlane16_swap_b32 v106, v108
    v_mfma_f32_16x16x32_bf16 v[218:221], a[168:171], v[74:77], v[22:25]
    v_permlane16_swap_b32 v107, v109
    v_mfma_f32_16x16x32_bf16 v[218:221], a[172:175], v[78:81], v[218:221]
    v_permlane16_swap_b32 v114, v116
    v_mfma_f32_16x16x32_bf16 v[218:221], a[176:179], v[82:85], v[218:221]
    v_permlane16_swap_b32 v115, v117
    v_mfma_f32_16x16x32_bf16 v[218:221], a[180:183], v[86:89], v[218:221]
    buffer_store_dwordx4 v[106:109], v0, s[28:31], s40 offen offset:128 sc0 sc1
    v_accvgpr_read_b32 v9, a98
    v_mfma_f32_16x16x32_bf16 a[100:103], a[128:131], v[238:241], a[100:103]
    buffer_store_dwordx4 v[114:117], v0, s[28:31], s40 offen offset:192 sc0 sc1
    v_accvgpr_read_b32 v255, a99
    v_mfma_f32_16x16x32_bf16 a[0:3], a[216:219], v[238:241], a[0:3]
    v_exp_f32 v230, v230
    v_mfma_f32_16x16x32_bf16 a[4:7], a[220:223], v[238:241], a[4:7]
    s_waitcnt lgkmcnt(0)
    v_exp_f32 v231, v231
    v_mfma_f32_16x16x32_bf16 a[8:11], a[224:227], v[238:241], a[8:11]
    v_exp_f32 v232, v232
    v_mfma_f32_16x16x32_bf16 a[12:15], a[228:231], v[238:241], a[12:15]
    v_exp_f32 v233, v233
    v_mfma_f32_16x16x32_bf16 a[16:19], a[232:235], v[238:241], a[16:19]
    v_exp_f32 v218, v218
    v_mfma_f32_16x16x32_bf16 a[20:23], a[236:239], v[238:241], a[20:23]
    v_exp_f32 v219, v219
    v_mfma_f32_16x16x32_bf16 a[24:27], a[240:243], v[238:241], a[24:27]
    v_exp_f32 v220, v220
    v_mfma_f32_16x16x32_bf16 a[28:31], a[244:247], v[238:241], a[28:31]
    v_cvt_pk_bf16_f32 v242, v230, v231
    v_cvt_pk_bf16_f32 v243, v232, v233
    v_mfma_f32_16x16x32_bf16 v[222:225], a[152:155], v[26:29], v[10:13]
    v_exp_f32 v221, v221
    v_mfma_f32_16x16x32_bf16 v[222:225], a[156:159], v[30:33], v[222:225]
    v_cvt_pk_bf16_f32 v244, v218, v219
    v_cvt_pk_bf16_f32 v245, v220, v221
    v_mfma_f32_16x16x32_bf16 v[222:225], a[160:163], v[34:37], v[222:225]
    v_add_f32 v9, v9, v255
    v_accvgpr_read_b32 v8, a100
    v_mfma_f32_16x16x32_bf16 v[222:225], a[164:167], v[38:41], v[222:225]
    v_accvgpr_read_b32 v255, a101
    v_max3_f32 v16, v186, v187, v188
    v_mfma_f32_16x16x32_bf16 v[226:229], a[168:171], v[26:29], v[10:13]
    v_max_f32 v14, v16, v189
    v_max_f32 v15, v16, v189
    v_mfma_f32_16x16x32_bf16 v[226:229], a[172:175], v[30:33], v[226:229]
    ds_read_b128 a[184:187], v1 offset:43520
    ds_read_b128 a[188:191], v1 offset:43584
    v_mfma_f32_16x16x32_bf16 v[226:229], a[176:179], v[34:37], v[226:229]
    v_permlane16_swap_b32 v14, v15
    v_mfma_f32_16x16x32_bf16 v[226:229], a[180:183], v[38:41], v[226:229]
    v_max_f32 v16, v14, v15
    v_max_f32 v17, v14, v15
    v_mfma_f32_16x16x32_bf16 a[100:103], a[112:115], v[242:245], a[100:103]
    v_exp_f32 v222, v222
    v_mfma_f32_16x16x32_bf16 a[32:35], a[216:219], v[242:245], a[32:35]
    v_exp_f32 v223, v223
    v_mfma_f32_16x16x32_bf16 a[36:39], a[220:223], v[242:245], a[36:39]
    v_permlane32_swap_b32 v16, v17
    v_mfma_f32_16x16x32_bf16 a[40:43], a[224:227], v[242:245], a[40:43]
    v_exp_f32 v224, v224
    v_mfma_f32_16x16x32_bf16 a[44:47], a[228:231], v[242:245], a[44:47]
    v_min_f32_e64 v14, -v16, -v17
    v_min_f32_e64 v15, -v16, -v17
    v_mfma_f32_16x16x32_bf16 a[48:51], a[232:235], v[242:245], a[48:51]
    v_exp_f32 v225, v225
    v_mfma_f32_16x16x32_bf16 a[52:55], a[236:239], v[242:245], a[52:55]
    v_mov_b32 v16, v14
    v_mov_b32 v17, v14
    v_mfma_f32_16x16x32_bf16 a[56:59], a[240:243], v[242:245], a[56:59]
    v_exp_f32 v226, v226
    v_mfma_f32_16x16x32_bf16 a[60:63], a[244:247], v[242:245], a[60:63]
    v_exp_f32 v227, v227
    v_mfma_f32_16x16x32_bf16 v[230:233], a[168:171], v[42:45], v[14:17]
    v_exp_f32 v228, v228
    v_mfma_f32_16x16x32_bf16 v[230:233], a[172:175], v[46:49], v[230:233]
    v_cvt_pk_bf16_f32 v234, v222, v223
    v_exp_f32 v229, v229
    v_mfma_f32_16x16x32_bf16 v[230:233], a[176:179], v[50:53], v[230:233]
    v_cvt_pk_bf16_f32 v235, v224, v225
    v_cvt_pk_bf16_f32 v236, v226, v227
    v_mfma_f32_16x16x32_bf16 v[230:233], a[180:183], v[54:57], v[230:233]
    ds_read_b128 a[192:195], v1 offset:43648
    v_cvt_pk_bf16_f32 v237, v228, v229
    v_add_f32 v186, v186, v14
    s_nop 0
    v_mfma_f32_16x16x32_bf16 v[154:157], a[216:219], v[234:237], v[154:157]
    ds_read_b128 a[196:199], v1 offset:43712
    ds_read_b128 a[148:151], v1 offset:47872
    v_mfma_f32_16x16x32_bf16 v[158:161], a[220:223], v[234:237], v[158:161]
    ds_read_b128 a[152:155], v1 offset:47936
    ds_read_b128 a[156:159], v1 offset:48000
    v_mfma_f32_16x16x32_bf16 v[162:165], a[224:227], v[234:237], v[162:165]
    v_exp_f32 v186, v186
    v_mfma_f32_16x16x32_bf16 v[166:169], a[228:231], v[234:237], v[166:169]
    ds_read_b128 a[160:163], v1 offset:48064
    v_add_f32 v187, v187, v14
    v_mfma_f32_16x16x32_bf16 v[170:173], a[232:235], v[234:237], v[170:173]
    v_exp_f32 v187, v187
    v_mfma_f32_16x16x32_bf16 v[174:177], a[236:239], v[234:237], v[174:177]
    v_add_f32 v188, v188, v14
    v_add_f32 v189, v189, v14
    v_mfma_f32_16x16x32_bf16 v[178:181], a[240:243], v[234:237], v[178:181]
    v_exp_f32 v188, v188
    v_mfma_f32_16x16x32_bf16 v[182:185], a[244:247], v[234:237], v[182:185]
    v_exp_f32 v189, v189
    s_waitcnt vmcnt(6)
    s_barrier
    s_waitcnt lgkmcnt(3)
    v_exp_f32 v230, v230
    v_mfma_f32_16x16x32_bf16 v[218:221], a[184:187], v[74:77], v[22:25]
    s_add_u32 m0, s33, 17408
    v_exp_f32 v231, v231
    v_mfma_f32_16x16x32_bf16 v[218:221], a[188:191], v[78:81], v[218:221]
    buffer_load_dwordx4 v3, s[20:23], s57 offen offset:0 lds
    v_mfma_f32_16x16x32_bf16 v[218:221], a[192:195], v[82:85], v[218:221]
    s_add_u32 m0, s33, 17472
    v_exp_f32 v232, v232
    v_mfma_f32_16x16x32_bf16 v[218:221], a[196:199], v[86:89], v[218:221]
    v_cvt_pk_bf16_f32 v238, v186, v187
    v_cvt_pk_bf16_f32 v239, v188, v189
    v_mfma_f32_16x16x32_bf16 v[222:225], a[148:151], v[74:77], v[22:25]
    s_waitcnt lgkmcnt(0)
    v_exp_f32 v233, v233
    v_mfma_f32_16x16x32_bf16 v[222:225], a[152:155], v[78:81], v[222:225]
    v_cvt_pk_bf16_f32 v240, v230, v231
    v_cvt_pk_bf16_f32 v241, v232, v233
    v_mfma_f32_16x16x32_bf16 v[222:225], a[156:159], v[82:85], v[222:225]
    v_exp_f32 v218, v218
    v_mfma_f32_16x16x32_bf16 v[222:225], a[160:163], v[86:89], v[222:225]
    buffer_load_dwordx4 v3, s[20:23], s57 offen offset:1024 lds
    v_smfmac_f32_16x16x64_bf16 a[104:107], a[116:119], v[234:241], v7
    s_add_u32 m0, s34, 59136
    v_exp_f32 v219, v219
    v_mfma_f32_16x16x32_bf16 v[186:189], a[216:219], v[238:241], 0
    v_exp_f32 v220, v220
    v_mfma_f32_16x16x32_bf16 v[190:193], a[220:223], v[238:241], 0
    v_exp_f32 v221, v221
    v_mfma_f32_16x16x32_bf16 v[194:197], a[224:227], v[238:241], 0
    v_exp_f32 v222, v222
    v_mfma_f32_16x16x32_bf16 v[198:201], a[228:231], v[238:241], 0
    v_exp_f32 v223, v223
    v_mfma_f32_16x16x32_bf16 v[202:205], a[232:235], v[238:241], 0
    v_cvt_pk_bf16_f32 v242, v218, v219
    v_exp_f32 v224, v224
    v_mfma_f32_16x16x32_bf16 v[206:209], a[236:239], v[238:241], 0
    v_cvt_pk_bf16_f32 v243, v220, v221
    v_exp_f32 v225, v225
    v_mfma_f32_16x16x32_bf16 v[210:213], a[240:243], v[238:241], 0
    buffer_load_dwordx4 v4, s[24:27], s57 offen offset:0 lds
    v_mfma_f32_16x16x32_bf16 v[214:217], a[244:247], v[238:241], 0
    s_add_u32 m0, s34, 59936
    v_cmp_nle_f32_e64 s[48:49], v9, s35
    v_rcp_f32 v9, v9
    v_mfma_f32_16x16x32_bf16 v[226:229], a[184:187], v[26:29], v[10:13]
    v_cvt_pk_bf16_f32 v244, v222, v223
    v_cvt_pk_bf16_f32 v245, v224, v225
    v_mfma_f32_16x16x32_bf16 v[226:229], a[188:191], v[30:33], v[226:229]
    s_or_b64 s[36:37], s[36:37], s[48:49]
    ds_read_b64_tr_b16 a[248:249], v2 offset:25344
    ds_read_b64_tr_b16 a[250:251], v2 offset:25856
    v_mfma_f32_16x16x32_bf16 v[226:229], a[192:195], v[34:37], v[226:229]
    ds_read_b64_tr_b16 a[252:253], v2 offset:25376
    ds_read_b64_tr_b16 a[254:255], v2 offset:25888
    v_mfma_f32_16x16x32_bf16 v[226:229], a[196:199], v[38:41], v[226:229]
    ds_read_b64_tr_b16 a[200:201], v2 offset:25408
    ds_read_b64_tr_b16 a[202:203], v2 offset:25920
    v_mfma_f32_16x16x32_bf16 v[230:233], a[148:151], v[26:29], v[10:13]
    ds_read_b64_tr_b16 a[204:205], v2 offset:25440
    ds_read_b64_tr_b16 a[206:207], v2 offset:25952
    buffer_load_dwordx4 v4, s[24:27], s57 offen offset:256 lds
    v_mfma_f32_16x16x32_bf16 v[230:233], a[152:155], v[30:33], v[230:233]
    s_add_u32 m0, s33, 26112
    ds_read_b64_tr_b16 a[208:209], v2 offset:25472
    ds_read_b64_tr_b16 a[210:211], v2 offset:25984
    v_mfma_f32_16x16x32_bf16 v[230:233], a[156:159], v[34:37], v[230:233]
    ds_read_b64_tr_b16 a[212:213], v2 offset:25504
    ds_read_b64_tr_b16 a[214:215], v2 offset:26016
    v_mfma_f32_16x16x32_bf16 v[230:233], a[160:163], v[38:41], v[230:233]
    ds_read_b64_tr_b16 a[216:217], v2 offset:25536
    ds_read_b64_tr_b16 a[218:219], v2 offset:26048
    v_mfma_f32_16x16x32_bf16 a[100:103], a[112:115], v[242:245], a[100:103]
    s_waitcnt lgkmcnt(12)
    ds_read_b64_tr_b16 a[220:221], v2 offset:25568
    ds_read_b64_tr_b16 a[222:223], v2 offset:26080
    v_mfma_f32_16x16x32_bf16 a[32:35], a[248:251], v[242:245], a[32:35]
    s_waitcnt lgkmcnt(12)
    v_mul_f32 v122, v122, v9
    v_mul_f32 v123, v123, v9
    v_mfma_f32_16x16x32_bf16 a[36:39], a[252:255], v[242:245], a[36:39]
    s_waitcnt lgkmcnt(10)
    buffer_load_dwordx4 v3, s[20:23], s58 offen offset:0 lds
    v_mfma_f32_16x16x32_bf16 a[40:43], a[200:203], v[242:245], a[40:43]
    s_waitcnt lgkmcnt(8)
    v_mul_f32 v130, v130, v9
    v_mul_f32 v131, v131, v9
    v_mul_f32 v124, v124, v9
    v_mul_f32 v125, v125, v9
    v_cvt_pk_bf16_f32 v122, v122, v123
    v_mul_f32 v132, v132, v9
    v_mul_f32 v133, v133, v9
    v_cvt_pk_bf16_f32 v130, v130, v131
    v_mfma_f32_16x16x32_bf16 a[44:47], a[204:207], v[242:245], a[44:47]
    s_waitcnt lgkmcnt(6)
    v_mul_f32 v126, v126, v9
    v_mul_f32 v127, v127, v9
    v_mul_f32 v128, v128, v9
    v_mul_f32 v129, v129, v9
    v_cvt_pk_bf16_f32 v123, v124, v125
    v_mul_f32 v134, v134, v9
    v_mul_f32 v135, v135, v9
    v_mul_f32 v136, v136, v9
    v_mul_f32 v137, v137, v9
    v_cvt_pk_bf16_f32 v131, v132, v133
    v_cvt_pk_bf16_f32 v124, v126, v127
    v_cvt_pk_bf16_f32 v125, v128, v129
    v_cvt_pk_bf16_f32 v132, v134, v135
    v_cvt_pk_bf16_f32 v133, v136, v137
    v_mfma_f32_16x16x32_bf16 a[48:51], a[208:211], v[242:245], a[48:51]
    s_waitcnt lgkmcnt(4)
    ds_read_b128 a[68:71], v6 offset:64
    v_permlane16_swap_b32 v122, v124
    v_mfma_f32_16x16x32_bf16 a[52:55], a[212:215], v[242:245], a[52:55]
    s_waitcnt lgkmcnt(3)
    v_permlane16_swap_b32 v123, v125
    v_permlane16_swap_b32 v130, v132
    v_permlane16_swap_b32 v131, v133
    v_mfma_f32_16x16x32_bf16 a[56:59], a[216:219], v[242:245], a[56:59]
    s_waitcnt lgkmcnt(1)
    ds_read_b128 a[72:75], v6 offset:128
    ds_read_b128 a[76:79], v6 offset:192
    s_add_u32 m0, s33, 26176
    v_mfma_f32_16x16x32_bf16 a[60:63], a[220:223], v[242:245], a[60:63]
    buffer_load_dwordx4 v3, s[20:23], s58 offen offset:1024 lds
    v_mfma_f32_16x16x32_bf16 v[90:93], a[134:137], a[64:67], 0
    s_add_u32 m0, s34, 0
    v_exp_f32 v226, v226
    v_mfma_f32_16x16x32_bf16 v[90:93], a[140:143], a[64:67], v[90:93]
    v_exp_f32 v227, v227
    v_mfma_f32_16x16x32_bf16 v[94:97], a[132:135], a[64:67], 0
    v_exp_f32 v228, v228
    v_mfma_f32_16x16x32_bf16 v[94:97], a[142:145], a[64:67], v[94:97]
    s_waitcnt lgkmcnt(2)
    buffer_load_dwordx4 v4, s[24:27], s58 offen offset:0 lds
    v_mfma_f32_16x16x32_bf16 v[98:101], a[134:137], a[68:71], 0
    s_add_u32 m0, s34, 800
    v_exp_f32 v229, v229
    v_mfma_f32_16x16x32_bf16 v[98:101], a[140:143], a[68:71], v[98:101]
    v_exp_f32 v230, v230
    v_mfma_f32_16x16x32_bf16 v[102:105], a[132:135], a[68:71], 0
    v_exp_f32 v231, v231
    v_mfma_f32_16x16x32_bf16 v[102:105], a[142:145], a[68:71], v[102:105]
    s_waitcnt lgkmcnt(0)
    v_exp_f32 v232, v232
    v_mfma_f32_16x16x32_bf16 v[106:109], a[134:137], a[72:75], 0
    v_cvt_pk_bf16_f32 v234, v226, v227
    v_cvt_pk_bf16_f32 v235, v228, v229
    v_mfma_f32_16x16x32_bf16 v[106:109], a[140:143], a[72:75], v[106:109]
    buffer_load_dwordx4 v4, s[24:27], s58 offen offset:256 lds
    v_mfma_f32_16x16x32_bf16 v[110:113], a[132:135], a[72:75], 0
    s_add_u32 m0, s33, 34816
    v_exp_f32 v233, v233
    v_mfma_f32_16x16x32_bf16 v[110:113], a[142:145], a[72:75], v[110:113]
    v_cvt_pk_bf16_f32 v236, v230, v231
    v_cvt_pk_bf16_f32 v237, v232, v233
    v_mfma_f32_16x16x32_bf16 v[114:117], a[134:137], a[76:79], 0
    ds_read_b128 a[164:167], v1 offset:52224
    ds_read_b128 a[168:171], v1 offset:52288
    v_mfma_f32_16x16x32_bf16 v[114:117], a[140:143], a[76:79], v[114:117]
    ds_read_b128 a[172:175], v1 offset:52352
    v_cvt_pk_bf16_f32 v58, v90, v91
    v_mfma_f32_16x16x32_bf16 v[118:121], a[132:135], a[76:79], 0
    v_cvt_pk_bf16_f32 v59, v92, v93
    v_cvt_pk_bf16_f32 v60, v94, v95
    v_mfma_f32_16x16x32_bf16 v[118:121], a[142:145], a[76:79], v[118:121]
    buffer_load_dwordx4 v3, s[20:23], s59 offen offset:0 lds
    v_mfma_f32_16x16x32_bf16 v[218:221], a[184:187], v[42:45], v[14:17]
    s_add_u32 m0, s33, 34880
    ds_read_b128 a[176:179], v1 offset:52416
    v_cvt_pk_bf16_f32 v61, v96, v97
    v_mfma_f32_16x16x32_bf16 v[218:221], a[188:191], v[46:49], v[218:221]
    v_cvt_pk_bf16_f32 v62, v98, v99
    v_cvt_pk_bf16_f32 v63, v100, v101
    v_mfma_f32_16x16x32_bf16 v[218:221], a[192:195], v[50:53], v[218:221]
    v_cvt_pk_bf16_f32 v64, v102, v103
    v_cvt_pk_bf16_f32 v65, v104, v105
    v_mfma_f32_16x16x32_bf16 v[218:221], a[196:199], v[54:57], v[218:221]
    v_cvt_pk_bf16_f32 v66, v106, v107
    v_cvt_pk_bf16_f32 v67, v108, v109
    v_mfma_f32_16x16x32_bf16 v[222:225], a[148:151], v[42:45], v[14:17]
    v_cvt_pk_bf16_f32 v68, v110, v111
    v_cvt_pk_bf16_f32 v69, v112, v113
    v_mfma_f32_16x16x32_bf16 v[222:225], a[152:155], v[46:49], v[222:225]
    buffer_load_dwordx4 v3, s[20:23], s59 offen offset:1024 lds
    v_mfma_f32_16x16x32_bf16 v[222:225], a[156:159], v[50:53], v[222:225]
    s_add_u32 m0, s34, 8448
    ds_read_b128 a[180:183], v1 offset:56576
    v_cvt_pk_bf16_f32 v70, v114, v115
    v_mfma_f32_16x16x32_bf16 v[222:225], a[160:163], v[54:57], v[222:225]
    v_cvt_pk_bf16_f32 v71, v116, v117
    v_cvt_pk_bf16_f32 v72, v118, v119
    v_mfma_f32_16x16x32_bf16 v[154:157], a[248:251], v[234:237], v[154:157]
    buffer_store_dwordx4 v[122:125], v0, s[28:31], s41 offen offset:0 sc0 sc1
    v_cvt_pk_bf16_f32 v73, v120, v121
    v_mfma_f32_16x16x32_bf16 v[158:161], a[252:255], v[234:237], v[158:161]
    buffer_store_dwordx4 v[130:133], v0, s[28:31], s41 offen offset:64 sc0 sc1
    v_mul_f32 v138, v138, v9
    v_mfma_f32_16x16x32_bf16 v[162:165], a[200:203], v[234:237], v[162:165]
    ds_read_b128 a[184:187], v1 offset:56640
    ds_read_b128 a[188:191], v1 offset:56704
    v_mfma_f32_16x16x32_bf16 v[166:169], a[204:207], v[234:237], v[166:169]
    buffer_load_dwordx4 v4, s[24:27], s59 offen offset:0 lds
    v_mfma_f32_16x16x32_bf16 v[170:173], a[208:211], v[234:237], v[170:173]
    s_add_u32 m0, s34, 9248
    v_exp_f32 v218, v218
    v_mfma_f32_16x16x32_bf16 v[174:177], a[212:215], v[234:237], v[174:177]
    ds_read_b128 a[192:195], v1 offset:56768
    ds_read_b64_tr_b16 a[224:225], v2 offset:33792
    v_mfma_f32_16x16x32_bf16 v[178:181], a[216:219], v[234:237], v[178:181]
    v_exp_f32 v219, v219
    v_mfma_f32_16x16x32_bf16 v[182:185], a[220:223], v[234:237], v[182:185]
    s_waitcnt lgkmcnt(4)
    v_exp_f32 v220, v220
    v_mfma_f32_16x16x32_bf16 v[90:93], a[164:167], v[58:61], 0
    v_exp_f32 v221, v221
    v_mfma_f32_16x16x32_bf16 v[90:93], a[168:171], v[62:65], v[90:93]
    buffer_load_dwordx4 v4, s[24:27], s59 offen offset:256 lds
    v_mfma_f32_16x16x32_bf16 v[90:93], a[172:175], v[66:69], v[90:93]
    v_exp_f32 v222, v222
    v_mfma_f32_16x16x32_bf16 v[90:93], a[176:179], v[70:73], v[90:93]
    v_exp_f32 v223, v223
    v_mfma_f32_16x16x32_bf16 v[226:229], a[164:167], v[26:29], v[10:13]
    v_exp_f32 v224, v224
    v_mfma_f32_16x16x32_bf16 v[226:229], a[168:171], v[30:33], v[226:229]
    v_cvt_pk_bf16_f32 v238, v218, v219
    v_cvt_pk_bf16_f32 v239, v220, v221
    v_mfma_f32_16x16x32_bf16 v[226:229], a[172:175], v[34:37], v[226:229]
    v_exp_f32 v225, v225
    v_mfma_f32_16x16x32_bf16 v[226:229], a[176:179], v[38:41], v[226:229]
    v_cvt_pk_bf16_f32 v240, v222, v223
    v_cvt_pk_bf16_f32 v241, v224, v225
    v_mfma_f32_16x16x32_bf16 v[230:233], a[180:183], v[26:29], v[10:13]
    s_waitcnt lgkmcnt(0)
    ds_read_b64_tr_b16 a[226:227], v2 offset:34304
    ds_read_b64_tr_b16 a[228:229], v2 offset:33824
    v_mfma_f32_16x16x32_bf16 v[230:233], a[184:187], v[30:33], v[230:233]
    ds_read_b64_tr_b16 a[230:231], v2 offset:34336
    ds_read_b64_tr_b16 a[232:233], v2 offset:33856
    v_mfma_f32_16x16x32_bf16 v[230:233], a[188:191], v[34:37], v[230:233]
    v_exp_f32 v226, v226
    v_mfma_f32_16x16x32_bf16 v[230:233], a[192:195], v[38:41], v[230:233]
    v_exp_f32 v227, v227
    v_smfmac_f32_16x16x64_bf16 a[104:107], a[116:119], v[234:241], v7
    ds_read_b64_tr_b16 a[234:235], v2 offset:34368
    v_mfma_f32_16x16x32_bf16 v[186:189], a[248:251], v[238:241], v[186:189]
    v_exp_f32 v228, v228
    v_mfma_f32_16x16x32_bf16 v[190:193], a[252:255], v[238:241], v[190:193]
    v_exp_f32 v229, v229
    v_mfma_f32_16x16x32_bf16 v[194:197], a[200:203], v[238:241], v[194:197]
    v_exp_f32 v230, v230
    v_mfma_f32_16x16x32_bf16 v[198:201], a[204:207], v[238:241], v[198:201]
    ds_read_b64_tr_b16 a[236:237], v2 offset:33888
    ds_read_b64_tr_b16 a[238:239], v2 offset:34400
    v_mfma_f32_16x16x32_bf16 v[202:205], a[208:211], v[238:241], v[202:205]
    v_exp_f32 v231, v231
    v_mfma_f32_16x16x32_bf16 v[206:209], a[212:215], v[238:241], v[206:209]
    ds_read_b64_tr_b16 a[240:241], v2 offset:33920
    ds_read_b64_tr_b16 a[242:243], v2 offset:34432
    v_mfma_f32_16x16x32_bf16 v[210:213], a[216:219], v[238:241], v[210:213]
    v_exp_f32 v232, v232
    v_mfma_f32_16x16x32_bf16 v[214:217], a[220:223], v[238:241], v[214:217]
    ds_read_b64_tr_b16 a[244:245], v2 offset:33952
    v_cvt_pk_bf16_f32 v242, v226, v227
    v_mfma_f32_16x16x32_bf16 v[218:221], a[164:167], v[42:45], v[14:17]
    ds_read_b64_tr_b16 a[246:247], v2 offset:34464
    v_cvt_pk_bf16_f32 v243, v228, v229
    v_mfma_f32_16x16x32_bf16 v[218:221], a[168:171], v[46:49], v[218:221]
    v_exp_f32 v233, v233
    v_mfma_f32_16x16x32_bf16 v[218:221], a[172:175], v[50:53], v[218:221]
    ds_read_b64_tr_b16 a[248:249], v2 offset:33984
    v_cvt_pk_bf16_f32 v244, v230, v231
    v_mfma_f32_16x16x32_bf16 v[218:221], a[176:179], v[54:57], v[218:221]
    ds_read_b64_tr_b16 a[250:251], v2 offset:34496
    v_cvt_pk_bf16_f32 v245, v232, v233
    v_mfma_f32_16x16x32_bf16 v[222:225], a[180:183], v[42:45], v[14:17]
    ds_read_b64_tr_b16 a[252:253], v2 offset:34016
    ds_read_b64_tr_b16 a[254:255], v2 offset:34528
    v_mfma_f32_16x16x32_bf16 v[222:225], a[184:187], v[46:49], v[222:225]
    ds_read_b128 a[196:199], v1 offset:0
    v_max3_f32 v20, v90, v91, v92
    v_mfma_f32_16x16x32_bf16 v[222:225], a[188:191], v[50:53], v[222:225]
    v_max_f32 v18, v20, v93
    v_max_f32 v19, v20, v93
    v_mfma_f32_16x16x32_bf16 v[222:225], a[192:195], v[54:57], v[222:225]
    s_waitcnt lgkmcnt(6)
    v_permlane16_swap_b32 v18, v19
    v_mfma_f32_16x16x32_bf16 v[154:157], a[224:227], v[242:245], v[154:157]
    v_max_f32 v20, v18, v19
    v_max_f32 v21, v18, v19
    v_mfma_f32_16x16x32_bf16 v[158:161], a[228:231], v[242:245], v[158:161]
    v_exp_f32 v218, v218
    v_mfma_f32_16x16x32_bf16 v[162:165], a[232:235], v[242:245], v[162:165]
    v_exp_f32 v219, v219
    v_mfma_f32_16x16x32_bf16 v[166:169], a[236:239], v[242:245], v[166:169]
    v_permlane32_swap_b32 v20, v21
    v_mfma_f32_16x16x32_bf16 v[170:173], a[240:243], v[242:245], v[170:173]
    s_waitcnt lgkmcnt(1)
    v_exp_f32 v220, v220
    v_mfma_f32_16x16x32_bf16 v[174:177], a[244:247], v[242:245], v[174:177]
    v_min_f32_e64 v18, -v20, -v21
    v_exp_f32 v221, v221
    v_mfma_f32_16x16x32_bf16 v[178:181], a[248:251], v[242:245], v[178:181]
    v_min_f32_e64 v19, -v20, -v21
    v_exp_f32 v222, v222
    v_mfma_f32_16x16x32_bf16 v[182:185], a[252:255], v[242:245], v[182:185]
    v_mov_b32 v20, v18
    v_exp_f32 v223, v223
    v_mov_b32 v21, v18
    v_exp_f32 v224, v224
    s_nop 0
    v_mfma_f32_16x16x32_bf16 v[226:229], a[180:183], v[58:61], v[18:21]
    v_cvt_pk_bf16_f32 v246, v218, v219
    v_cvt_pk_bf16_f32 v247, v220, v221
    v_mfma_f32_16x16x32_bf16 v[226:229], a[184:187], v[62:65], v[226:229]
    v_exp_f32 v225, v225
    v_mfma_f32_16x16x32_bf16 v[226:229], a[188:191], v[66:69], v[226:229]
    v_cvt_pk_bf16_f32 v248, v222, v223
    v_cvt_pk_bf16_f32 v249, v224, v225
    v_mfma_f32_16x16x32_bf16 v[226:229], a[192:195], v[70:73], v[226:229]
    ds_read_b128 a[148:151], v1 offset:64
    v_add_f32 v90, v90, v18
    v_smfmac_f32_16x16x64_bf16 a[104:107], a[116:119], v[242:249], v7
    ds_read_b128 a[152:155], v1 offset:128
    v_mfma_f32_16x16x32_bf16 v[186:189], a[224:227], v[246:249], v[186:189]
    v_exp_f32 v90, v90
    v_mfma_f32_16x16x32_bf16 v[190:193], a[228:231], v[246:249], v[190:193]
    ds_read_b128 a[156:159], v1 offset:192
    v_add_f32 v91, v91, v18
    v_mfma_f32_16x16x32_bf16 v[194:197], a[232:235], v[246:249], v[194:197]
    v_exp_f32 v91, v91
    v_mfma_f32_16x16x32_bf16 v[198:201], a[236:239], v[246:249], v[198:201]
    ds_read_b128 a[160:163], v1 offset:4352
    v_add_f32 v92, v92, v18
    v_mfma_f32_16x16x32_bf16 v[202:205], a[240:243], v[246:249], v[202:205]
    v_exp_f32 v92, v92
    v_mfma_f32_16x16x32_bf16 v[206:209], a[244:247], v[246:249], v[206:209]
    ds_read_b128 a[164:167], v1 offset:4416
    v_add_f32 v93, v93, v18
    v_mfma_f32_16x16x32_bf16 v[210:213], a[248:251], v[246:249], v[210:213]
    ds_read_b128 a[168:171], v1 offset:4480
    v_exp_f32 v93, v93
    v_mfma_f32_16x16x32_bf16 v[214:217], a[252:255], v[246:249], v[214:217]
    s_waitcnt lgkmcnt(4)
    ds_read_b128 a[172:175], v1 offset:4544
    v_exp_f32 v226, v226
    v_mfma_f32_16x16x32_bf16 v[230:233], a[196:199], v[26:29], v[10:13]
    v_exp_f32 v227, v227
    v_mfma_f32_16x16x32_bf16 v[230:233], a[148:151], v[30:33], v[230:233]
    v_exp_f32 v228, v228
    v_mfma_f32_16x16x32_bf16 v[230:233], a[152:155], v[34:37], v[230:233]
    s_waitcnt lgkmcnt(4)
    v_cvt_pk_bf16_f32 v234, v90, v91
    v_exp_f32 v229, v229
    v_mfma_f32_16x16x32_bf16 v[230:233], a[156:159], v[38:41], v[230:233]
    s_waitcnt lgkmcnt(3)
    v_cvt_pk_bf16_f32 v235, v92, v93
    v_cvt_pk_bf16_f32 v236, v226, v227
    v_mfma_f32_16x16x32_bf16 v[218:221], a[160:163], v[26:29], v[10:13]
    s_waitcnt lgkmcnt(2)
    v_cvt_pk_bf16_f32 v237, v228, v229
    v_mul_f32 v139, v139, v9
    v_mfma_f32_16x16x32_bf16 v[218:221], a[164:167], v[30:33], v[218:221]
    s_waitcnt lgkmcnt(1)
    v_mul_f32 v146, v146, v9
    v_mul_f32 v147, v147, v9
    v_mfma_f32_16x16x32_bf16 v[218:221], a[168:171], v[34:37], v[218:221]
    s_waitcnt lgkmcnt(0)
    v_mul_f32 v140, v140, v9
    v_mul_f32 v141, v141, v9
    v_mfma_f32_16x16x32_bf16 v[218:221], a[172:175], v[38:41], v[218:221]
    v_cvt_pk_bf16_f32 v138, v138, v139
    v_mul_f32 v148, v148, v9
    v_mfma_f32_16x16x32_bf16 a[108:111], a[128:131], v[234:237], a[108:111]
    v_mul_f32 v149, v149, v9
    v_cvt_pk_bf16_f32 v146, v146, v147
    v_mfma_f32_16x16x32_bf16 v[90:93], a[224:227], v[234:237], 0
    v_mul_f32 v142, v142, v9
    v_mul_f32 v143, v143, v9
    v_mfma_f32_16x16x32_bf16 v[94:97], a[228:231], v[234:237], 0
    v_mul_f32 v144, v144, v9
    v_mul_f32 v145, v145, v9
    v_mfma_f32_16x16x32_bf16 v[98:101], a[232:235], v[234:237], 0
    v_cvt_pk_bf16_f32 v139, v140, v141
    v_mul_f32 v150, v150, v9
    v_mfma_f32_16x16x32_bf16 v[102:105], a[236:239], v[234:237], 0
    v_mul_f32 v151, v151, v9
    v_mul_f32 v152, v152, v9
    v_mfma_f32_16x16x32_bf16 v[106:109], a[240:243], v[234:237], 0
    v_mul_f32 v153, v153, v9
    v_cvt_pk_bf16_f32 v147, v148, v149
    v_mfma_f32_16x16x32_bf16 v[110:113], a[244:247], v[234:237], 0
    v_cvt_pk_bf16_f32 v140, v142, v143
    v_cvt_pk_bf16_f32 v141, v144, v145
    v_mfma_f32_16x16x32_bf16 v[114:117], a[248:251], v[234:237], 0
    v_cvt_pk_bf16_f32 v148, v150, v151
    v_exp_f32 v230, v230
    v_cvt_pk_bf16_f32 v149, v152, v153
    v_mfma_f32_16x16x32_bf16 v[118:121], a[252:255], v[234:237], 0
    v_permlane16_swap_b32 v138, v140
    v_mfma_f32_16x16x32_bf16 v[222:225], a[196:199], v[42:45], v[14:17]
    ds_read_b64_tr_b16 a[200:201], v2 offset:42240
    ds_read_b64_tr_b16 a[202:203], v2 offset:42752
    v_permlane16_swap_b32 v139, v141
    v_permlane16_swap_b32 v146, v148
    v_permlane16_swap_b32 v147, v149
    v_mfma_f32_16x16x32_bf16 v[222:225], a[148:151], v[46:49], v[222:225]
    ds_read_b64_tr_b16 a[204:205], v2 offset:42272
    ds_read_b64_tr_b16 a[206:207], v2 offset:42784
    buffer_store_dwordx4 v[138:141], v0, s[28:31], s41 offen offset:128 sc0 sc1
    v_add_f32 v8, v8, v255
    v_mfma_f32_16x16x32_bf16 v[222:225], a[152:155], v[50:53], v[222:225]
    ds_read_b64_tr_b16 a[208:209], v2 offset:42304
    ds_read_b64_tr_b16 a[210:211], v2 offset:42816
    buffer_store_dwordx4 v[146:149], v0, s[28:31], s41 offen offset:192 sc0 sc1
    v_cmp_nle_f32_e64 s[38:39], v8, s35
    v_mfma_f32_16x16x32_bf16 v[222:225], a[156:159], v[54:57], v[222:225]
    ds_read_b64_tr_b16 a[212:213], v2 offset:42336
    ds_read_b64_tr_b16 a[214:215], v2 offset:42848
    v_mfma_f32_16x16x32_bf16 v[226:229], a[160:163], v[42:45], v[14:17]
    s_or_b64 s[36:37], s[36:37], s[38:39]
    ds_read_b64_tr_b16 a[216:217], v2 offset:42368
    ds_read_b64_tr_b16 a[218:219], v2 offset:42880
    v_mfma_f32_16x16x32_bf16 v[226:229], a[164:167], v[46:49], v[226:229]
    ds_read_b64_tr_b16 a[220:221], v2 offset:42400
    ds_read_b64_tr_b16 a[222:223], v2 offset:42912
    v_mfma_f32_16x16x32_bf16 v[226:229], a[168:171], v[50:53], v[226:229]
    ds_read_b64_tr_b16 a[224:225], v2 offset:42432
    ds_read_b64_tr_b16 a[226:227], v2 offset:42944
    v_exp_f32 v231, v231
    v_exp_f32 v232, v232
    v_exp_f32 v233, v233
    v_exp_f32 v218, v218
    v_exp_f32 v219, v219
    v_exp_f32 v220, v220
    v_exp_f32 v221, v221
    v_mfma_f32_16x16x32_bf16 v[226:229], a[172:175], v[54:57], v[226:229]
    s_waitcnt lgkmcnt(12)
    ds_read_b64_tr_b16 a[228:229], v2 offset:42464
    ds_read_b64_tr_b16 a[230:231], v2 offset:42976
    v_cvt_pk_bf16_f32 v242, v230, v231
    v_cvt_pk_bf16_f32 v243, v232, v233
    v_cvt_pk_bf16_f32 v244, v218, v219
    v_cvt_pk_bf16_f32 v245, v220, v221
    v_exp_f32 v222, v222
    s_nop 0
    v_mfma_f32_16x16x32_bf16 v[154:157], a[200:203], v[242:245], v[154:157]
L_pad6:
    s_cbranch_vccnz L_pad10
    s_waitcnt lgkmcnt(12)
    ds_read_b128 a[80:83], v6 offset:4352
    ds_read_b128 a[84:87], v6 offset:4416
    v_mfma_f32_16x16x32_bf16 v[158:161], a[204:207], v[242:245], v[158:161]
    s_waitcnt lgkmcnt(12)
    ds_read_b128 a[88:91], v6 offset:4480
    ds_read_b128 a[92:95], v6 offset:4544
    v_mfma_f32_16x16x32_bf16 v[162:165], a[208:211], v[242:245], v[162:165]
    s_waitcnt lgkmcnt(12)
    v_exp_f32 v223, v223
    v_mfma_f32_16x16x32_bf16 v[166:169], a[212:215], v[242:245], v[166:169]
    s_waitcnt lgkmcnt(10)
    v_exp_f32 v224, v224
    v_mfma_f32_16x16x32_bf16 v[170:173], a[216:219], v[242:245], v[170:173]
    s_waitcnt lgkmcnt(8)
    v_exp_f32 v225, v225
    v_mfma_f32_16x16x32_bf16 v[174:177], a[220:223], v[242:245], v[174:177]
    s_waitcnt lgkmcnt(6)
    v_exp_f32 v226, v226
    v_mfma_f32_16x16x32_bf16 v[178:181], a[224:227], v[242:245], v[178:181]
    s_waitcnt lgkmcnt(4)
    v_exp_f32 v227, v227
    v_mfma_f32_16x16x32_bf16 v[182:185], a[228:231], v[242:245], v[182:185]
    s_waitcnt lgkmcnt(3)
    v_exp_f32 v228, v228
    v_mfma_f32_16x16x32_bf16 v[122:125], a[134:137], a[80:83], 0
    v_cvt_pk_bf16_f32 v246, v222, v223
    v_cvt_pk_bf16_f32 v247, v224, v225
    v_mfma_f32_16x16x32_bf16 v[122:125], a[140:143], a[80:83], v[122:125]
    v_exp_f32 v229, v229
    v_mfma_f32_16x16x32_bf16 v[126:129], a[132:135], a[80:83], 0
    v_cvt_pk_bf16_f32 v248, v226, v227
    v_cvt_pk_bf16_f32 v249, v228, v229
    v_mfma_f32_16x16x32_bf16 v[126:129], a[142:145], a[80:83], v[126:129]
    s_waitcnt lgkmcnt(0)
    ds_read_b128 a[176:179], v1 offset:8704
    ds_read_b128 a[180:183], v1 offset:8768
    v_mfma_f32_16x16x32_bf16 v[130:133], a[134:137], a[84:87], 0
    ds_read_b128 a[184:187], v1 offset:8832
    v_cvt_pk_bf16_f32 v74, v122, v123
    v_mfma_f32_16x16x32_bf16 v[130:133], a[140:143], a[84:87], v[130:133]
    ds_read_b128 a[188:191], v1 offset:8896
    v_cvt_pk_bf16_f32 v75, v124, v125
    v_mfma_f32_16x16x32_bf16 v[134:137], a[132:135], a[84:87], 0
    v_cvt_pk_bf16_f32 v76, v126, v127
    v_cvt_pk_bf16_f32 v77, v128, v129
    v_mfma_f32_16x16x32_bf16 v[134:137], a[142:145], a[84:87], v[134:137]
    ds_read_b128 a[192:195], v1 offset:13056
    v_accvgpr_read_b32 v250, a0
    v_mfma_f32_16x16x32_bf16 v[138:141], a[134:137], a[88:91], 0
    v_cvt_pk_bf16_f32 v78, v130, v131
    v_cvt_pk_bf16_f32 v79, v132, v133
    v_mfma_f32_16x16x32_bf16 v[138:141], a[140:143], a[88:91], v[138:141]
    v_accvgpr_read_b32 v251, a1
    v_accvgpr_read_b32 v252, a2
    v_mfma_f32_16x16x32_bf16 v[142:145], a[132:135], a[88:91], 0
    v_cvt_pk_bf16_f32 v80, v134, v135
    v_cvt_pk_bf16_f32 v81, v136, v137
    v_mfma_f32_16x16x32_bf16 v[142:145], a[142:145], a[88:91], v[142:145]
    v_rcp_f32 v8, v8
    v_mfma_f32_16x16x32_bf16 v[146:149], a[134:137], a[92:95], 0
    v_cvt_pk_bf16_f32 v82, v138, v139
    v_cvt_pk_bf16_f32 v83, v140, v141
    v_mfma_f32_16x16x32_bf16 v[146:149], a[140:143], a[92:95], v[146:149]
    v_accvgpr_read_b32 v253, a3
    v_mul_f32 v250, v250, v8
    v_mfma_f32_16x16x32_bf16 v[150:153], a[132:135], a[92:95], 0
    v_cvt_pk_bf16_f32 v84, v142, v143
    v_cvt_pk_bf16_f32 v85, v144, v145
    v_mfma_f32_16x16x32_bf16 v[150:153], a[142:145], a[92:95], v[150:153]
    v_mul_f32 v251, v251, v8
    v_mul_f32 v252, v252, v8
    v_mfma_f32_16x16x32_bf16 v[230:233], a[196:199], v[58:61], v[18:21]
    v_cvt_pk_bf16_f32 v86, v146, v147
    v_cvt_pk_bf16_f32 v87, v148, v149
    v_mfma_f32_16x16x32_bf16 v[230:233], a[148:151], v[62:65], v[230:233]
    ds_read_b128 a[196:199], v1 offset:13120
    ds_read_b128 a[148:151], v1 offset:13184
    v_mfma_f32_16x16x32_bf16 v[230:233], a[152:155], v[66:69], v[230:233]
    v_cvt_pk_bf16_f32 v88, v150, v151
    v_cvt_pk_bf16_f32 v89, v152, v153
    v_mfma_f32_16x16x32_bf16 v[230:233], a[156:159], v[70:73], v[230:233]
    ds_read_b128 a[152:155], v1 offset:13248
    v_mul_f32 v253, v253, v8
    v_mfma_f32_16x16x32_bf16 v[218:221], a[160:163], v[58:61], v[18:21]
    v_cvt_pk_bf16_f32 v250, v250, v251
    v_cvt_pk_bf16_f32 v251, v252, v253
    v_mfma_f32_16x16x32_bf16 v[218:221], a[164:167], v[62:65], v[218:221]
    v_accvgpr_read_b32 v252, a4
    v_accvgpr_read_b32 v253, a5
    v_mfma_f32_16x16x32_bf16 v[218:221], a[168:171], v[66:69], v[218:221]
    v_exp_f32 v230, v230
    v_mfma_f32_16x16x32_bf16 v[218:221], a[172:175], v[70:73], v[218:221]
    v_exp_f32 v231, v231
    v_smfmac_f32_16x16x64_bf16 a[104:107], a[116:119], v[242:249], v7
    v_cvt_pk_bf16_f32 v234, v230, v231
    v_mfma_f32_16x16x32_bf16 v[186:189], a[200:203], v[246:249], v[186:189]
    v_exp_f32 v232, v232
    v_mfma_f32_16x16x32_bf16 v[190:193], a[204:207], v[246:249], v[190:193]
    v_exp_f32 v233, v233
    v_mfma_f32_16x16x32_bf16 v[194:197], a[208:211], v[246:249], v[194:197]
    v_exp_f32 v218, v218
    v_mfma_f32_16x16x32_bf16 v[198:201], a[212:215], v[246:249], v[198:201]
    v_exp_f32 v219, v219
    v_mfma_f32_16x16x32_bf16 v[202:205], a[216:219], v[246:249], v[202:205]
    v_exp_f32 v220, v220
    v_mfma_f32_16x16x32_bf16 v[206:209], a[220:223], v[246:249], v[206:209]
    v_cvt_pk_bf16_f32 v235, v232, v233
    v_cvt_pk_bf16_f32 v236, v218, v219
    v_mfma_f32_16x16x32_bf16 v[210:213], a[224:227], v[246:249], v[210:213]
    v_exp_f32 v221, v221
    v_mfma_f32_16x16x32_bf16 v[214:217], a[228:231], v[246:249], v[214:217]
    v_cvt_pk_bf16_f32 v237, v220, v221
    v_accvgpr_read_b32 v254, a6
    s_waitcnt vmcnt(6)
    s_barrier
    s_waitcnt lgkmcnt(0)
    ds_read_b64_tr_b16 a[232:233], v2 offset:50688
    ds_read_b64_tr_b16 a[234:235], v2 offset:51200
    v_mfma_f32_16x16x32_bf16 v[122:125], a[176:179], v[74:77], 0
    s_add_u32 m0, s33, 43520
    ds_read_b64_tr_b16 a[236:237], v2 offset:50720
    ds_read_b64_tr_b16 a[238:239], v2 offset:51232
    v_mfma_f32_16x16x32_bf16 v[122:125], a[180:183], v[78:81], v[122:125]
    buffer_load_dwordx4 v3, s[20:23], s60 offen offset:0 lds
    v_mfma_f32_16x16x32_bf16 v[122:125], a[184:187], v[82:85], v[122:125]
    s_add_u32 m0, s33, 43584
    ds_read_b64_tr_b16 a[240:241], v2 offset:50752
    ds_read_b64_tr_b16 a[242:243], v2 offset:51264
    v_mfma_f32_16x16x32_bf16 v[122:125], a[188:191], v[86:89], v[122:125]
    ds_read_b64_tr_b16 a[244:245], v2 offset:50784
    ds_read_b64_tr_b16 a[246:247], v2 offset:51296
    v_mfma_f32_16x16x32_bf16 v[222:225], a[176:179], v[26:29], v[10:13]
    ds_read_b64_tr_b16 a[248:249], v2 offset:50816
    ds_read_b64_tr_b16 a[250:251], v2 offset:51328
    v_mfma_f32_16x16x32_bf16 v[222:225], a[180:183], v[30:33], v[222:225]
    ds_read_b64_tr_b16 a[252:253], v2 offset:50848
    ds_read_b64_tr_b16 a[254:255], v2 offset:51360
    v_mfma_f32_16x16x32_bf16 v[222:225], a[184:187], v[34:37], v[222:225]
    v_accvgpr_read_b32 v255, a7
    v_mul_f32 v252, v252, v8
    v_mfma_f32_16x16x32_bf16 v[222:225], a[188:191], v[38:41], v[222:225]
    buffer_load_dwordx4 v3, s[20:23], s60 offen offset:1024 lds
    v_mfma_f32_16x16x32_bf16 v[226:229], a[192:195], v[26:29], v[10:13]
    s_add_u32 m0, s34, 16896
    v_mul_f32 v253, v253, v8
    v_mul_f32 v254, v254, v8
    v_mfma_f32_16x16x32_bf16 v[226:229], a[196:199], v[30:33], v[226:229]
    v_mul_f32 v255, v255, v8
    v_cvt_pk_bf16_f32 v252, v252, v253
    v_mfma_f32_16x16x32_bf16 v[226:229], a[148:151], v[34:37], v[226:229]
    v_exp_f32 v222, v222
    v_mfma_f32_16x16x32_bf16 v[226:229], a[152:155], v[38:41], v[226:229]
    v_exp_f32 v223, v223
    v_mfma_f32_16x16x32_bf16 a[108:111], a[128:131], v[234:237], a[108:111]
    v_exp_f32 v224, v224
    v_mfma_f32_16x16x32_bf16 v[90:93], a[200:203], v[234:237], v[90:93]
    buffer_load_dwordx4 v4, s[24:27], s60 offen offset:0 lds
    v_mfma_f32_16x16x32_bf16 v[94:97], a[204:207], v[234:237], v[94:97]
    s_add_u32 m0, s34, 17696
    v_exp_f32 v225, v225
    v_mfma_f32_16x16x32_bf16 v[98:101], a[208:211], v[234:237], v[98:101]
    v_exp_f32 v226, v226
    v_mfma_f32_16x16x32_bf16 v[102:105], a[212:215], v[234:237], v[102:105]
    v_exp_f32 v227, v227
    v_mfma_f32_16x16x32_bf16 v[106:109], a[216:219], v[234:237], v[106:109]
    v_exp_f32 v228, v228
    v_mfma_f32_16x16x32_bf16 v[110:113], a[220:223], v[234:237], v[110:113]
    v_cvt_pk_bf16_f32 v242, v222, v223
    v_cvt_pk_bf16_f32 v243, v224, v225
    v_mfma_f32_16x16x32_bf16 v[114:117], a[224:227], v[234:237], v[114:117]
    buffer_load_dwordx4 v4, s[24:27], s60 offen offset:256 lds
    v_mfma_f32_16x16x32_bf16 v[118:121], a[228:231], v[234:237], v[118:121]
    s_add_u32 m0, s33, 52224
    v_exp_f32 v229, v229
    v_mfma_f32_16x16x32_bf16 v[230:233], a[176:179], v[42:45], v[14:17]
    ds_read_b64_tr_b16 a[200:201], v2 offset:50880
    v_cvt_pk_bf16_f32 v244, v226, v227
    v_mfma_f32_16x16x32_bf16 v[230:233], a[180:183], v[46:49], v[230:233]
    ds_read_b64_tr_b16 a[202:203], v2 offset:51392
    v_cvt_pk_bf16_f32 v245, v228, v229
    v_mfma_f32_16x16x32_bf16 v[230:233], a[184:187], v[50:53], v[230:233]
    ds_read_b64_tr_b16 a[204:205], v2 offset:50912
    ds_read_b64_tr_b16 a[206:207], v2 offset:51424
    v_mfma_f32_16x16x32_bf16 v[230:233], a[188:191], v[54:57], v[230:233]
    v_max3_f32 v24, v122, v123, v124
    v_cvt_pk_bf16_f32 v253, v254, v255
    v_mfma_f32_16x16x32_bf16 v[218:221], a[192:195], v[42:45], v[14:17]
    buffer_load_dwordx4 v3, s[20:23], s61 offen offset:0 lds
    v_mfma_f32_16x16x32_bf16 v[218:221], a[196:199], v[46:49], v[218:221]
    s_add_u32 m0, s33, 52288
    v_max_f32 v22, v24, v125
    v_max_f32 v23, v24, v125
    v_mfma_f32_16x16x32_bf16 v[218:221], a[148:151], v[50:53], v[218:221]
    v_exp_f32 v230, v230
    v_mfma_f32_16x16x32_bf16 v[218:221], a[152:155], v[54:57], v[218:221]
    s_waitcnt lgkmcnt(4)
    v_exp_f32 v231, v231
    v_mfma_f32_16x16x32_bf16 v[154:157], a[232:235], v[242:245], v[154:157]
    v_exp_f32 v232, v232
    v_mfma_f32_16x16x32_bf16 v[158:161], a[236:239], v[242:245], v[158:161]
    v_exp_f32 v233, v233
    v_mfma_f32_16x16x32_bf16 v[162:165], a[240:243], v[242:245], v[162:165]
    buffer_load_dwordx4 v3, s[20:23], s61 offen offset:1024 lds
    v_mfma_f32_16x16x32_bf16 v[166:169], a[244:247], v[242:245], v[166:169]
    s_add_u32 m0, s34, 25344
    v_exp_f32 v218, v218
    v_mfma_f32_16x16x32_bf16 v[170:173], a[248:251], v[242:245], v[170:173]
    v_exp_f32 v219, v219
    v_mfma_f32_16x16x32_bf16 v[174:177], a[252:255], v[242:245], v[174:177]
    s_waitcnt lgkmcnt(0)
    v_exp_f32 v220, v220
    v_mfma_f32_16x16x32_bf16 v[178:181], a[200:203], v[242:245], v[178:181]
    v_cvt_pk_bf16_f32 v246, v230, v231
    v_exp_f32 v221, v221
    v_mfma_f32_16x16x32_bf16 v[182:185], a[204:207], v[242:245], v[182:185]
    v_cvt_pk_bf16_f32 v247, v232, v233
    v_cvt_pk_bf16_f32 v248, v218, v219
    v_mfma_f32_16x16x32_bf16 v[222:225], a[176:179], v[58:61], v[18:21]
    ds_read_b128 a[156:159], v1 offset:17408
    v_cvt_pk_bf16_f32 v249, v220, v221
    v_mfma_f32_16x16x32_bf16 v[222:225], a[180:183], v[62:65], v[222:225]
    buffer_load_dwordx4 v4, s[24:27], s61 offen offset:0 lds
    v_mfma_f32_16x16x32_bf16 v[222:225], a[184:187], v[66:69], v[222:225]
    s_add_u32 m0, s34, 26144
    v_permlane16_swap_b32 v250, v252
    v_mfma_f32_16x16x32_bf16 v[222:225], a[188:191], v[70:73], v[222:225]
    v_permlane16_swap_b32 v251, v253
    v_mfma_f32_16x16x32_bf16 v[226:229], a[192:195], v[58:61], v[18:21]
    v_permlane16_swap_b32 v22, v23
    v_mfma_f32_16x16x32_bf16 v[226:229], a[196:199], v[62:65], v[226:229]
    v_max_f32 v24, v22, v23
    v_max_f32 v25, v22, v23
    v_mfma_f32_16x16x32_bf16 v[226:229], a[148:151], v[66:69], v[226:229]
    buffer_load_dwordx4 v4, s[24:27], s61 offen offset:256 lds
    v_mfma_f32_16x16x32_bf16 v[226:229], a[152:155], v[70:73], v[226:229]
    s_add_u32 m0, s33, 0
    v_exp_f32 v222, v222
    v_smfmac_f32_16x16x64_bf16 a[104:107], a[116:119], v[242:249], v7
    ds_read_b128 a[160:163], v1 offset:17472
    v_mfma_f32_16x16x32_bf16 v[186:189], a[232:235], v[246:249], v[186:189]
    v_exp_f32 v223, v223
    v_mfma_f32_16x16x32_bf16 v[190:193], a[236:239], v[246:249], v[190:193]
    v_permlane32_swap_b32 v24, v25
    v_mfma_f32_16x16x32_bf16 v[194:197], a[240:243], v[246:249], v[194:197]
    v_exp_f32 v224, v224
    v_mfma_f32_16x16x32_bf16 v[198:201], a[244:247], v[246:249], v[198:201]
    buffer_load_dwordx4 v3, s[20:23], s62 offen offset:0 lds
    v_mfma_f32_16x16x32_bf16 v[202:205], a[248:251], v[246:249], v[202:205]
    s_add_u32 m0, s33, 64
    v_min_f32_e64 v22, -v24, -v25
    v_min_f32_e64 v23, -v24, -v25
    v_mfma_f32_16x16x32_bf16 v[206:209], a[252:255], v[246:249], v[206:209]
    v_exp_f32 v225, v225
    v_mfma_f32_16x16x32_bf16 v[210:213], a[200:203], v[246:249], v[210:213]
    v_mov_b32 v24, v22
    v_exp_f32 v226, v226
    v_mfma_f32_16x16x32_bf16 v[214:217], a[204:207], v[246:249], v[214:217]
    v_mov_b32 v25, v22
    v_exp_f32 v227, v227
    s_nop 0
    v_mfma_f32_16x16x32_bf16 v[230:233], a[192:195], v[74:77], v[22:25]
    v_exp_f32 v228, v228
    v_mfma_f32_16x16x32_bf16 v[230:233], a[196:199], v[78:81], v[230:233]
    v_cvt_pk_bf16_f32 v234, v222, v223
    v_exp_f32 v229, v229
    v_mfma_f32_16x16x32_bf16 v[230:233], a[148:151], v[82:85], v[230:233]
    v_cvt_pk_bf16_f32 v235, v224, v225
    v_cvt_pk_bf16_f32 v236, v226, v227
    v_mfma_f32_16x16x32_bf16 v[230:233], a[152:155], v[86:89], v[230:233]
    buffer_load_dwordx4 v3, s[20:23], s62 offen offset:1024 lds
    v_cvt_pk_bf16_f32 v237, v228, v229
    s_add_u32 m0, s34, 33792
    s_nop 0
    v_mfma_f32_16x16x32_bf16 v[90:93], a[232:235], v[234:237], v[90:93]
    buffer_store_dwordx4 v[250:253], v0, s[28:31], s42 offen offset:0 sc0 sc1
    v_add_f32 v122, v122, v22
    v_mfma_f32_16x16x32_bf16 v[94:97], a[236:239], v[234:237], v[94:97]
    ds_read_b128 a[164:167], v1 offset:17536
    ds_read_b128 a[168:171], v1 offset:17600
    v_mfma_f32_16x16x32_bf16 v[98:101], a[240:243], v[234:237], v[98:101]
    ds_read_b128 a[172:175], v1 offset:21760
    ds_read_b128 a[176:179], v1 offset:21824
    v_mfma_f32_16x16x32_bf16 v[102:105], a[244:247], v[234:237], v[102:105]
    buffer_load_dwordx4 v4, s[24:27], s62 offen offset:0 lds
    v_mfma_f32_16x16x32_bf16 v[106:109], a[248:251], v[234:237], v[106:109]
    s_add_u32 m0, s34, 34592
    ds_read_b128 a[180:183], v1 offset:21888
    v_add_f32 v123, v123, v22
    v_mfma_f32_16x16x32_bf16 v[110:113], a[252:255], v[234:237], v[110:113]
    v_exp_f32 v122, v122
    v_mfma_f32_16x16x32_bf16 v[114:117], a[200:203], v[234:237], v[114:117]
    ds_read_b128 a[184:187], v1 offset:21952
    v_add_f32 v124, v124, v22
    v_mfma_f32_16x16x32_bf16 v[118:121], a[204:207], v[234:237], v[118:121]
    s_waitcnt lgkmcnt(6)
    v_exp_f32 v123, v123
    v_mfma_f32_16x16x32_bf16 v[218:221], a[156:159], v[26:29], v[10:13]
    v_exp_f32 v124, v124
    v_mfma_f32_16x16x32_bf16 v[218:221], a[160:163], v[30:33], v[218:221]
    s_waitcnt lgkmcnt(4)
    v_add_f32 v125, v125, v22
    v_exp_f32 v125, v125
    v_mfma_f32_16x16x32_bf16 v[218:221], a[164:167], v[34:37], v[218:221]
    v_exp_f32 v230, v230
    v_mfma_f32_16x16x32_bf16 v[218:221], a[168:171], v[38:41], v[218:221]
    s_waitcnt lgkmcnt(2)
    buffer_load_dwordx4 v4, s[24:27], s62 offen offset:256 lds
    v_mfma_f32_16x16x32_bf16 v[222:225], a[172:175], v[26:29], v[10:13]
    v_exp_f32 v231, v231
    v_mfma_f32_16x16x32_bf16 v[222:225], a[176:179], v[30:33], v[222:225]
    s_waitcnt lgkmcnt(1)
    v_exp_f32 v232, v232
    v_mfma_f32_16x16x32_bf16 v[222:225], a[180:183], v[34:37], v[222:225]
    s_waitcnt lgkmcnt(0)
    v_cvt_pk_bf16_f32 v238, v122, v123
    v_exp_f32 v233, v233
    v_mfma_f32_16x16x32_bf16 v[222:225], a[184:187], v[38:41], v[222:225]
    v_cvt_pk_bf16_f32 v239, v124, v125
    v_cvt_pk_bf16_f32 v240, v230, v231
    v_cvt_pk_bf16_f32 v241, v232, v233
    v_exp_f32 v218, v218
    s_nop 0
    v_smfmac_f32_16x16x64_bf16 a[108:111], a[116:119], v[234:241], v7
    ds_read_b64_tr_b16 a[208:209], v2 offset:59136
    v_mfma_f32_16x16x32_bf16 v[122:125], a[232:235], v[238:241], 0
    v_exp_f32 v219, v219
    v_mfma_f32_16x16x32_bf16 v[126:129], a[236:239], v[238:241], 0
    v_exp_f32 v220, v220
    v_mfma_f32_16x16x32_bf16 v[130:133], a[240:243], v[238:241], 0
    v_exp_f32 v221, v221
    v_mfma_f32_16x16x32_bf16 v[134:137], a[244:247], v[238:241], 0
    ds_read_b64_tr_b16 a[210:211], v2 offset:59648
    ds_read_b64_tr_b16 a[212:213], v2 offset:59168
    v_mfma_f32_16x16x32_bf16 v[138:141], a[248:251], v[238:241], 0
    v_exp_f32 v222, v222
    v_mfma_f32_16x16x32_bf16 v[142:145], a[252:255], v[238:241], 0
    ds_read_b64_tr_b16 a[214:215], v2 offset:59680
    ds_read_b64_tr_b16 a[216:217], v2 offset:59200
    v_mfma_f32_16x16x32_bf16 v[146:149], a[200:203], v[238:241], 0
    v_exp_f32 v223, v223
    v_mfma_f32_16x16x32_bf16 v[150:153], a[204:207], v[238:241], 0
    ds_read_b64_tr_b16 a[218:219], v2 offset:59712
    ds_read_b64_tr_b16 a[220:221], v2 offset:59232
    v_mfma_f32_16x16x32_bf16 v[226:229], a[156:159], v[42:45], v[14:17]
    v_exp_f32 v224, v224
    v_mfma_f32_16x16x32_bf16 v[226:229], a[160:163], v[46:49], v[226:229]
    ds_read_b64_tr_b16 a[222:223], v2 offset:59744
    v_cvt_pk_bf16_f32 v242, v218, v219
    v_mfma_f32_16x16x32_bf16 v[226:229], a[164:167], v[50:53], v[226:229]
    ds_read_b64_tr_b16 a[224:225], v2 offset:59264
    v_cvt_pk_bf16_f32 v243, v220, v221
    v_mfma_f32_16x16x32_bf16 v[226:229], a[168:171], v[54:57], v[226:229]
    v_exp_f32 v225, v225
    v_mfma_f32_16x16x32_bf16 v[230:233], a[172:175], v[42:45], v[14:17]
    ds_read_b64_tr_b16 a[226:227], v2 offset:59776
    v_cvt_pk_bf16_f32 v244, v222, v223
    v_mfma_f32_16x16x32_bf16 v[230:233], a[176:179], v[46:49], v[230:233]
    ds_read_b64_tr_b16 a[228:229], v2 offset:59296
    ds_read_b64_tr_b16 a[230:231], v2 offset:59808
    v_mfma_f32_16x16x32_bf16 v[230:233], a[180:183], v[50:53], v[230:233]
    ds_read_b64_tr_b16 a[232:233], v2 offset:59328
    ds_read_b64_tr_b16 a[234:235], v2 offset:59840
    v_mfma_f32_16x16x32_bf16 v[230:233], a[184:187], v[54:57], v[230:233]
    s_waitcnt lgkmcnt(7)
    ds_read_b64_tr_b16 a[236:237], v2 offset:59360
    ds_read_b64_tr_b16 a[238:239], v2 offset:59872
    v_cvt_pk_bf16_f32 v245, v224, v225
    v_accvgpr_read_b32 v250, a8
    s_nop 0
    v_mfma_f32_16x16x32_bf16 v[154:157], a[208:211], v[242:245], v[154:157]
    v_accvgpr_read_b32 v251, a9
    v_accvgpr_read_b32 v252, a10
    v_mfma_f32_16x16x32_bf16 v[158:161], a[212:215], v[242:245], v[158:161]
    v_accvgpr_read_b32 v253, a11
    v_mul_f32 v250, v250, v8
    v_mfma_f32_16x16x32_bf16 v[162:165], a[216:219], v[242:245], v[162:165]
    s_waitcnt lgkmcnt(7)
    v_mul_f32 v251, v251, v8
    v_mul_f32 v252, v252, v8
    v_mfma_f32_16x16x32_bf16 v[166:169], a[220:223], v[242:245], v[166:169]
    s_waitcnt lgkmcnt(6)
    v_mul_f32 v253, v253, v8
    v_cvt_pk_bf16_f32 v250, v250, v251
    v_mfma_f32_16x16x32_bf16 v[170:173], a[224:227], v[242:245], v[170:173]
    s_waitcnt lgkmcnt(4)
    v_cvt_pk_bf16_f32 v251, v252, v253
    v_accvgpr_read_b32 v252, a12
    v_mfma_f32_16x16x32_bf16 v[174:177], a[228:231], v[242:245], v[174:177]
    s_waitcnt lgkmcnt(2)
    v_accvgpr_read_b32 v253, a13
    v_accvgpr_read_b32 v254, a14
    v_mfma_f32_16x16x32_bf16 v[178:181], a[232:235], v[242:245], v[178:181]
    s_waitcnt lgkmcnt(0)
    v_accvgpr_read_b32 v255, a15
    v_exp_f32 v226, v226
    v_mul_f32 v252, v252, v8
    v_mul_f32 v253, v253, v8
    v_mfma_f32_16x16x32_bf16 v[182:185], a[236:239], v[242:245], v[182:185]
    v_mul_f32 v254, v254, v8
    v_exp_f32 v227, v227
    v_mul_f32 v255, v255, v8
    v_cvt_pk_bf16_f32 v252, v252, v253
    v_cvt_pk_bf16_f32 v253, v254, v255
    v_mfma_f32_16x16x32_bf16 v[218:221], a[156:159], v[58:61], v[18:21]
    v_permlane16_swap_b32 v250, v252
    v_mfma_f32_16x16x32_bf16 v[218:221], a[160:163], v[62:65], v[218:221]
    v_permlane16_swap_b32 v251, v253
    v_mfma_f32_16x16x32_bf16 v[218:221], a[164:167], v[66:69], v[218:221]
    buffer_store_dwordx4 v[250:253], v0, s[28:31], s42 offen offset:64 sc0 sc1
    v_cvt_pk_bf16_f32 v246, v226, v227
    v_mfma_f32_16x16x32_bf16 v[218:221], a[168:171], v[70:73], v[218:221]
    v_exp_f32 v228, v228
    v_mfma_f32_16x16x32_bf16 v[222:225], a[172:175], v[58:61], v[18:21]
    v_exp_f32 v229, v229
    v_mfma_f32_16x16x32_bf16 v[222:225], a[176:179], v[62:65], v[222:225]
    v_exp_f32 v230, v230
    v_mfma_f32_16x16x32_bf16 v[222:225], a[180:183], v[66:69], v[222:225]
    v_exp_f32 v231, v231
    v_exp_f32 v232, v232
    v_exp_f32 v233, v233
    v_mfma_f32_16x16x32_bf16 v[222:225], a[184:187], v[70:73], v[222:225]
    v_cvt_pk_bf16_f32 v247, v228, v229
    v_cvt_pk_bf16_f32 v248, v230, v231
    v_cvt_pk_bf16_f32 v249, v232, v233
    v_exp_f32 v218, v218
    s_nop 0
    v_smfmac_f32_16x16x64_bf16 a[104:107], a[116:119], v[242:249], v7
    ds_read_b128 a[188:191], v1 offset:26112
    v_mfma_f32_16x16x32_bf16 v[186:189], a[208:211], v[246:249], v[186:189]
    v_exp_f32 v219, v219
    v_mfma_f32_16x16x32_bf16 v[190:193], a[212:215], v[246:249], v[190:193]
    v_exp_f32 v220, v220
    v_mfma_f32_16x16x32_bf16 v[194:197], a[216:219], v[246:249], v[194:197]
    v_exp_f32 v221, v221
    v_mfma_f32_16x16x32_bf16 v[198:201], a[220:223], v[246:249], v[198:201]
    v_exp_f32 v222, v222
    v_mfma_f32_16x16x32_bf16 v[202:205], a[224:227], v[246:249], v[202:205]
    v_exp_f32 v223, v223
    v_mfma_f32_16x16x32_bf16 v[206:209], a[228:231], v[246:249], v[206:209]
    v_exp_f32 v224, v224
    v_mfma_f32_16x16x32_bf16 v[210:213], a[232:235], v[246:249], v[210:213]
    v_cvt_pk_bf16_f32 v234, v218, v219
    v_cvt_pk_bf16_f32 v235, v220, v221
    v_mfma_f32_16x16x32_bf16 v[214:217], a[236:239], v[246:249], v[214:217]
    v_exp_f32 v225, v225
    v_mfma_f32_16x16x32_bf16 v[226:229], a[156:159], v[74:77], v[22:25]
    v_cvt_pk_bf16_f32 v236, v222, v223
    v_cvt_pk_bf16_f32 v237, v224, v225
    v_mfma_f32_16x16x32_bf16 v[226:229], a[160:163], v[78:81], v[226:229]
    ds_read_b128 a[192:195], v1 offset:26176
    ds_read_b128 a[196:199], v1 offset:26240
    v_mfma_f32_16x16x32_bf16 v[226:229], a[164:167], v[82:85], v[226:229]
    ds_read_b128 a[148:151], v1 offset:26304
    ds_read_b128 a[152:155], v1 offset:30464
    v_mfma_f32_16x16x32_bf16 v[226:229], a[168:171], v[86:89], v[226:229]
    ds_read_b128 a[156:159], v1 offset:30528
    ds_read_b128 a[160:163], v1 offset:30592
    v_mfma_f32_16x16x32_bf16 v[230:233], a[172:175], v[74:77], v[22:25]
    ds_read_b128 a[164:167], v1 offset:30656
    ds_read_b64_tr_b16 a[240:241], v2 offset:0
    v_mfma_f32_16x16x32_bf16 v[230:233], a[176:179], v[78:81], v[230:233]
    ds_read_b64_tr_b16 a[242:243], v2 offset:512
    ds_read_b64_tr_b16 a[244:245], v2 offset:32
    v_mfma_f32_16x16x32_bf16 v[230:233], a[180:183], v[82:85], v[230:233]
    v_exp_f32 v226, v226
    v_mfma_f32_16x16x32_bf16 v[230:233], a[184:187], v[86:89], v[230:233]
    v_exp_f32 v227, v227
    v_mfma_f32_16x16x32_bf16 v[90:93], a[208:211], v[234:237], v[90:93]
    v_exp_f32 v228, v228
    v_mfma_f32_16x16x32_bf16 v[94:97], a[212:215], v[234:237], v[94:97]
    v_exp_f32 v229, v229
    v_mfma_f32_16x16x32_bf16 v[98:101], a[216:219], v[234:237], v[98:101]
    v_cvt_pk_bf16_f32 v238, v226, v227
    v_cvt_pk_bf16_f32 v239, v228, v229
    v_mfma_f32_16x16x32_bf16 v[102:105], a[220:223], v[234:237], v[102:105]
    v_exp_f32 v230, v230
    v_mfma_f32_16x16x32_bf16 v[106:109], a[224:227], v[234:237], v[106:109]
    v_exp_f32 v231, v231
    v_mfma_f32_16x16x32_bf16 v[110:113], a[228:231], v[234:237], v[110:113]
    v_exp_f32 v232, v232
    v_mfma_f32_16x16x32_bf16 v[114:117], a[232:235], v[234:237], v[114:117]
    v_exp_f32 v233, v233
    v_mfma_f32_16x16x32_bf16 v[118:121], a[236:239], v[234:237], v[118:121]
    s_waitcnt lgkmcnt(0)
    v_cvt_pk_bf16_f32 v240, v230, v231
    v_cvt_pk_bf16_f32 v241, v232, v233
    v_mfma_f32_16x16x32_bf16 v[218:221], a[188:191], v[26:29], v[10:13]
    ds_read_b64_tr_b16 a[246:247], v2 offset:544
    ds_read_b64_tr_b16 a[248:249], v2 offset:64
    v_mfma_f32_16x16x32_bf16 v[218:221], a[192:195], v[30:33], v[218:221]
    ds_read_b64_tr_b16 a[250:251], v2 offset:576
    ds_read_b64_tr_b16 a[252:253], v2 offset:96
    v_mfma_f32_16x16x32_bf16 v[218:221], a[196:199], v[34:37], v[218:221]
    ds_read_b64_tr_b16 a[254:255], v2 offset:608
    ds_read_b64_tr_b16 a[200:201], v2 offset:128
    v_mfma_f32_16x16x32_bf16 v[218:221], a[148:151], v[38:41], v[218:221]
    ds_read_b64_tr_b16 a[202:203], v2 offset:640
    ds_read_b64_tr_b16 a[204:205], v2 offset:160
    v_mfma_f32_16x16x32_bf16 v[222:225], a[152:155], v[26:29], v[10:13]
    ds_read_b64_tr_b16 a[206:207], v2 offset:672
    v_accvgpr_read_b32 v250, a16
    v_mfma_f32_16x16x32_bf16 v[222:225], a[156:159], v[30:33], v[222:225]
    v_accvgpr_read_b32 v251, a17
    v_accvgpr_read_b32 v252, a18
    v_mfma_f32_16x16x32_bf16 v[222:225], a[160:163], v[34:37], v[222:225]
    v_exp_f32 v218, v218
    v_mfma_f32_16x16x32_bf16 v[222:225], a[164:167], v[38:41], v[222:225]
    v_exp_f32 v219, v219
    v_smfmac_f32_16x16x64_bf16 a[108:111], a[116:119], v[234:241], v7
    v_cvt_pk_bf16_f32 v242, v218, v219
    v_mfma_f32_16x16x32_bf16 v[122:125], a[208:211], v[238:241], v[122:125]
    v_exp_f32 v220, v220
    v_mfma_f32_16x16x32_bf16 v[126:129], a[212:215], v[238:241], v[126:129]
    v_exp_f32 v221, v221
    v_mfma_f32_16x16x32_bf16 v[130:133], a[216:219], v[238:241], v[130:133]
    v_exp_f32 v222, v222
    v_mfma_f32_16x16x32_bf16 v[134:137], a[220:223], v[238:241], v[134:137]
    v_exp_f32 v223, v223
    v_mfma_f32_16x16x32_bf16 v[138:141], a[224:227], v[238:241], v[138:141]
    v_exp_f32 v224, v224
    v_mfma_f32_16x16x32_bf16 v[142:145], a[228:231], v[238:241], v[142:145]
    ds_read_b64_tr_b16 a[208:209], v2 offset:192
    v_cvt_pk_bf16_f32 v243, v220, v221
    v_mfma_f32_16x16x32_bf16 v[146:149], a[232:235], v[238:241], v[146:149]
    v_exp_f32 v225, v225
    v_mfma_f32_16x16x32_bf16 v[150:153], a[236:239], v[238:241], v[150:153]
    ds_read_b64_tr_b16 a[210:211], v2 offset:704
    v_cvt_pk_bf16_f32 v244, v222, v223
    v_mfma_f32_16x16x32_bf16 v[226:229], a[188:191], v[42:45], v[14:17]
    ds_read_b64_tr_b16 a[212:213], v2 offset:224
    v_cvt_pk_bf16_f32 v245, v224, v225
    v_mfma_f32_16x16x32_bf16 v[226:229], a[192:195], v[46:49], v[226:229]
    ds_read_b64_tr_b16 a[214:215], v2 offset:736
    v_accvgpr_read_b32 v253, a19
    v_mfma_f32_16x16x32_bf16 v[226:229], a[196:199], v[50:53], v[226:229]
    v_mul_f32 v250, v250, v8
    v_mul_f32 v251, v251, v8
    v_mfma_f32_16x16x32_bf16 v[226:229], a[148:151], v[54:57], v[226:229]
    v_mul_f32 v252, v252, v8
    v_mul_f32 v253, v253, v8
    v_mfma_f32_16x16x32_bf16 v[230:233], a[152:155], v[42:45], v[14:17]
    v_cvt_pk_bf16_f32 v250, v250, v251
    v_cvt_pk_bf16_f32 v251, v252, v253
    v_mfma_f32_16x16x32_bf16 v[230:233], a[156:159], v[46:49], v[230:233]
    v_accvgpr_read_b32 v252, a20
    v_accvgpr_read_b32 v253, a21
    v_mfma_f32_16x16x32_bf16 v[230:233], a[160:163], v[50:53], v[230:233]
    v_exp_f32 v226, v226
    v_mfma_f32_16x16x32_bf16 v[230:233], a[164:167], v[54:57], v[230:233]
    v_exp_f32 v227, v227
    v_mfma_f32_16x16x32_bf16 v[154:157], a[240:243], v[242:245], v[154:157]
    s_waitcnt lgkmcnt(1)
    v_exp_f32 v228, v228
    v_mfma_f32_16x16x32_bf16 v[158:161], a[244:247], v[242:245], v[158:161]
    v_exp_f32 v229, v229
    v_mfma_f32_16x16x32_bf16 v[162:165], a[248:251], v[242:245], v[162:165]
    v_cvt_pk_bf16_f32 v246, v226, v227
    v_cvt_pk_bf16_f32 v247, v228, v229
    v_mfma_f32_16x16x32_bf16 v[166:169], a[252:255], v[242:245], v[166:169]
    v_exp_f32 v230, v230
    v_mfma_f32_16x16x32_bf16 v[170:173], a[200:203], v[242:245], v[170:173]
    v_exp_f32 v231, v231
    v_mfma_f32_16x16x32_bf16 v[174:177], a[204:207], v[242:245], v[174:177]
    v_exp_f32 v232, v232
    v_mfma_f32_16x16x32_bf16 v[178:181], a[208:211], v[242:245], v[178:181]
    s_waitcnt lgkmcnt(0)
    v_exp_f32 v233, v233
    v_mfma_f32_16x16x32_bf16 v[182:185], a[212:215], v[242:245], v[182:185]
    v_cvt_pk_bf16_f32 v248, v230, v231
    v_cvt_pk_bf16_f32 v249, v232, v233
    v_mfma_f32_16x16x32_bf16 v[218:221], a[188:191], v[58:61], v[18:21]
    v_accvgpr_read_b32 v254, a22
    v_accvgpr_read_b32 v255, a23
    v_mfma_f32_16x16x32_bf16 v[218:221], a[192:195], v[62:65], v[218:221]
    v_mul_f32 v252, v252, v8
    v_mul_f32 v253, v253, v8
    v_mfma_f32_16x16x32_bf16 v[218:221], a[196:199], v[66:69], v[218:221]
    v_mul_f32 v254, v254, v8
    v_mul_f32 v255, v255, v8
    v_mfma_f32_16x16x32_bf16 v[218:221], a[148:151], v[70:73], v[218:221]
    ds_read_b128 a[168:171], v1 offset:34816
    v_cvt_pk_bf16_f32 v252, v252, v253
    v_mfma_f32_16x16x32_bf16 v[222:225], a[152:155], v[58:61], v[18:21]
    ds_read_b128 a[172:175], v1 offset:34880
    v_cvt_pk_bf16_f32 v253, v254, v255
    v_mfma_f32_16x16x32_bf16 v[222:225], a[156:159], v[62:65], v[222:225]
    v_permlane16_swap_b32 v250, v252
    v_mfma_f32_16x16x32_bf16 v[222:225], a[160:163], v[66:69], v[222:225]
    v_exp_f32 v218, v218
    v_mfma_f32_16x16x32_bf16 v[222:225], a[164:167], v[70:73], v[222:225]
    v_exp_f32 v219, v219
    v_smfmac_f32_16x16x64_bf16 a[104:107], a[116:119], v[242:249], v7
L_pad7:
    s_cbranch_vccnz L_warm
    v_cvt_pk_bf16_f32 v234, v218, v219
    v_mfma_f32_16x16x32_bf16 v[186:189], a[240:243], v[246:249], v[186:189]
    v_permlane16_swap_b32 v251, v253
    v_mfma_f32_16x16x32_bf16 v[190:193], a[244:247], v[246:249], v[190:193]
    v_exp_f32 v220, v220
    v_mfma_f32_16x16x32_bf16 v[194:197], a[248:251], v[246:249], v[194:197]
    buffer_store_dwordx4 v[250:253], v0, s[28:31], s42 offen offset:128 sc0 sc1
    v_accvgpr_read_b32 v254, a30
    v_mfma_f32_16x16x32_bf16 v[198:201], a[252:255], v[246:249], v[198:201]
    v_exp_f32 v221, v221
    v_mfma_f32_16x16x32_bf16 v[202:205], a[200:203], v[246:249], v[202:205]
    v_exp_f32 v222, v222
    v_mfma_f32_16x16x32_bf16 v[206:209], a[204:207], v[246:249], v[206:209]
    v_exp_f32 v223, v223
    v_mfma_f32_16x16x32_bf16 v[210:213], a[208:211], v[246:249], v[210:213]
    v_exp_f32 v224, v224
    v_mfma_f32_16x16x32_bf16 v[214:217], a[212:215], v[246:249], v[214:217]
    v_cvt_pk_bf16_f32 v235, v220, v221
    v_cvt_pk_bf16_f32 v236, v222, v223
    v_mfma_f32_16x16x32_bf16 v[226:229], a[188:191], v[74:77], v[22:25]
    v_exp_f32 v225, v225
    v_mfma_f32_16x16x32_bf16 v[226:229], a[192:195], v[78:81], v[226:229]
    ds_read_b128 a[176:179], v1 offset:34944
    v_cvt_pk_bf16_f32 v237, v224, v225
    v_mfma_f32_16x16x32_bf16 v[226:229], a[196:199], v[82:85], v[226:229]
    ds_read_b128 a[180:183], v1 offset:35008
    ds_read_b128 a[184:187], v1 offset:39168
    v_mfma_f32_16x16x32_bf16 v[226:229], a[148:151], v[86:89], v[226:229]
    ds_read_b128 a[188:191], v1 offset:39232
    ds_read_b128 a[192:195], v1 offset:39296
    v_mfma_f32_16x16x32_bf16 v[230:233], a[152:155], v[74:77], v[22:25]
    ds_read_b128 a[196:199], v1 offset:39360
    v_accvgpr_read_b32 v250, a24
    v_mfma_f32_16x16x32_bf16 v[230:233], a[156:159], v[78:81], v[230:233]
    v_accvgpr_read_b32 v251, a25
    v_accvgpr_read_b32 v252, a26
    v_mfma_f32_16x16x32_bf16 v[230:233], a[160:163], v[82:85], v[230:233]
    v_exp_f32 v226, v226
    v_mfma_f32_16x16x32_bf16 v[230:233], a[164:167], v[86:89], v[230:233]
    v_exp_f32 v227, v227
    v_mfma_f32_16x16x32_bf16 v[90:93], a[240:243], v[234:237], v[90:93]
    v_exp_f32 v228, v228
    v_mfma_f32_16x16x32_bf16 v[94:97], a[244:247], v[234:237], v[94:97]
    v_exp_f32 v229, v229
    v_mfma_f32_16x16x32_bf16 v[98:101], a[248:251], v[234:237], v[98:101]
    v_cvt_pk_bf16_f32 v238, v226, v227
    v_cvt_pk_bf16_f32 v239, v228, v229
    v_mfma_f32_16x16x32_bf16 v[102:105], a[252:255], v[234:237], v[102:105]
    v_exp_f32 v230, v230
    v_mfma_f32_16x16x32_bf16 v[106:109], a[200:203], v[234:237], v[106:109]
    v_exp_f32 v231, v231
    v_mfma_f32_16x16x32_bf16 v[110:113], a[204:207], v[234:237], v[110:113]
    v_exp_f32 v232, v232
    v_mfma_f32_16x16x32_bf16 v[114:117], a[208:211], v[234:237], v[114:117]
    v_exp_f32 v233, v233
    v_mfma_f32_16x16x32_bf16 v[118:121], a[212:215], v[234:237], v[118:121]
    v_cvt_pk_bf16_f32 v240, v230, v231
    v_cvt_pk_bf16_f32 v241, v232, v233
    s_waitcnt vmcnt(5)
    s_barrier
    s_waitcnt lgkmcnt(0)
    ds_read_b64_tr_b16 a[216:217], v2 offset:8448
    ds_read_b64_tr_b16 a[218:219], v2 offset:8960
    v_mfma_f32_16x16x32_bf16 v[218:221], a[168:171], v[26:29], v[10:13]
    s_add_u32 m0, s33, 8704
    ds_read_b64_tr_b16 a[220:221], v2 offset:8480
    ds_read_b64_tr_b16 a[222:223], v2 offset:8992
    v_mfma_f32_16x16x32_bf16 v[218:221], a[172:175], v[30:33], v[218:221]
    buffer_load_dwordx4 v3, s[20:23], s63 offen offset:0 lds
    v_mfma_f32_16x16x32_bf16 v[218:221], a[176:179], v[34:37], v[218:221]
    s_add_u32 m0, s33, 8768
    ds_read_b64_tr_b16 a[224:225], v2 offset:8512
    ds_read_b64_tr_b16 a[226:227], v2 offset:9024
    v_mfma_f32_16x16x32_bf16 v[218:221], a[180:183], v[38:41], v[218:221]
    ds_read_b64_tr_b16 a[228:229], v2 offset:8544
    ds_read_b64_tr_b16 a[230:231], v2 offset:9056
    v_mfma_f32_16x16x32_bf16 v[222:225], a[184:187], v[26:29], v[10:13]
    ds_read_b64_tr_b16 a[232:233], v2 offset:8576
    ds_read_b64_tr_b16 a[234:235], v2 offset:9088
    v_mfma_f32_16x16x32_bf16 v[222:225], a[188:191], v[30:33], v[222:225]
    ds_read_b64_tr_b16 a[236:237], v2 offset:8608
    ds_read_b64_tr_b16 a[238:239], v2 offset:9120
    v_mfma_f32_16x16x32_bf16 v[222:225], a[192:195], v[34:37], v[222:225]
    v_exp_f32 v218, v218
    v_mfma_f32_16x16x32_bf16 v[222:225], a[196:199], v[38:41], v[222:225]
    buffer_load_dwordx4 v3, s[20:23], s63 offen offset:1024 lds
    v_smfmac_f32_16x16x64_bf16 a[108:111], a[116:119], v[234:241], v7
    s_add_u32 m0, s34, 42240
    ds_read_b128 a[148:151], v1 offset:43520
    v_mfma_f32_16x16x32_bf16 v[122:125], a[240:243], v[238:241], v[122:125]
    v_exp_f32 v219, v219
    v_mfma_f32_16x16x32_bf16 v[126:129], a[244:247], v[238:241], v[126:129]
    v_exp_f32 v220, v220
    v_mfma_f32_16x16x32_bf16 v[130:133], a[248:251], v[238:241], v[130:133]
    v_exp_f32 v221, v221
    v_mfma_f32_16x16x32_bf16 v[134:137], a[252:255], v[238:241], v[134:137]
    v_exp_f32 v222, v222
    v_mfma_f32_16x16x32_bf16 v[138:141], a[200:203], v[238:241], v[138:141]
    buffer_load_dwordx4 v4, s[24:27], s63 offen offset:0 lds
    v_mfma_f32_16x16x32_bf16 v[142:145], a[204:207], v[238:241], v[142:145]
    s_add_u32 m0, s34, 43040
    v_exp_f32 v223, v223
    v_mfma_f32_16x16x32_bf16 v[146:149], a[208:211], v[238:241], v[146:149]
    v_exp_f32 v224, v224
    v_mfma_f32_16x16x32_bf16 v[150:153], a[212:215], v[238:241], v[150:153]
    v_cvt_pk_bf16_f32 v242, v218, v219
    v_cvt_pk_bf16_f32 v243, v220, v221
    v_mfma_f32_16x16x32_bf16 v[226:229], a[168:171], v[42:45], v[14:17]
    v_exp_f32 v225, v225
    v_mfma_f32_16x16x32_bf16 v[226:229], a[172:175], v[46:49], v[226:229]
    ds_read_b64_tr_b16 a[240:241], v2 offset:8640
    v_cvt_pk_bf16_f32 v244, v222, v223
    v_mfma_f32_16x16x32_bf16 v[226:229], a[176:179], v[50:53], v[226:229]
    buffer_load_dwordx4 v4, s[24:27], s63 offen offset:256 lds
    v_mfma_f32_16x16x32_bf16 v[226:229], a[180:183], v[54:57], v[226:229]
    s_add_u32 m0, s33, 17408
    ds_read_b64_tr_b16 a[242:243], v2 offset:9152
    v_cvt_pk_bf16_f32 v245, v224, v225
    v_mfma_f32_16x16x32_bf16 v[230:233], a[184:187], v[42:45], v[14:17]
    ds_read_b64_tr_b16 a[244:245], v2 offset:8672
    ds_read_b64_tr_b16 a[246:247], v2 offset:9184
    v_mfma_f32_16x16x32_bf16 v[230:233], a[188:191], v[46:49], v[230:233]
    ds_read_b128 a[152:155], v1 offset:43584
    ds_read_b128 a[156:159], v1 offset:43648
    v_mfma_f32_16x16x32_bf16 v[230:233], a[192:195], v[50:53], v[230:233]
    v_exp_f32 v226, v226
    v_mfma_f32_16x16x32_bf16 v[230:233], a[196:199], v[54:57], v[230:233]
    s_waitcnt lgkmcnt(6)
    v_exp_f32 v227, v227
    v_mfma_f32_16x16x32_bf16 v[154:157], a[216:219], v[242:245], v[154:157]
    buffer_load_dwordx4 v3, s[20:23], s64 offen offset:0 lds
    v_mfma_f32_16x16x32_bf16 v[158:161], a[220:223], v[242:245], v[158:161]
    s_add_u32 m0, s33, 17472
    v_exp_f32 v228, v228
    v_mfma_f32_16x16x32_bf16 v[162:165], a[224:227], v[242:245], v[162:165]
    v_exp_f32 v229, v229
    v_mfma_f32_16x16x32_bf16 v[166:169], a[228:231], v[242:245], v[166:169]
    v_exp_f32 v230, v230
    v_mfma_f32_16x16x32_bf16 v[170:173], a[232:235], v[242:245], v[170:173]
    v_exp_f32 v231, v231
    v_mfma_f32_16x16x32_bf16 v[174:177], a[236:239], v[242:245], v[174:177]
    s_waitcnt lgkmcnt(0)
    v_exp_f32 v232, v232
    v_mfma_f32_16x16x32_bf16 v[178:181], a[240:243], v[242:245], v[178:181]
    buffer_load_dwordx4 v3, s[20:23], s64 offen offset:1024 lds
    v_mfma_f32_16x16x32_bf16 v[182:185], a[244:247], v[242:245], v[182:185]
    s_add_u32 m0, s34, 50688
    v_cvt_pk_bf16_f32 v246, v226, v227
    v_cvt_pk_bf16_f32 v247, v228, v229
    v_mfma_f32_16x16x32_bf16 v[218:221], a[168:171], v[58:61], v[18:21]
    v_exp_f32 v233, v233
    v_mfma_f32_16x16x32_bf16 v[218:221], a[172:175], v[62:65], v[218:221]
    v_cvt_pk_bf16_f32 v248, v230, v231
    v_cvt_pk_bf16_f32 v249, v232, v233
    v_mfma_f32_16x16x32_bf16 v[218:221], a[176:179], v[66:69], v[218:221]
    ds_read_b128 a[160:163], v1 offset:43712
    ds_read_b128 a[164:167], v1 offset:47872
    v_mfma_f32_16x16x32_bf16 v[218:221], a[180:183], v[70:73], v[218:221]
    v_accvgpr_read_b32 v253, a27
    v_mul_f32 v250, v250, v8
    v_mfma_f32_16x16x32_bf16 v[222:225], a[184:187], v[58:61], v[18:21]
    buffer_load_dwordx4 v4, s[24:27], s64 offen offset:0 lds
    v_mfma_f32_16x16x32_bf16 v[222:225], a[188:191], v[62:65], v[222:225]
    s_add_u32 m0, s34, 51488
    v_mul_f32 v251, v251, v8
    v_mul_f32 v252, v252, v8
    v_mfma_f32_16x16x32_bf16 v[222:225], a[192:195], v[66:69], v[222:225]
    v_exp_f32 v218, v218
    v_mfma_f32_16x16x32_bf16 v[222:225], a[196:199], v[70:73], v[222:225]
    v_exp_f32 v219, v219
    v_smfmac_f32_16x16x64_bf16 a[104:107], a[116:119], v[242:249], v7
    v_cvt_pk_bf16_f32 v234, v218, v219
    v_mfma_f32_16x16x32_bf16 v[186:189], a[216:219], v[246:249], v[186:189]
    v_exp_f32 v220, v220
    v_mfma_f32_16x16x32_bf16 v[190:193], a[220:223], v[246:249], v[190:193]
    buffer_load_dwordx4 v4, s[24:27], s64 offen offset:256 lds
    v_mfma_f32_16x16x32_bf16 v[194:197], a[224:227], v[246:249], v[194:197]
    s_add_u32 m0, s33, 26112
    v_exp_f32 v221, v221
    v_mfma_f32_16x16x32_bf16 v[198:201], a[228:231], v[246:249], v[198:201]
    v_exp_f32 v222, v222
    v_mfma_f32_16x16x32_bf16 v[202:205], a[232:235], v[246:249], v[202:205]
    v_exp_f32 v223, v223
    v_mfma_f32_16x16x32_bf16 v[206:209], a[236:239], v[246:249], v[206:209]
    v_exp_f32 v224, v224
    v_mfma_f32_16x16x32_bf16 v[210:213], a[240:243], v[246:249], v[210:213]
    v_cvt_pk_bf16_f32 v235, v220, v221
    v_cvt_pk_bf16_f32 v236, v222, v223
    v_mfma_f32_16x16x32_bf16 v[214:217], a[244:247], v[246:249], v[214:217]
    buffer_load_dwordx4 v3, s[20:23], s65 offen offset:0 lds
    v_mfma_f32_16x16x32_bf16 v[226:229], a[168:171], v[74:77], v[22:25]
    s_add_u32 m0, s33, 26176
    v_exp_f32 v225, v225
    v_mfma_f32_16x16x32_bf16 v[226:229], a[172:175], v[78:81], v[226:229]
    ds_read_b128 a[168:171], v1 offset:47936
    v_cvt_pk_bf16_f32 v237, v224, v225
    v_mfma_f32_16x16x32_bf16 v[226:229], a[176:179], v[82:85], v[226:229]
    ds_read_b128 a[172:175], v1 offset:48000
    ds_read_b128 a[176:179], v1 offset:48064
    v_mfma_f32_16x16x32_bf16 v[226:229], a[180:183], v[86:89], v[226:229]
    v_mul_f32 v253, v253, v8
    v_cvt_pk_bf16_f32 v250, v250, v251
    v_mfma_f32_16x16x32_bf16 v[230:233], a[184:187], v[74:77], v[22:25]
    ds_read_b64_tr_b16 a[248:249], v2 offset:16896
    v_cvt_pk_bf16_f32 v251, v252, v253
    v_mfma_f32_16x16x32_bf16 v[230:233], a[188:191], v[78:81], v[230:233]
    buffer_load_dwordx4 v3, s[20:23], s65 offen offset:1024 lds
    v_mfma_f32_16x16x32_bf16 v[230:233], a[192:195], v[82:85], v[230:233]
    s_add_u32 m0, s34, 59136
    v_exp_f32 v226, v226
    v_mfma_f32_16x16x32_bf16 v[230:233], a[196:199], v[86:89], v[230:233]
    v_exp_f32 v227, v227
    v_mfma_f32_16x16x32_bf16 v[90:93], a[216:219], v[234:237], v[90:93]
    v_exp_f32 v228, v228
    v_mfma_f32_16x16x32_bf16 v[94:97], a[220:223], v[234:237], v[94:97]
    v_exp_f32 v229, v229
    v_mfma_f32_16x16x32_bf16 v[98:101], a[224:227], v[234:237], v[98:101]
    v_cvt_pk_bf16_f32 v238, v226, v227
    v_cvt_pk_bf16_f32 v239, v228, v229
    v_mfma_f32_16x16x32_bf16 v[102:105], a[228:231], v[234:237], v[102:105]
    buffer_load_dwordx4 v4, s[24:27], s65 offen offset:0 lds
    v_mfma_f32_16x16x32_bf16 v[106:109], a[232:235], v[234:237], v[106:109]
    s_add_u32 m0, s34, 59936
    v_exp_f32 v230, v230
    v_mfma_f32_16x16x32_bf16 v[110:113], a[236:239], v[234:237], v[110:113]
    v_exp_f32 v231, v231
    v_mfma_f32_16x16x32_bf16 v[114:117], a[240:243], v[234:237], v[114:117]
    v_exp_f32 v232, v232
    v_mfma_f32_16x16x32_bf16 v[118:121], a[244:247], v[234:237], v[118:121]
    v_exp_f32 v233, v233
    v_mfma_f32_16x16x32_bf16 v[218:221], a[148:151], v[26:29], v[10:13]
    v_cvt_pk_bf16_f32 v240, v230, v231
    v_cvt_pk_bf16_f32 v241, v232, v233
    v_mfma_f32_16x16x32_bf16 v[218:221], a[152:155], v[30:33], v[218:221]
    buffer_load_dwordx4 v4, s[24:27], s65 offen offset:256 lds
    v_mfma_f32_16x16x32_bf16 v[218:221], a[156:159], v[34:37], v[218:221]
    s_waitcnt lgkmcnt(0)
    v_accvgpr_read_b32 v252, a28
    v_accvgpr_read_b32 v253, a29
    v_mfma_f32_16x16x32_bf16 v[218:221], a[160:163], v[38:41], v[218:221]
    ds_read_b64_tr_b16 a[250:251], v2 offset:17408
    v_accvgpr_read_b32 v255, a31
    v_mfma_f32_16x16x32_bf16 v[222:225], a[164:167], v[26:29], v[10:13]
    ds_read_b64_tr_b16 a[252:253], v2 offset:16928
    v_mul_f32 v252, v252, v8
    v_mfma_f32_16x16x32_bf16 v[222:225], a[168:171], v[30:33], v[222:225]
    ds_read_b64_tr_b16 a[254:255], v2 offset:17440
    v_mul_f32 v253, v253, v8
    v_mfma_f32_16x16x32_bf16 v[222:225], a[172:175], v[34:37], v[222:225]
    v_exp_f32 v218, v218
    v_mfma_f32_16x16x32_bf16 v[222:225], a[176:179], v[38:41], v[222:225]
    v_exp_f32 v219, v219
    v_smfmac_f32_16x16x64_bf16 a[108:111], a[116:119], v[234:241], v7
    v_mul_f32 v254, v254, v8
    v_mfma_f32_16x16x32_bf16 v[122:125], a[216:219], v[238:241], v[122:125]
    v_exp_f32 v220, v220
    v_mfma_f32_16x16x32_bf16 v[126:129], a[220:223], v[238:241], v[126:129]
    v_exp_f32 v221, v221
    v_mfma_f32_16x16x32_bf16 v[130:133], a[224:227], v[238:241], v[130:133]
    ds_read_b64_tr_b16 a[200:201], v2 offset:16960
    v_mul_f32 v255, v255, v8
    v_mfma_f32_16x16x32_bf16 v[134:137], a[228:231], v[238:241], v[134:137]
    ds_read_b64_tr_b16 a[202:203], v2 offset:17472
    v_cvt_pk_bf16_f32 v252, v252, v253
    v_mfma_f32_16x16x32_bf16 v[138:141], a[232:235], v[238:241], v[138:141]
    v_exp_f32 v222, v222
    v_mfma_f32_16x16x32_bf16 v[142:145], a[236:239], v[238:241], v[142:145]
    ds_read_b64_tr_b16 a[204:205], v2 offset:16992
    v_cvt_pk_bf16_f32 v253, v254, v255
    v_mfma_f32_16x16x32_bf16 v[146:149], a[240:243], v[238:241], v[146:149]
    ds_read_b64_tr_b16 a[206:207], v2 offset:17504
    ds_read_b64_tr_b16 a[208:209], v2 offset:17024
    v_mfma_f32_16x16x32_bf16 v[150:153], a[244:247], v[238:241], v[150:153]
    v_exp_f32 v223, v223
    v_mfma_f32_16x16x32_bf16 v[226:229], a[148:151], v[42:45], v[14:17]
    v_permlane16_swap_b32 v250, v252
    v_mfma_f32_16x16x32_bf16 v[226:229], a[152:155], v[46:49], v[226:229]
    ds_read_b64_tr_b16 a[210:211], v2 offset:17536
    ds_read_b64_tr_b16 a[212:213], v2 offset:17056
    v_mfma_f32_16x16x32_bf16 v[226:229], a[156:159], v[50:53], v[226:229]
    v_permlane16_swap_b32 v251, v253
    v_mfma_f32_16x16x32_bf16 v[226:229], a[160:163], v[54:57], v[226:229]
    v_exp_f32 v224, v224
    v_mfma_f32_16x16x32_bf16 v[230:233], a[164:167], v[42:45], v[14:17]
    buffer_store_dwordx4 v[250:253], v0, s[28:31], s42 offen offset:192 sc0 sc1
    v_cvt_pk_bf16_f32 v242, v218, v219
    v_mfma_f32_16x16x32_bf16 v[230:233], a[168:171], v[46:49], v[230:233]
    ds_read_b64_tr_b16 a[214:215], v2 offset:17568
    v_cvt_pk_bf16_f32 v243, v220, v221
    v_mfma_f32_16x16x32_bf16 v[230:233], a[172:175], v[50:53], v[230:233]
    ds_read_b64_tr_b16 a[216:217], v2 offset:17088
    ds_read_b64_tr_b16 a[218:219], v2 offset:17600
    v_exp_f32 v225, v225
    v_mfma_f32_16x16x32_bf16 v[230:233], a[176:179], v[54:57], v[230:233]
    s_waitcnt lgkmcnt(5)
    ds_read_b64_tr_b16 a[220:221], v2 offset:17120
    ds_read_b64_tr_b16 a[222:223], v2 offset:17632
    v_cvt_pk_bf16_f32 v244, v222, v223
    v_cvt_pk_bf16_f32 v245, v224, v225
    v_exp_f32 v226, v226
    s_nop 0
    v_mfma_f32_16x16x32_bf16 v[154:157], a[248:251], v[242:245], v[154:157]
    v_exp_f32 v227, v227
    v_mfma_f32_16x16x32_bf16 v[158:161], a[252:255], v[242:245], v[158:161]
    v_exp_f32 v228, v228
    v_mfma_f32_16x16x32_bf16 v[162:165], a[200:203], v[242:245], v[162:165]
    v_exp_f32 v229, v229
    v_mfma_f32_16x16x32_bf16 v[166:169], a[204:207], v[242:245], v[166:169]
    s_waitcnt lgkmcnt(5)
    v_exp_f32 v230, v230
    v_mfma_f32_16x16x32_bf16 v[170:173], a[208:211], v[242:245], v[170:173]
    s_waitcnt lgkmcnt(4)
    v_exp_f32 v231, v231
    v_mfma_f32_16x16x32_bf16 v[174:177], a[212:215], v[242:245], v[174:177]
    s_waitcnt lgkmcnt(2)
    v_exp_f32 v232, v232
    v_mfma_f32_16x16x32_bf16 v[178:181], a[216:219], v[242:245], v[178:181]
    s_waitcnt lgkmcnt(0)
    v_cvt_pk_bf16_f32 v246, v226, v227
    v_cvt_pk_bf16_f32 v247, v228, v229
    v_mfma_f32_16x16x32_bf16 v[182:185], a[220:223], v[242:245], v[182:185]
    v_exp_f32 v233, v233
    v_mfma_f32_16x16x32_bf16 v[218:221], a[148:151], v[58:61], v[18:21]
    v_cvt_pk_bf16_f32 v248, v230, v231
    v_cvt_pk_bf16_f32 v249, v232, v233
    v_mfma_f32_16x16x32_bf16 v[218:221], a[152:155], v[62:65], v[218:221]
    ds_read_b128 a[180:183], v1 offset:52224
    ds_read_b128 a[184:187], v1 offset:52288
    v_mfma_f32_16x16x32_bf16 v[218:221], a[156:159], v[66:69], v[218:221]
    ds_read_b128 a[188:191], v1 offset:52352
    ds_read_b128 a[192:195], v1 offset:52416
    v_mfma_f32_16x16x32_bf16 v[218:221], a[160:163], v[70:73], v[218:221]
    ds_read_b128 a[196:199], v1 offset:56576
    v_accvgpr_read_b32 v9, a102
    v_mfma_f32_16x16x32_bf16 v[222:225], a[164:167], v[58:61], v[18:21]
    ds_read_b64_tr_b16 a[224:225], v2 offset:25344
    v_accvgpr_read_b32 v255, a103
    v_mfma_f32_16x16x32_bf16 v[222:225], a[168:171], v[62:65], v[222:225]
    ds_read_b64_tr_b16 a[226:227], v2 offset:25856
    v_add_f32 v9, v9, v255
    v_mfma_f32_16x16x32_bf16 v[222:225], a[172:175], v[66:69], v[222:225]
    v_exp_f32 v218, v218
    v_mfma_f32_16x16x32_bf16 v[222:225], a[176:179], v[70:73], v[222:225]
    v_exp_f32 v219, v219
    v_smfmac_f32_16x16x64_bf16 a[104:107], a[116:119], v[242:249], v7
    v_cvt_pk_bf16_f32 v234, v218, v219
    v_mfma_f32_16x16x32_bf16 v[186:189], a[248:251], v[246:249], v[186:189]
    v_exp_f32 v220, v220
    v_mfma_f32_16x16x32_bf16 v[190:193], a[252:255], v[246:249], v[190:193]
    v_exp_f32 v221, v221
    v_mfma_f32_16x16x32_bf16 v[194:197], a[200:203], v[246:249], v[194:197]
    v_exp_f32 v222, v222
    v_mfma_f32_16x16x32_bf16 v[198:201], a[204:207], v[246:249], v[198:201]
    v_exp_f32 v223, v223
    v_mfma_f32_16x16x32_bf16 v[202:205], a[208:211], v[246:249], v[202:205]
    v_exp_f32 v224, v224
    v_mfma_f32_16x16x32_bf16 v[206:209], a[212:215], v[246:249], v[206:209]
    v_cvt_pk_bf16_f32 v235, v220, v221
    v_cvt_pk_bf16_f32 v236, v222, v223
    v_mfma_f32_16x16x32_bf16 v[210:213], a[216:219], v[246:249], v[210:213]
    v_exp_f32 v225, v225
    v_mfma_f32_16x16x32_bf16 v[214:217], a[220:223], v[246:249], v[214:217]
    v_cvt_pk_bf16_f32 v237, v224, v225
    v_cmp_nle_f32_e64 s[48:49], v9, s35
    v_mfma_f32_16x16x32_bf16 v[226:229], a[148:151], v[74:77], v[22:25]
    ds_read_b128 a[148:151], v1 offset:56640
    ds_read_b64_tr_b16 a[228:229], v2 offset:25376
    v_mfma_f32_16x16x32_bf16 v[226:229], a[152:155], v[78:81], v[226:229]
    s_or_b64 s[36:37], s[36:37], s[48:49]
    ds_read_b128 a[152:155], v1 offset:56704
    ds_read_b64_tr_b16 a[230:231], v2 offset:25888
    v_mfma_f32_16x16x32_bf16 v[226:229], a[156:159], v[82:85], v[226:229]
    ds_read_b128 a[156:159], v1 offset:56768
    ds_read_b64_tr_b16 a[232:233], v2 offset:25408
    v_mfma_f32_16x16x32_bf16 v[226:229], a[160:163], v[86:89], v[226:229]
    ds_read_b64_tr_b16 a[234:235], v2 offset:25920
    ds_read_b64_tr_b16 a[236:237], v2 offset:25440
    v_mfma_f32_16x16x32_bf16 v[230:233], a[164:167], v[74:77], v[22:25]
    ds_read_b64_tr_b16 a[238:239], v2 offset:25952
    ds_read_b64_tr_b16 a[240:241], v2 offset:25472
    v_mfma_f32_16x16x32_bf16 v[230:233], a[168:171], v[78:81], v[230:233]
    ds_read_b64_tr_b16 a[242:243], v2 offset:25984
    ds_read_b64_tr_b16 a[244:245], v2 offset:25504
    v_mfma_f32_16x16x32_bf16 v[230:233], a[172:175], v[82:85], v[230:233]
    v_exp_f32 v226, v226
    v_mfma_f32_16x16x32_bf16 v[230:233], a[176:179], v[86:89], v[230:233]
    v_exp_f32 v227, v227
    v_mfma_f32_16x16x32_bf16 v[90:93], a[248:251], v[234:237], v[90:93]
    v_exp_f32 v228, v228
    v_mfma_f32_16x16x32_bf16 v[94:97], a[252:255], v[234:237], v[94:97]
    v_exp_f32 v229, v229
    v_mfma_f32_16x16x32_bf16 v[98:101], a[200:203], v[234:237], v[98:101]
    v_cvt_pk_bf16_f32 v238, v226, v227
    v_cvt_pk_bf16_f32 v239, v228, v229
    v_mfma_f32_16x16x32_bf16 v[102:105], a[204:207], v[234:237], v[102:105]
    v_exp_f32 v230, v230
    v_mfma_f32_16x16x32_bf16 v[106:109], a[208:211], v[234:237], v[106:109]
    v_exp_f32 v231, v231
    v_mfma_f32_16x16x32_bf16 v[110:113], a[212:215], v[234:237], v[110:113]
    v_exp_f32 v232, v232
    v_mfma_f32_16x16x32_bf16 v[114:117], a[216:219], v[234:237], v[114:117]
    v_exp_f32 v233, v233
    v_mfma_f32_16x16x32_bf16 v[118:121], a[220:223], v[234:237], v[118:121]
    s_waitcnt lgkmcnt(0)
    v_cvt_pk_bf16_f32 v240, v230, v231
    v_cvt_pk_bf16_f32 v241, v232, v233
    v_mfma_f32_16x16x32_bf16 v[218:221], a[180:183], v[26:29], v[10:13]
    ds_read_b64_tr_b16 a[246:247], v2 offset:26016
    v_accvgpr_read_b32 v250, a32
    v_mfma_f32_16x16x32_bf16 v[218:221], a[184:187], v[30:33], v[218:221]
    v_accvgpr_read_b32 v251, a33
    v_accvgpr_read_b32 v252, a34
    v_mfma_f32_16x16x32_bf16 v[218:221], a[188:191], v[34:37], v[218:221]
    v_rcp_f32 v9, v9
    v_mfma_f32_16x16x32_bf16 v[218:221], a[192:195], v[38:41], v[218:221]
    v_accvgpr_read_b32 v253, a35
    v_mul_f32 v250, v250, v9
    v_mfma_f32_16x16x32_bf16 v[222:225], a[196:199], v[26:29], v[10:13]
    v_mul_f32 v251, v251, v9
    v_mul_f32 v252, v252, v9
    v_mfma_f32_16x16x32_bf16 v[222:225], a[148:151], v[30:33], v[222:225]
    v_mul_f32 v253, v253, v9
    v_cvt_pk_bf16_f32 v250, v250, v251
    v_mfma_f32_16x16x32_bf16 v[222:225], a[152:155], v[34:37], v[222:225]
    v_exp_f32 v218, v218
    v_mfma_f32_16x16x32_bf16 v[222:225], a[156:159], v[38:41], v[222:225]
    v_exp_f32 v219, v219
    v_smfmac_f32_16x16x64_bf16 a[108:111], a[116:119], v[234:241], v7
    v_cvt_pk_bf16_f32 v242, v218, v219
    v_mfma_f32_16x16x32_bf16 v[122:125], a[248:251], v[238:241], v[122:125]
    v_exp_f32 v220, v220
    v_mfma_f32_16x16x32_bf16 v[126:129], a[252:255], v[238:241], v[126:129]
    v_exp_f32 v221, v221
    v_mfma_f32_16x16x32_bf16 v[130:133], a[200:203], v[238:241], v[130:133]
    v_exp_f32 v222, v222
    v_mfma_f32_16x16x32_bf16 v[134:137], a[204:207], v[238:241], v[134:137]
    v_exp_f32 v223, v223
    v_mfma_f32_16x16x32_bf16 v[138:141], a[208:211], v[238:241], v[138:141]
    v_exp_f32 v224, v224
    v_mfma_f32_16x16x32_bf16 v[142:145], a[212:215], v[238:241], v[142:145]
    ds_read_b64_tr_b16 a[248:249], v2 offset:25536
    v_cvt_pk_bf16_f32 v243, v220, v221
    v_mfma_f32_16x16x32_bf16 v[146:149], a[216:219], v[238:241], v[146:149]
    v_exp_f32 v225, v225
    v_mfma_f32_16x16x32_bf16 v[150:153], a[220:223], v[238:241], v[150:153]
    ds_read_b64_tr_b16 a[250:251], v2 offset:26048
    v_cvt_pk_bf16_f32 v244, v222, v223
    v_mfma_f32_16x16x32_bf16 v[226:229], a[180:183], v[42:45], v[14:17]
    ds_read_b64_tr_b16 a[252:253], v2 offset:25568
    v_cvt_pk_bf16_f32 v245, v224, v225
    v_mfma_f32_16x16x32_bf16 v[226:229], a[184:187], v[46:49], v[226:229]
    ds_read_b64_tr_b16 a[254:255], v2 offset:26080
    v_cvt_pk_bf16_f32 v251, v252, v253
    v_mfma_f32_16x16x32_bf16 v[226:229], a[188:191], v[50:53], v[226:229]
    v_accvgpr_read_b32 v252, a36
    v_accvgpr_read_b32 v253, a37
    v_mfma_f32_16x16x32_bf16 v[226:229], a[192:195], v[54:57], v[226:229]
    v_accvgpr_read_b32 v254, a38
    v_accvgpr_read_b32 v255, a39
    v_mfma_f32_16x16x32_bf16 v[230:233], a[196:199], v[42:45], v[14:17]
    v_mul_f32 v252, v252, v9
    v_mul_f32 v253, v253, v9
    v_mfma_f32_16x16x32_bf16 v[230:233], a[148:151], v[46:49], v[230:233]
    v_mul_f32 v254, v254, v9
    v_mul_f32 v255, v255, v9
    v_mfma_f32_16x16x32_bf16 v[230:233], a[152:155], v[50:53], v[230:233]
    v_exp_f32 v226, v226
    v_mfma_f32_16x16x32_bf16 v[230:233], a[156:159], v[54:57], v[230:233]
    v_exp_f32 v227, v227
    v_mfma_f32_16x16x32_bf16 v[154:157], a[224:227], v[242:245], v[154:157]
    v_exp_f32 v228, v228
    v_mfma_f32_16x16x32_bf16 v[158:161], a[228:231], v[242:245], v[158:161]
    v_exp_f32 v229, v229
    v_mfma_f32_16x16x32_bf16 v[162:165], a[232:235], v[242:245], v[162:165]
    v_cvt_pk_bf16_f32 v246, v226, v227
    v_cvt_pk_bf16_f32 v247, v228, v229
    v_mfma_f32_16x16x32_bf16 v[166:169], a[236:239], v[242:245], v[166:169]
    v_exp_f32 v230, v230
    v_mfma_f32_16x16x32_bf16 v[170:173], a[240:243], v[242:245], v[170:173]
    s_waitcnt lgkmcnt(0)
    v_exp_f32 v231, v231
    v_mfma_f32_16x16x32_bf16 v[174:177], a[244:247], v[242:245], v[174:177]
    v_exp_f32 v232, v232
    v_mfma_f32_16x16x32_bf16 v[178:181], a[248:251], v[242:245], v[178:181]
    v_exp_f32 v233, v233
    v_mfma_f32_16x16x32_bf16 v[182:185], a[252:255], v[242:245], v[182:185]
    v_cvt_pk_bf16_f32 v248, v230, v231
    v_cvt_pk_bf16_f32 v249, v232, v233
    v_mfma_f32_16x16x32_bf16 v[218:221], a[180:183], v[58:61], v[18:21]
    ds_read_b128 a[160:163], v1 offset:0
    v_cvt_pk_bf16_f32 v252, v252, v253
    v_mfma_f32_16x16x32_bf16 v[218:221], a[184:187], v[62:65], v[218:221]
    ds_read_b128 a[164:167], v1 offset:64
    v_cvt_pk_bf16_f32 v253, v254, v255
    v_mfma_f32_16x16x32_bf16 v[218:221], a[188:191], v[66:69], v[218:221]
    v_permlane16_swap_b32 v250, v252
    v_mfma_f32_16x16x32_bf16 v[218:221], a[192:195], v[70:73], v[218:221]
    v_permlane16_swap_b32 v251, v253
    v_mfma_f32_16x16x32_bf16 v[222:225], a[196:199], v[58:61], v[18:21]
    buffer_store_dwordx4 v[250:253], v0, s[28:31], s43 offen offset:0 sc0 sc1
    v_accvgpr_read_b32 v254, a46
    v_mfma_f32_16x16x32_bf16 v[222:225], a[148:151], v[62:65], v[222:225]
    ds_read_b128 a[168:171], v1 offset:128
    ds_read_b128 a[172:175], v1 offset:192
    v_mfma_f32_16x16x32_bf16 v[222:225], a[152:155], v[66:69], v[222:225]
    v_exp_f32 v218, v218
    v_mfma_f32_16x16x32_bf16 v[222:225], a[156:159], v[70:73], v[222:225]
    v_exp_f32 v219, v219
    v_smfmac_f32_16x16x64_bf16 a[104:107], a[116:119], v[242:249], v7
    v_cvt_pk_bf16_f32 v234, v218, v219
    v_mfma_f32_16x16x32_bf16 v[186:189], a[224:227], v[246:249], v[186:189]
    v_exp_f32 v220, v220
    v_mfma_f32_16x16x32_bf16 v[190:193], a[228:231], v[246:249], v[190:193]
    v_exp_f32 v221, v221
    v_mfma_f32_16x16x32_bf16 v[194:197], a[232:235], v[246:249], v[194:197]
    v_exp_f32 v222, v222
    v_mfma_f32_16x16x32_bf16 v[198:201], a[236:239], v[246:249], v[198:201]
    v_exp_f32 v223, v223
    v_mfma_f32_16x16x32_bf16 v[202:205], a[240:243], v[246:249], v[202:205]
    v_exp_f32 v224, v224
    v_mfma_f32_16x16x32_bf16 v[206:209], a[244:247], v[246:249], v[206:209]
    v_cvt_pk_bf16_f32 v235, v220, v221
    v_cvt_pk_bf16_f32 v236, v222, v223
    v_mfma_f32_16x16x32_bf16 v[210:213], a[248:251], v[246:249], v[210:213]
    v_exp_f32 v225, v225
    v_mfma_f32_16x16x32_bf16 v[214:217], a[252:255], v[246:249], v[214:217]
    ds_read_b128 a[176:179], v1 offset:4352
    v_cvt_pk_bf16_f32 v237, v224, v225
    v_mfma_f32_16x16x32_bf16 v[226:229], a[180:183], v[74:77], v[22:25]
    ds_read_b128 a[180:183], v1 offset:4416
    v_accvgpr_read_b32 v250, a40
    v_mfma_f32_16x16x32_bf16 v[226:229], a[184:187], v[78:81], v[226:229]
    ds_read_b128 a[184:187], v1 offset:4480
    v_accvgpr_read_b32 v251, a41
    v_mfma_f32_16x16x32_bf16 v[226:229], a[188:191], v[82:85], v[226:229]
    ds_read_b128 a[188:191], v1 offset:4544
    v_accvgpr_read_b32 v252, a42
    v_mfma_f32_16x16x32_bf16 v[226:229], a[192:195], v[86:89], v[226:229]
    v_accvgpr_read_b32 v253, a43
    v_mul_f32 v250, v250, v9
    v_mfma_f32_16x16x32_bf16 v[230:233], a[196:199], v[74:77], v[22:25]
    v_mul_f32 v251, v251, v9
    v_mul_f32 v252, v252, v9
    v_mfma_f32_16x16x32_bf16 v[230:233], a[148:151], v[78:81], v[230:233]
    v_mul_f32 v253, v253, v9
    v_cvt_pk_bf16_f32 v250, v250, v251
    v_mfma_f32_16x16x32_bf16 v[230:233], a[152:155], v[82:85], v[230:233]
    v_exp_f32 v226, v226
    v_mfma_f32_16x16x32_bf16 v[230:233], a[156:159], v[86:89], v[230:233]
    v_exp_f32 v227, v227
    v_mfma_f32_16x16x32_bf16 v[90:93], a[224:227], v[234:237], v[90:93]
    v_exp_f32 v228, v228
    v_mfma_f32_16x16x32_bf16 v[94:97], a[228:231], v[234:237], v[94:97]
    v_exp_f32 v229, v229
    v_mfma_f32_16x16x32_bf16 v[98:101], a[232:235], v[234:237], v[98:101]
    v_cvt_pk_bf16_f32 v238, v226, v227
    v_cvt_pk_bf16_f32 v239, v228, v229
    v_mfma_f32_16x16x32_bf16 v[102:105], a[236:239], v[234:237], v[102:105]
    v_exp_f32 v230, v230
    v_mfma_f32_16x16x32_bf16 v[106:109], a[240:243], v[234:237], v[106:109]
    v_exp_f32 v231, v231
    v_mfma_f32_16x16x32_bf16 v[110:113], a[244:247], v[234:237], v[110:113]
    v_exp_f32 v232, v232
    v_mfma_f32_16x16x32_bf16 v[114:117], a[248:251], v[234:237], v[114:117]
    v_exp_f32 v233, v233
    v_mfma_f32_16x16x32_bf16 v[118:121], a[252:255], v[234:237], v[118:121]
    v_cvt_pk_bf16_f32 v240, v230, v231
    v_cvt_pk_bf16_f32 v241, v232, v233
    s_waitcnt vmcnt(4)
    s_barrier
    s_waitcnt lgkmcnt(0)
    ds_read_b64_tr_b16 a[200:201], v2 offset:33792
    ds_read_b64_tr_b16 a[202:203], v2 offset:34304
    v_mfma_f32_16x16x32_bf16 v[218:221], a[160:163], v[26:29], v[10:13]
    s_add_u32 m0, s33, 34816
    ds_read_b64_tr_b16 a[204:205], v2 offset:33824
    ds_read_b64_tr_b16 a[206:207], v2 offset:34336
    v_mfma_f32_16x16x32_bf16 v[218:221], a[164:167], v[30:33], v[218:221]
    buffer_load_dwordx4 v3, s[20:23], s50 offen offset:0 lds
    v_mfma_f32_16x16x32_bf16 v[218:221], a[168:171], v[34:37], v[218:221]
    s_add_u32 m0, s33, 34880
    ds_read_b64_tr_b16 a[208:209], v2 offset:33856
    ds_read_b64_tr_b16 a[210:211], v2 offset:34368
    v_mfma_f32_16x16x32_bf16 v[218:221], a[172:175], v[38:41], v[218:221]
    ds_read_b64_tr_b16 a[212:213], v2 offset:33888
    ds_read_b64_tr_b16 a[214:215], v2 offset:34400
    v_mfma_f32_16x16x32_bf16 v[222:225], a[176:179], v[26:29], v[10:13]
    ds_read_b64_tr_b16 a[216:217], v2 offset:33920
    ds_read_b64_tr_b16 a[218:219], v2 offset:34432
    v_mfma_f32_16x16x32_bf16 v[222:225], a[180:183], v[30:33], v[222:225]
L_pad8:
    s_cbranch_vccnz L_warm
    ds_read_b64_tr_b16 a[220:221], v2 offset:33952
    ds_read_b64_tr_b16 a[222:223], v2 offset:34464
    v_mfma_f32_16x16x32_bf16 v[222:225], a[184:187], v[34:37], v[222:225]
    v_exp_f32 v218, v218
    v_mfma_f32_16x16x32_bf16 v[222:225], a[188:191], v[38:41], v[222:225]
    buffer_load_dwordx4 v3, s[20:23], s50 offen offset:1024 lds
    v_smfmac_f32_16x16x64_bf16 a[108:111], a[116:119], v[234:241], v7
    s_add_u32 m0, s34, 0
    v_cvt_pk_bf16_f32 v251, v252, v253
    v_mfma_f32_16x16x32_bf16 v[122:125], a[224:227], v[238:241], v[122:125]
    v_exp_f32 v219, v219
    v_mfma_f32_16x16x32_bf16 v[126:129], a[228:231], v[238:241], v[126:129]
    v_exp_f32 v220, v220
    v_mfma_f32_16x16x32_bf16 v[130:133], a[232:235], v[238:241], v[130:133]
    v_exp_f32 v221, v221
    v_mfma_f32_16x16x32_bf16 v[134:137], a[236:239], v[238:241], v[134:137]
    v_exp_f32 v222, v222
    v_mfma_f32_16x16x32_bf16 v[138:141], a[240:243], v[238:241], v[138:141]
    buffer_load_dwordx4 v4, s[24:27], s50 offen offset:0 lds
    v_mfma_f32_16x16x32_bf16 v[142:145], a[244:247], v[238:241], v[142:145]
    s_add_u32 m0, s34, 800
    v_exp_f32 v223, v223
    v_mfma_f32_16x16x32_bf16 v[146:149], a[248:251], v[238:241], v[146:149]
    v_exp_f32 v224, v224
    v_mfma_f32_16x16x32_bf16 v[150:153], a[252:255], v[238:241], v[150:153]
    v_cvt_pk_bf16_f32 v242, v218, v219
    v_cvt_pk_bf16_f32 v243, v220, v221
    v_mfma_f32_16x16x32_bf16 v[226:229], a[160:163], v[42:45], v[14:17]
    v_exp_f32 v225, v225
    v_mfma_f32_16x16x32_bf16 v[226:229], a[164:167], v[46:49], v[226:229]
    v_cvt_pk_bf16_f32 v244, v222, v223
    v_cvt_pk_bf16_f32 v245, v224, v225
    v_mfma_f32_16x16x32_bf16 v[226:229], a[168:171], v[50:53], v[226:229]
    buffer_load_dwordx4 v4, s[24:27], s50 offen offset:256 lds
    v_mfma_f32_16x16x32_bf16 v[226:229], a[172:175], v[54:57], v[226:229]
    s_add_u32 m0, s33, 43520
    ds_read_b64_tr_b16 a[224:225], v2 offset:33984
    ds_read_b64_tr_b16 a[226:227], v2 offset:34496
    v_mfma_f32_16x16x32_bf16 v[230:233], a[176:179], v[42:45], v[14:17]
    ds_read_b64_tr_b16 a[228:229], v2 offset:34016
    ds_read_b64_tr_b16 a[230:231], v2 offset:34528
    v_mfma_f32_16x16x32_bf16 v[230:233], a[180:183], v[46:49], v[230:233]
    v_accvgpr_read_b32 v252, a44
    v_accvgpr_read_b32 v253, a45
    v_mfma_f32_16x16x32_bf16 v[230:233], a[184:187], v[50:53], v[230:233]
    v_accvgpr_read_b32 v255, a47
    v_mul_f32 v252, v252, v9
    v_mfma_f32_16x16x32_bf16 v[230:233], a[188:191], v[54:57], v[230:233]
    s_waitcnt lgkmcnt(4)
    v_mul_f32 v253, v253, v9
    v_mul_f32 v254, v254, v9
    v_mfma_f32_16x16x32_bf16 v[154:157], a[200:203], v[242:245], v[154:157]
    buffer_load_dwordx4 v3, s[20:23], s51 offen offset:0 lds
    v_mfma_f32_16x16x32_bf16 v[158:161], a[204:207], v[242:245], v[158:161]
    s_add_u32 m0, s33, 43584
    v_mul_f32 v255, v255, v9
    v_cvt_pk_bf16_f32 v252, v252, v253
    v_mfma_f32_16x16x32_bf16 v[162:165], a[208:211], v[242:245], v[162:165]
    v_exp_f32 v226, v226
    v_mfma_f32_16x16x32_bf16 v[166:169], a[212:215], v[242:245], v[166:169]
    ds_read_b128 a[192:195], v1 offset:8704
    v_cvt_pk_bf16_f32 v253, v254, v255
    v_mfma_f32_16x16x32_bf16 v[170:173], a[216:219], v[242:245], v[170:173]
    v_exp_f32 v227, v227
    v_mfma_f32_16x16x32_bf16 v[174:177], a[220:223], v[242:245], v[174:177]
    s_waitcnt lgkmcnt(1)
    v_permlane16_swap_b32 v250, v252
    v_mfma_f32_16x16x32_bf16 v[178:181], a[224:227], v[242:245], v[178:181]
    buffer_load_dwordx4 v3, s[20:23], s51 offen offset:1024 lds
    v_mfma_f32_16x16x32_bf16 v[182:185], a[228:231], v[242:245], v[182:185]
    s_add_u32 m0, s34, 8448
    v_permlane16_swap_b32 v251, v253
    v_mfma_f32_16x16x32_bf16 v[218:221], a[160:163], v[58:61], v[18:21]
    v_exp_f32 v228, v228
    v_mfma_f32_16x16x32_bf16 v[218:221], a[164:167], v[62:65], v[218:221]
    v_exp_f32 v229, v229
    v_mfma_f32_16x16x32_bf16 v[218:221], a[168:171], v[66:69], v[218:221]
    v_exp_f32 v230, v230
    v_mfma_f32_16x16x32_bf16 v[218:221], a[172:175], v[70:73], v[218:221]
    v_exp_f32 v231, v231
    v_mfma_f32_16x16x32_bf16 v[222:225], a[176:179], v[58:61], v[18:21]
    v_exp_f32 v232, v232
    v_mfma_f32_16x16x32_bf16 v[222:225], a[180:183], v[62:65], v[222:225]
    v_cvt_pk_bf16_f32 v246, v226, v227
    v_exp_f32 v233, v233
    v_mfma_f32_16x16x32_bf16 v[222:225], a[184:187], v[66:69], v[222:225]
    buffer_load_dwordx4 v4, s[24:27], s51 offen offset:0 lds
    v_mfma_f32_16x16x32_bf16 v[222:225], a[188:191], v[70:73], v[222:225]
    s_add_u32 m0, s34, 9248
    v_cvt_pk_bf16_f32 v247, v228, v229
    v_cvt_pk_bf16_f32 v248, v230, v231
    v_cvt_pk_bf16_f32 v249, v232, v233
    v_exp_f32 v218, v218
    s_nop 0
    v_smfmac_f32_16x16x64_bf16 a[104:107], a[116:119], v[242:249], v7
    ds_read_b128 a[196:199], v1 offset:8768
    v_mfma_f32_16x16x32_bf16 v[186:189], a[200:203], v[246:249], v[186:189]
    v_exp_f32 v219, v219
    v_mfma_f32_16x16x32_bf16 v[190:193], a[204:207], v[246:249], v[190:193]
    buffer_load_dwordx4 v4, s[24:27], s51 offen offset:256 lds
    v_mfma_f32_16x16x32_bf16 v[194:197], a[208:211], v[246:249], v[194:197]
    s_add_u32 m0, s33, 52224
    v_exp_f32 v220, v220
    v_mfma_f32_16x16x32_bf16 v[198:201], a[212:215], v[246:249], v[198:201]
    v_exp_f32 v221, v221
    v_mfma_f32_16x16x32_bf16 v[202:205], a[216:219], v[246:249], v[202:205]
    v_exp_f32 v222, v222
    v_mfma_f32_16x16x32_bf16 v[206:209], a[220:223], v[246:249], v[206:209]
    v_exp_f32 v223, v223
    v_mfma_f32_16x16x32_bf16 v[210:213], a[224:227], v[246:249], v[210:213]
    v_exp_f32 v224, v224
    v_mfma_f32_16x16x32_bf16 v[214:217], a[228:231], v[246:249], v[214:217]
    buffer_load_dwordx4 v3, s[20:23], s52 offen offset:0 lds
    v_mfma_f32_16x16x32_bf16 v[226:229], a[160:163], v[74:77], v[22:25]
    s_add_u32 m0, s33, 52288
    v_cvt_pk_bf16_f32 v234, v218, v219
    v_cvt_pk_bf16_f32 v235, v220, v221
    v_mfma_f32_16x16x32_bf16 v[226:229], a[164:167], v[78:81], v[226:229]
    v_exp_f32 v225, v225
    v_mfma_f32_16x16x32_bf16 v[226:229], a[168:171], v[82:85], v[226:229]
    v_cvt_pk_bf16_f32 v236, v222, v223
    v_cvt_pk_bf16_f32 v237, v224, v225
    v_mfma_f32_16x16x32_bf16 v[226:229], a[172:175], v[86:89], v[226:229]
    ds_read_b128 a[148:151], v1 offset:8832
    ds_read_b128 a[152:155], v1 offset:8896
    v_mfma_f32_16x16x32_bf16 v[230:233], a[176:179], v[74:77], v[22:25]
    ds_read_b128 a[156:159], v1 offset:13056
    ds_read_b128 a[160:163], v1 offset:13120
    v_mfma_f32_16x16x32_bf16 v[230:233], a[180:183], v[78:81], v[230:233]
    buffer_load_dwordx4 v3, s[20:23], s52 offen offset:1024 lds
    v_mfma_f32_16x16x32_bf16 v[230:233], a[184:187], v[82:85], v[230:233]
    s_add_u32 m0, s34, 16896
    v_exp_f32 v226, v226
    v_mfma_f32_16x16x32_bf16 v[230:233], a[188:191], v[86:89], v[230:233]
    ds_read_b128 a[164:167], v1 offset:13184
    ds_read_b128 a[168:171], v1 offset:13248
    v_mfma_f32_16x16x32_bf16 v[90:93], a[200:203], v[234:237], v[90:93]
    buffer_store_dwordx4 v[250:253], v0, s[28:31], s43 offen offset:64 sc0 sc1
    v_accvgpr_read_b32 v254, a54
    v_mfma_f32_16x16x32_bf16 v[94:97], a[204:207], v[234:237], v[94:97]
    v_exp_f32 v227, v227
    v_mfma_f32_16x16x32_bf16 v[98:101], a[208:211], v[234:237], v[98:101]
    v_exp_f32 v228, v228
    v_mfma_f32_16x16x32_bf16 v[102:105], a[212:215], v[234:237], v[102:105]
    buffer_load_dwordx4 v4, s[24:27], s52 offen offset:0 lds
    v_mfma_f32_16x16x32_bf16 v[106:109], a[216:219], v[234:237], v[106:109]
    s_add_u32 m0, s34, 17696
    v_exp_f32 v229, v229
    v_mfma_f32_16x16x32_bf16 v[110:113], a[220:223], v[234:237], v[110:113]
    v_exp_f32 v230, v230
    v_mfma_f32_16x16x32_bf16 v[114:117], a[224:227], v[234:237], v[114:117]
    v_exp_f32 v231, v231
    v_mfma_f32_16x16x32_bf16 v[118:121], a[228:231], v[234:237], v[118:121]
    s_waitcnt lgkmcnt(0)
    v_exp_f32 v232, v232
    v_mfma_f32_16x16x32_bf16 v[218:221], a[192:195], v[26:29], v[10:13]
    v_cvt_pk_bf16_f32 v238, v226, v227
    v_cvt_pk_bf16_f32 v239, v228, v229
    v_mfma_f32_16x16x32_bf16 v[218:221], a[196:199], v[30:33], v[218:221]
    buffer_load_dwordx4 v4, s[24:27], s52 offen offset:256 lds
    v_mfma_f32_16x16x32_bf16 v[218:221], a[148:151], v[34:37], v[218:221]
    v_exp_f32 v233, v233
    v_mfma_f32_16x16x32_bf16 v[218:221], a[152:155], v[38:41], v[218:221]
    v_cvt_pk_bf16_f32 v240, v230, v231
    v_cvt_pk_bf16_f32 v241, v232, v233
    v_mfma_f32_16x16x32_bf16 v[222:225], a[156:159], v[26:29], v[10:13]
    v_accvgpr_read_b32 v250, a48
    v_accvgpr_read_b32 v251, a49
    v_mfma_f32_16x16x32_bf16 v[222:225], a[160:163], v[30:33], v[222:225]
    v_accvgpr_read_b32 v252, a50
    v_accvgpr_read_b32 v253, a51
    v_mfma_f32_16x16x32_bf16 v[222:225], a[164:167], v[34:37], v[222:225]
    v_mul_f32 v250, v250, v9
    v_mul_f32 v251, v251, v9
    v_mfma_f32_16x16x32_bf16 v[222:225], a[168:171], v[38:41], v[222:225]
    v_mul_f32 v252, v252, v9
    v_mul_f32 v253, v253, v9
    v_smfmac_f32_16x16x64_bf16 a[108:111], a[116:119], v[234:241], v7
    v_cvt_pk_bf16_f32 v250, v250, v251
    v_mfma_f32_16x16x32_bf16 v[122:125], a[200:203], v[238:241], v[122:125]
    v_cvt_pk_bf16_f32 v251, v252, v253
    v_accvgpr_read_b32 v252, a52
    v_mfma_f32_16x16x32_bf16 v[126:129], a[204:207], v[238:241], v[126:129]
    v_accvgpr_read_b32 v253, a53
    v_accvgpr_read_b32 v255, a55
    v_mfma_f32_16x16x32_bf16 v[130:133], a[208:211], v[238:241], v[130:133]
    v_mul_f32 v252, v252, v9
    v_mul_f32 v253, v253, v9
    v_mfma_f32_16x16x32_bf16 v[134:137], a[212:215], v[238:241], v[134:137]
    v_mul_f32 v254, v254, v9
    v_mul_f32 v255, v255, v9
    v_mfma_f32_16x16x32_bf16 v[138:141], a[216:219], v[238:241], v[138:141]
    ds_read_b64_tr_b16 a[232:233], v2 offset:42240
    v_cvt_pk_bf16_f32 v252, v252, v253
    v_mfma_f32_16x16x32_bf16 v[142:145], a[220:223], v[238:241], v[142:145]
    v_exp_f32 v218, v218
    v_mfma_f32_16x16x32_bf16 v[146:149], a[224:227], v[238:241], v[146:149]
    ds_read_b64_tr_b16 a[234:235], v2 offset:42752
    v_cvt_pk_bf16_f32 v253, v254, v255
    v_mfma_f32_16x16x32_bf16 v[150:153], a[228:231], v[238:241], v[150:153]
    v_exp_f32 v219, v219
    v_mfma_f32_16x16x32_bf16 v[226:229], a[192:195], v[42:45], v[14:17]
    v_permlane16_swap_b32 v250, v252
    v_mfma_f32_16x16x32_bf16 v[226:229], a[196:199], v[46:49], v[226:229]
    ds_read_b64_tr_b16 a[236:237], v2 offset:42272
    ds_read_b64_tr_b16 a[238:239], v2 offset:42784
    v_permlane16_swap_b32 v251, v253
    v_mfma_f32_16x16x32_bf16 v[226:229], a[148:151], v[50:53], v[226:229]
    ds_read_b64_tr_b16 a[240:241], v2 offset:42304
    ds_read_b64_tr_b16 a[242:243], v2 offset:42816
    buffer_store_dwordx4 v[250:253], v0, s[28:31], s43 offen offset:128 sc0 sc1
    v_cvt_pk_bf16_f32 v242, v218, v219
    v_mfma_f32_16x16x32_bf16 v[226:229], a[152:155], v[54:57], v[226:229]
    ds_read_b64_tr_b16 a[244:245], v2 offset:42336
    ds_read_b64_tr_b16 a[246:247], v2 offset:42848
    v_mfma_f32_16x16x32_bf16 v[230:233], a[156:159], v[42:45], v[14:17]
    ds_read_b64_tr_b16 a[248:249], v2 offset:42368
    ds_read_b64_tr_b16 a[250:251], v2 offset:42880
    v_mfma_f32_16x16x32_bf16 v[230:233], a[160:163], v[46:49], v[230:233]
    ds_read_b64_tr_b16 a[252:253], v2 offset:42400
    ds_read_b64_tr_b16 a[254:255], v2 offset:42912
    v_mfma_f32_16x16x32_bf16 v[230:233], a[164:167], v[50:53], v[230:233]
    ds_read_b64_tr_b16 a[200:201], v2 offset:42432
    ds_read_b64_tr_b16 a[202:203], v2 offset:42944
    v_exp_f32 v220, v220
    v_exp_f32 v221, v221
    v_exp_f32 v222, v222
    v_exp_f32 v223, v223
    v_exp_f32 v224, v224
    v_exp_f32 v225, v225
    v_mfma_f32_16x16x32_bf16 v[230:233], a[168:171], v[54:57], v[230:233]
    s_waitcnt lgkmcnt(12)
    ds_read_b64_tr_b16 a[204:205], v2 offset:42464
    ds_read_b64_tr_b16 a[206:207], v2 offset:42976
    v_cvt_pk_bf16_f32 v243, v220, v221
    v_cvt_pk_bf16_f32 v244, v222, v223
    v_cvt_pk_bf16_f32 v245, v224, v225
    v_exp_f32 v226, v226
    s_nop 0
    v_mfma_f32_16x16x32_bf16 v[154:157], a[232:235], v[242:245], v[154:157]
    s_waitcnt lgkmcnt(12)
    v_exp_f32 v227, v227
    v_mfma_f32_16x16x32_bf16 v[158:161], a[236:239], v[242:245], v[158:161]
    s_waitcnt lgkmcnt(10)
    v_exp_f32 v228, v228
    v_mfma_f32_16x16x32_bf16 v[162:165], a[240:243], v[242:245], v[162:165]
    s_waitcnt lgkmcnt(8)
    v_exp_f32 v229, v229
    v_mfma_f32_16x16x32_bf16 v[166:169], a[244:247], v[242:245], v[166:169]
    s_waitcnt lgkmcnt(6)
    v_exp_f32 v230, v230
    v_mfma_f32_16x16x32_bf16 v[170:173], a[248:251], v[242:245], v[170:173]
    s_waitcnt lgkmcnt(4)
    v_exp_f32 v231, v231
    v_mfma_f32_16x16x32_bf16 v[174:177], a[252:255], v[242:245], v[174:177]
    s_waitcnt lgkmcnt(2)
    v_exp_f32 v232, v232
    v_mfma_f32_16x16x32_bf16 v[178:181], a[200:203], v[242:245], v[178:181]
    s_waitcnt lgkmcnt(0)
    v_cvt_pk_bf16_f32 v246, v226, v227
    v_cvt_pk_bf16_f32 v247, v228, v229
    v_mfma_f32_16x16x32_bf16 v[182:185], a[204:207], v[242:245], v[182:185]
    v_exp_f32 v233, v233
    v_mfma_f32_16x16x32_bf16 v[218:221], a[192:195], v[58:61], v[18:21]
    v_cvt_pk_bf16_f32 v248, v230, v231
    v_cvt_pk_bf16_f32 v249, v232, v233
    v_mfma_f32_16x16x32_bf16 v[218:221], a[196:199], v[62:65], v[218:221]
    ds_read_b128 a[172:175], v1 offset:17408
    ds_read_b128 a[176:179], v1 offset:17472
    v_mfma_f32_16x16x32_bf16 v[218:221], a[148:151], v[66:69], v[218:221]
    ds_read_b128 a[180:183], v1 offset:17536
    ds_read_b128 a[184:187], v1 offset:17600
    v_mfma_f32_16x16x32_bf16 v[218:221], a[152:155], v[70:73], v[218:221]
    ds_read_b128 a[188:191], v1 offset:21760
    ds_read_b64_tr_b16 a[208:209], v2 offset:50688
    v_mfma_f32_16x16x32_bf16 v[222:225], a[156:159], v[58:61], v[18:21]
    ds_read_b64_tr_b16 a[210:211], v2 offset:51200
    ds_read_b64_tr_b16 a[212:213], v2 offset:50720
    v_mfma_f32_16x16x32_bf16 v[222:225], a[160:163], v[62:65], v[222:225]
    ds_read_b64_tr_b16 a[214:215], v2 offset:51232
    ds_read_b64_tr_b16 a[216:217], v2 offset:50752
    v_mfma_f32_16x16x32_bf16 v[222:225], a[164:167], v[66:69], v[222:225]
    v_exp_f32 v218, v218
    v_mfma_f32_16x16x32_bf16 v[222:225], a[168:171], v[70:73], v[222:225]
    v_exp_f32 v219, v219
    v_smfmac_f32_16x16x64_bf16 a[104:107], a[116:119], v[242:249], v7
    v_cvt_pk_bf16_f32 v234, v218, v219
    v_mfma_f32_16x16x32_bf16 v[186:189], a[232:235], v[246:249], v[186:189]
    v_exp_f32 v220, v220
    v_mfma_f32_16x16x32_bf16 v[190:193], a[236:239], v[246:249], v[190:193]
    v_exp_f32 v221, v221
    v_mfma_f32_16x16x32_bf16 v[194:197], a[240:243], v[246:249], v[194:197]
    v_exp_f32 v222, v222
    v_mfma_f32_16x16x32_bf16 v[198:201], a[244:247], v[246:249], v[198:201]
    v_exp_f32 v223, v223
    v_mfma_f32_16x16x32_bf16 v[202:205], a[248:251], v[246:249], v[202:205]
    v_exp_f32 v224, v224
    v_mfma_f32_16x16x32_bf16 v[206:209], a[252:255], v[246:249], v[206:209]
    v_cvt_pk_bf16_f32 v235, v220, v221
    v_cvt_pk_bf16_f32 v236, v222, v223
    v_mfma_f32_16x16x32_bf16 v[210:213], a[200:203], v[246:249], v[210:213]
    v_exp_f32 v225, v225
    v_mfma_f32_16x16x32_bf16 v[214:217], a[204:207], v[246:249], v[214:217]
    ds_read_b64_tr_b16 a[218:219], v2 offset:51264
    v_cvt_pk_bf16_f32 v237, v224, v225
    v_mfma_f32_16x16x32_bf16 v[226:229], a[192:195], v[74:77], v[22:25]
    ds_read_b128 a[192:195], v1 offset:21824
    ds_read_b64_tr_b16 a[220:221], v2 offset:50784
    v_mfma_f32_16x16x32_bf16 v[226:229], a[196:199], v[78:81], v[226:229]
    ds_read_b128 a[196:199], v1 offset:21888
    ds_read_b64_tr_b16 a[222:223], v2 offset:51296
    v_mfma_f32_16x16x32_bf16 v[226:229], a[148:151], v[82:85], v[226:229]
    ds_read_b128 a[148:151], v1 offset:21952
    ds_read_b64_tr_b16 a[224:225], v2 offset:50816
    v_mfma_f32_16x16x32_bf16 v[226:229], a[152:155], v[86:89], v[226:229]
    ds_read_b64_tr_b16 a[226:227], v2 offset:51328
    ds_read_b64_tr_b16 a[228:229], v2 offset:50848
    v_mfma_f32_16x16x32_bf16 v[230:233], a[156:159], v[74:77], v[22:25]
    ds_read_b64_tr_b16 a[230:231], v2 offset:51360
    v_accvgpr_read_b32 v250, a56
    v_mfma_f32_16x16x32_bf16 v[230:233], a[160:163], v[78:81], v[230:233]
    v_accvgpr_read_b32 v251, a57
    v_accvgpr_read_b32 v252, a58
    v_mfma_f32_16x16x32_bf16 v[230:233], a[164:167], v[82:85], v[230:233]
    v_exp_f32 v226, v226
    v_mfma_f32_16x16x32_bf16 v[230:233], a[168:171], v[86:89], v[230:233]
    v_exp_f32 v227, v227
    v_mfma_f32_16x16x32_bf16 v[90:93], a[232:235], v[234:237], v[90:93]
    v_exp_f32 v228, v228
    v_mfma_f32_16x16x32_bf16 v[94:97], a[236:239], v[234:237], v[94:97]
    v_exp_f32 v229, v229
    v_mfma_f32_16x16x32_bf16 v[98:101], a[240:243], v[234:237], v[98:101]
    v_cvt_pk_bf16_f32 v238, v226, v227
    v_cvt_pk_bf16_f32 v239, v228, v229
    v_mfma_f32_16x16x32_bf16 v[102:105], a[244:247], v[234:237], v[102:105]
    v_exp_f32 v230, v230
    v_mfma_f32_16x16x32_bf16 v[106:109], a[248:251], v[234:237], v[106:109]
    v_exp_f32 v231, v231
    v_mfma_f32_16x16x32_bf16 v[110:113], a[252:255], v[234:237], v[110:113]
    v_exp_f32 v232, v232
    v_mfma_f32_16x16x32_bf16 v[114:117], a[200:203], v[234:237], v[114:117]
    v_exp_f32 v233, v233
    v_mfma_f32_16x16x32_bf16 v[118:121], a[204:207], v[234:237], v[118:121]
    s_waitcnt lgkmcnt(0)
    v_cvt_pk_bf16_f32 v240, v230, v231
    v_cvt_pk_bf16_f32 v241, v232, v233
    v_mfma_f32_16x16x32_bf16 v[218:221], a[172:175], v[26:29], v[10:13]
    v_accvgpr_read_b32 v253, a59
    v_mul_f32 v250, v250, v9
    v_mfma_f32_16x16x32_bf16 v[218:221], a[176:179], v[30:33], v[218:221]
    v_mul_f32 v251, v251, v9
    v_mul_f32 v252, v252, v9
    v_mfma_f32_16x16x32_bf16 v[218:221], a[180:183], v[34:37], v[218:221]
    v_mul_f32 v253, v253, v9
    v_cvt_pk_bf16_f32 v250, v250, v251
    v_mfma_f32_16x16x32_bf16 v[218:221], a[184:187], v[38:41], v[218:221]
    v_cvt_pk_bf16_f32 v251, v252, v253
    v_accvgpr_read_b32 v252, a60
    v_mfma_f32_16x16x32_bf16 v[222:225], a[188:191], v[26:29], v[10:13]
    v_accvgpr_read_b32 v253, a61
    v_accvgpr_read_b32 v254, a62
    v_mfma_f32_16x16x32_bf16 v[222:225], a[192:195], v[30:33], v[222:225]
    v_accvgpr_read_b32 v255, a63
    v_mul_f32 v252, v252, v9
    v_mfma_f32_16x16x32_bf16 v[222:225], a[196:199], v[34:37], v[222:225]
    v_exp_f32 v218, v218
    v_mfma_f32_16x16x32_bf16 v[222:225], a[148:151], v[38:41], v[222:225]
    v_exp_f32 v219, v219
    v_smfmac_f32_16x16x64_bf16 a[108:111], a[116:119], v[234:241], v7
    v_cvt_pk_bf16_f32 v242, v218, v219
    v_mfma_f32_16x16x32_bf16 v[122:125], a[232:235], v[238:241], v[122:125]
    v_exp_f32 v220, v220
    v_mfma_f32_16x16x32_bf16 v[126:129], a[236:239], v[238:241], v[126:129]
    v_exp_f32 v221, v221
    v_mfma_f32_16x16x32_bf16 v[130:133], a[240:243], v[238:241], v[130:133]
    v_exp_f32 v222, v222
    v_mfma_f32_16x16x32_bf16 v[134:137], a[244:247], v[238:241], v[134:137]
    v_exp_f32 v223, v223
    v_mfma_f32_16x16x32_bf16 v[138:141], a[248:251], v[238:241], v[138:141]
    v_exp_f32 v224, v224
    v_mfma_f32_16x16x32_bf16 v[142:145], a[252:255], v[238:241], v[142:145]
    ds_read_b64_tr_b16 a[232:233], v2 offset:50880
    v_cvt_pk_bf16_f32 v243, v220, v221
    v_mfma_f32_16x16x32_bf16 v[146:149], a[200:203], v[238:241], v[146:149]
    v_exp_f32 v225, v225
    v_mfma_f32_16x16x32_bf16 v[150:153], a[204:207], v[238:241], v[150:153]
    ds_read_b64_tr_b16 a[234:235], v2 offset:51392
    v_cvt_pk_bf16_f32 v244, v222, v223
    v_mfma_f32_16x16x32_bf16 v[226:229], a[172:175], v[42:45], v[14:17]
    ds_read_b64_tr_b16 a[236:237], v2 offset:50912
    v_cvt_pk_bf16_f32 v245, v224, v225
    v_mfma_f32_16x16x32_bf16 v[226:229], a[176:179], v[46:49], v[226:229]
    ds_read_b64_tr_b16 a[238:239], v2 offset:51424
    v_mul_f32 v253, v253, v9
    v_mfma_f32_16x16x32_bf16 v[226:229], a[180:183], v[50:53], v[226:229]
    v_mul_f32 v254, v254, v9
    v_mul_f32 v255, v255, v9
    v_mfma_f32_16x16x32_bf16 v[226:229], a[184:187], v[54:57], v[226:229]
    ds_read_b128 a[152:155], v1 offset:26112
    v_cvt_pk_bf16_f32 v252, v252, v253
    v_mfma_f32_16x16x32_bf16 v[230:233], a[188:191], v[42:45], v[14:17]
    ds_read_b128 a[156:159], v1 offset:26176
    v_cvt_pk_bf16_f32 v253, v254, v255
    v_mfma_f32_16x16x32_bf16 v[230:233], a[192:195], v[46:49], v[230:233]
    v_permlane16_swap_b32 v250, v252
    v_mfma_f32_16x16x32_bf16 v[230:233], a[196:199], v[50:53], v[230:233]
    v_exp_f32 v226, v226
    v_mfma_f32_16x16x32_bf16 v[230:233], a[148:151], v[54:57], v[230:233]
    v_exp_f32 v227, v227
    v_mfma_f32_16x16x32_bf16 v[154:157], a[208:211], v[242:245], v[154:157]
    v_exp_f32 v228, v228
    v_mfma_f32_16x16x32_bf16 v[158:161], a[212:215], v[242:245], v[158:161]
    v_exp_f32 v229, v229
    v_mfma_f32_16x16x32_bf16 v[162:165], a[216:219], v[242:245], v[162:165]
    v_cvt_pk_bf16_f32 v246, v226, v227
    v_cvt_pk_bf16_f32 v247, v228, v229
    v_mfma_f32_16x16x32_bf16 v[166:169], a[220:223], v[242:245], v[166:169]
    v_exp_f32 v230, v230
    v_mfma_f32_16x16x32_bf16 v[170:173], a[224:227], v[242:245], v[170:173]
    v_exp_f32 v231, v231
    v_mfma_f32_16x16x32_bf16 v[174:177], a[228:231], v[242:245], v[174:177]
    s_waitcnt lgkmcnt(0)
    v_exp_f32 v232, v232
    v_mfma_f32_16x16x32_bf16 v[178:181], a[232:235], v[242:245], v[178:181]
    v_exp_f32 v233, v233
    v_mfma_f32_16x16x32_bf16 v[182:185], a[236:239], v[242:245], v[182:185]
    v_cvt_pk_bf16_f32 v248, v230, v231
    v_cvt_pk_bf16_f32 v249, v232, v233
    v_mfma_f32_16x16x32_bf16 v[218:221], a[172:175], v[58:61], v[18:21]
    v_permlane16_swap_b32 v251, v253
    v_mfma_f32_16x16x32_bf16 v[218:221], a[176:179], v[62:65], v[218:221]
    buffer_store_dwordx4 v[250:253], v0, s[28:31], s43 offen offset:192 sc0 sc1
    v_mfma_f32_16x16x32_bf16 v[218:221], a[180:183], v[66:69], v[218:221]
    ds_read_b128 a[160:163], v1 offset:26240
    ds_read_b128 a[164:167], v1 offset:26304
    v_mfma_f32_16x16x32_bf16 v[218:221], a[184:187], v[70:73], v[218:221]
    ds_read_b128 a[168:171], v1 offset:30464
    v_accvgpr_read_b32 v251, a121
    v_mfma_f32_16x16x32_bf16 v[222:225], a[188:191], v[58:61], v[18:21]
    v_accvgpr_read_b32 v252, a122
    v_accvgpr_read_b32 v250, a120
    v_mfma_f32_16x16x32_bf16 v[222:225], a[192:195], v[62:65], v[222:225]
    v_mfma_f32_16x16x32_bf16 v[222:225], a[196:199], v[66:69], v[222:225]
    v_mfma_f32_16x16x32_bf16 v[222:225], a[148:151], v[70:73], v[222:225]
    v_exp_f32 v218, v218
    v_smfmac_f32_16x16x64_bf16 a[104:107], a[116:119], v[242:249], v7
    v_mfma_f32_16x16x32_bf16 v[186:189], a[208:211], v[246:249], v[186:189]
    v_exp_f32 v219, v219
    v_mfma_f32_16x16x32_bf16 v[190:193], a[212:215], v[246:249], v[190:193]
    v_exp_f32 v220, v220
    v_mfma_f32_16x16x32_bf16 v[194:197], a[216:219], v[246:249], v[194:197]
    v_exp_f32 v221, v221
    v_mfma_f32_16x16x32_bf16 v[198:201], a[220:223], v[246:249], v[198:201]
    v_exp_f32 v222, v222
    v_mfma_f32_16x16x32_bf16 v[202:205], a[224:227], v[246:249], v[202:205]
    v_exp_f32 v223, v223
    v_mfma_f32_16x16x32_bf16 v[206:209], a[228:231], v[246:249], v[206:209]
    v_exp_f32 v224, v224
    v_mfma_f32_16x16x32_bf16 v[210:213], a[232:235], v[246:249], v[210:213]
    v_cvt_pk_bf16_f32 v234, v218, v219
    v_cvt_pk_bf16_f32 v235, v220, v221
    v_mfma_f32_16x16x32_bf16 v[214:217], a[236:239], v[246:249], v[214:217]
    v_exp_f32 v225, v225
    v_mfma_f32_16x16x32_bf16 v[226:229], a[172:175], v[74:77], v[22:25]
    v_cvt_pk_bf16_f32 v236, v222, v223
    v_cvt_pk_bf16_f32 v237, v224, v225
    v_mfma_f32_16x16x32_bf16 v[226:229], a[176:179], v[78:81], v[226:229]
    ds_read_b128 a[172:175], v1 offset:30528
    ds_read_b128 a[176:179], v1 offset:30592
    v_mfma_f32_16x16x32_bf16 v[226:229], a[180:183], v[82:85], v[226:229]
    ds_read_b128 a[180:183], v1 offset:30656
    v_mfma_f32_16x16x32_bf16 v[226:229], a[184:187], v[86:89], v[226:229]
    v_mfma_f32_16x16x32_bf16 v[230:233], a[188:191], v[74:77], v[22:25]
    v_mfma_f32_16x16x32_bf16 v[230:233], a[192:195], v[78:81], v[230:233]
    v_mfma_f32_16x16x32_bf16 v[230:233], a[196:199], v[82:85], v[230:233]
    v_mfma_f32_16x16x32_bf16 v[230:233], a[148:151], v[86:89], v[230:233]
    v_mfma_f32_16x16x32_bf16 v[90:93], a[208:211], v[234:237], v[90:93]
    v_mfma_f32_16x16x32_bf16 v[94:97], a[212:215], v[234:237], v[94:97]
    v_mfma_f32_16x16x32_bf16 v[98:101], a[216:219], v[234:237], v[98:101]
    v_mfma_f32_16x16x32_bf16 v[102:105], a[220:223], v[234:237], v[102:105]
    v_exp_f32 v226, v226
    v_mfma_f32_16x16x32_bf16 v[106:109], a[224:227], v[234:237], v[106:109]
    v_exp_f32 v227, v227
    v_mfma_f32_16x16x32_bf16 v[110:113], a[228:231], v[234:237], v[110:113]
    v_exp_f32 v228, v228
    v_mfma_f32_16x16x32_bf16 v[114:117], a[232:235], v[234:237], v[114:117]
    v_exp_f32 v229, v229
    v_mfma_f32_16x16x32_bf16 v[118:121], a[236:239], v[234:237], v[118:121]
    v_exp_f32 v230, v230
    s_waitcnt vmcnt(5)
    s_barrier
    s_add_u32 m0, s33, 0
    v_exp_f32 v231, v231
    v_mfma_f32_16x16x32_bf16 v[218:221], a[152:155], v[26:29], v[10:13]
    v_exp_f32 v232, v232
    v_mfma_f32_16x16x32_bf16 v[218:221], a[156:159], v[30:33], v[218:221]
    s_waitcnt lgkmcnt(0)
    buffer_load_dwordx4 v3, s[20:23], s53 offen offset:0 lds
    v_mfma_f32_16x16x32_bf16 v[218:221], a[160:163], v[34:37], v[218:221]
    s_add_u32 m0, s33, 64
    v_cvt_pk_bf16_f32 v238, v226, v227
    v_cvt_pk_bf16_f32 v239, v228, v229
    v_mfma_f32_16x16x32_bf16 v[218:221], a[164:167], v[38:41], v[218:221]
    v_exp_f32 v233, v233
    v_mfma_f32_16x16x32_bf16 v[222:225], a[168:171], v[26:29], v[10:13]
    buffer_load_dwordx4 v3, s[20:23], s53 offen offset:1024 lds
    v_mfma_f32_16x16x32_bf16 v[222:225], a[172:175], v[30:33], v[222:225]
    s_add_u32 m0, s34, 25344
    v_cvt_pk_bf16_f32 v240, v230, v231
    v_cvt_pk_bf16_f32 v241, v232, v233
    v_mfma_f32_16x16x32_bf16 v[222:225], a[176:179], v[34:37], v[222:225]
    v_exp_f32 v218, v218
    v_mfma_f32_16x16x32_bf16 v[222:225], a[180:183], v[38:41], v[222:225]
    buffer_load_dwordx4 v4, s[24:27], s53 offen offset:0 lds
    v_smfmac_f32_16x16x64_bf16 a[108:111], a[116:119], v[234:241], v7
    s_add_u32 m0, s34, 26144
    ds_read_b64_tr_b16 a[240:241], v2 offset:59136
    v_mfma_f32_16x16x32_bf16 v[122:125], a[208:211], v[238:241], v[122:125]
    v_exp_f32 v219, v219
    v_mfma_f32_16x16x32_bf16 v[126:129], a[212:215], v[238:241], v[126:129]
    buffer_load_dwordx4 v4, s[24:27], s53 offen offset:256 lds
    v_mfma_f32_16x16x32_bf16 v[130:133], a[216:219], v[238:241], v[130:133]
    s_add_u32 m0, s33, 8704
    v_exp_f32 v220, v220
    v_mfma_f32_16x16x32_bf16 v[134:137], a[220:223], v[238:241], v[134:137]
    v_exp_f32 v221, v221
    v_mfma_f32_16x16x32_bf16 v[138:141], a[224:227], v[238:241], v[138:141]
    buffer_load_dwordx4 v3, s[20:23], s54 offen offset:0 lds
    v_mfma_f32_16x16x32_bf16 v[142:145], a[228:231], v[238:241], v[142:145]
    s_add_u32 m0, s33, 8768
    v_exp_f32 v222, v222
    v_mfma_f32_16x16x32_bf16 v[146:149], a[232:235], v[238:241], v[146:149]
    ds_read_b64_tr_b16 a[242:243], v2 offset:59648
    ds_read_b64_tr_b16 a[244:245], v2 offset:59168
    v_mfma_f32_16x16x32_bf16 v[150:153], a[236:239], v[238:241], v[150:153]
    buffer_load_dwordx4 v3, s[20:23], s54 offen offset:1024 lds
    v_mfma_f32_16x16x32_bf16 v[226:229], a[152:155], v[42:45], v[14:17]
    s_add_u32 m0, s34, 33792
    v_exp_f32 v223, v223
    v_mfma_f32_16x16x32_bf16 v[226:229], a[156:159], v[46:49], v[226:229]
    ds_read_b64_tr_b16 a[246:247], v2 offset:59680
    ds_read_b64_tr_b16 a[248:249], v2 offset:59200
    v_mfma_f32_16x16x32_bf16 v[226:229], a[160:163], v[50:53], v[226:229]
    v_exp_f32 v224, v224
    v_mfma_f32_16x16x32_bf16 v[226:229], a[164:167], v[54:57], v[226:229]
    ds_read_b64_tr_b16 a[250:251], v2 offset:59712
    ds_read_b64_tr_b16 a[252:253], v2 offset:59232
    v_mfma_f32_16x16x32_bf16 v[230:233], a[168:171], v[42:45], v[14:17]
    ds_read_b64_tr_b16 a[254:255], v2 offset:59744
    buffer_load_dwordx4 v4, s[24:27], s54 offen offset:0 lds
    v_mfma_f32_16x16x32_bf16 v[230:233], a[172:175], v[46:49], v[230:233]
    s_add_u32 m0, s34, 34592
    ds_read_b64_tr_b16 a[200:201], v2 offset:59264
    ds_read_b64_tr_b16 a[202:203], v2 offset:59776
    v_mfma_f32_16x16x32_bf16 v[230:233], a[176:179], v[50:53], v[230:233]
    ds_read_b64_tr_b16 a[204:205], v2 offset:59296
    ds_read_b64_tr_b16 a[206:207], v2 offset:59808
    v_exp_f32 v225, v225
    v_mfma_f32_16x16x32_bf16 v[230:233], a[180:183], v[54:57], v[230:233]
    ds_read_b64_tr_b16 a[208:209], v2 offset:59328
    ds_read_b64_tr_b16 a[210:211], v2 offset:59840
    buffer_load_dwordx4 v4, s[24:27], s54 offen offset:256 lds
    v_cvt_pk_bf16_f32 v242, v218, v219
    v_cvt_pk_bf16_f32 v243, v220, v221
    v_cvt_pk_bf16_f32 v244, v222, v223
    v_cvt_pk_bf16_f32 v245, v224, v225
    v_exp_f32 v226, v226
    s_nop 0
    v_mfma_f32_16x16x32_bf16 a[104:107], a[128:131], v[242:245], a[104:107]
    s_waitcnt lgkmcnt(11)
    ds_read_b64_tr_b16 a[212:213], v2 offset:59360
    ds_read_b64_tr_b16 a[214:215], v2 offset:59872
    v_mfma_f32_16x16x32_bf16 v[154:157], a[240:243], v[242:245], v[154:157]
    s_waitcnt lgkmcnt(11)
    v_exp_f32 v227, v227
    s_add_u32 m0, s33, 17408
    v_mfma_f32_16x16x32_bf16 v[158:161], a[244:247], v[242:245], v[158:161]
    s_waitcnt lgkmcnt(10)
    buffer_load_dwordx4 v3, s[20:23], s55 offen offset:0 lds
    v_mfma_f32_16x16x32_bf16 v[162:165], a[248:251], v[242:245], v[162:165]
    s_waitcnt lgkmcnt(8)
    v_exp_f32 v228, v228
    v_mfma_f32_16x16x32_bf16 v[166:169], a[252:255], v[242:245], v[166:169]
    s_waitcnt lgkmcnt(6)
    v_exp_f32 v229, v229
    s_add_u32 m0, s33, 17472
    v_mfma_f32_16x16x32_bf16 v[170:173], a[200:203], v[242:245], v[170:173]
    s_waitcnt lgkmcnt(4)
    buffer_load_dwordx4 v3, s[20:23], s55 offen offset:1024 lds
    v_mfma_f32_16x16x32_bf16 v[174:177], a[204:207], v[242:245], v[174:177]
    s_waitcnt lgkmcnt(2)
    v_exp_f32 v230, v230
    v_mfma_f32_16x16x32_bf16 v[178:181], a[208:211], v[242:245], v[178:181]
    s_waitcnt lgkmcnt(0)
    v_exp_f32 v231, v231
    s_add_u32 m0, s34, 42240
    v_mfma_f32_16x16x32_bf16 v[182:185], a[212:215], v[242:245], v[182:185]
L_pad9:
    s_cbranch_vccnz L_warm
    buffer_load_dwordx4 v4, s[24:27], s55 offen offset:0 lds
    v_mfma_f32_16x16x32_bf16 v[218:221], a[152:155], v[58:61], v[18:21]
    s_add_u32 m0, s34, 43040
    v_exp_f32 v232, v232
    v_mfma_f32_16x16x32_bf16 v[218:221], a[156:159], v[62:65], v[218:221]
    v_cvt_pk_bf16_f32 v246, v226, v227
    v_exp_f32 v233, v233
    v_mfma_f32_16x16x32_bf16 v[218:221], a[160:163], v[66:69], v[218:221]
    buffer_load_dwordx4 v4, s[24:27], s55 offen offset:256 lds
    v_mfma_f32_16x16x32_bf16 v[218:221], a[164:167], v[70:73], v[218:221]
    v_cvt_pk_bf16_f32 v247, v228, v229
    v_cvt_pk_bf16_f32 v248, v230, v231
    v_mfma_f32_16x16x32_bf16 v[222:225], a[168:171], v[58:61], v[18:21]
    v_cvt_pk_bf16_f32 v249, v232, v233
    v_accvgpr_read_b32 v8, a104
    v_mfma_f32_16x16x32_bf16 v[222:225], a[172:175], v[62:65], v[222:225]
    ds_read_b128 a[184:187], v1 offset:34816
    v_accvgpr_read_b32 v255, a105
    v_mfma_f32_16x16x32_bf16 v[222:225], a[176:179], v[66:69], v[222:225]
    ds_read_b128 a[188:191], v1 offset:34880
    v_add_f32 v8, v8, v255
    v_mfma_f32_16x16x32_bf16 v[222:225], a[180:183], v[70:73], v[222:225]
    ds_read_b128 a[192:195], v1 offset:34944
    v_cmp_nle_f32_e64 s[38:39], v8, s35
    v_mfma_f32_16x16x32_bf16 a[104:107], a[112:115], v[246:249], a[104:107]
    v_rcp_f32 v8, v8
    v_mfma_f32_16x16x32_bf16 v[186:189], a[240:243], v[246:249], v[186:189]
    v_mul_f32 v154, v154, v8
    v_exp_f32 v218, v218
    v_mfma_f32_16x16x32_bf16 v[190:193], a[244:247], v[246:249], v[190:193]
    s_or_b64 s[36:37], s[36:37], s[38:39]
    v_mul_f32 v155, v155, v8
    v_exp_f32 v219, v219
    v_mfma_f32_16x16x32_bf16 v[194:197], a[248:251], v[246:249], v[194:197]
    v_mul_f32 v162, v162, v8
    v_exp_f32 v220, v220
    v_mul_f32 v163, v163, v8
    v_mfma_f32_16x16x32_bf16 v[198:201], a[252:255], v[246:249], v[198:201]
    v_mul_f32 v156, v156, v8
    v_exp_f32 v221, v221
    v_mul_f32 v157, v157, v8
    v_cvt_pk_bf16_f32 v154, v154, v155
    v_mul_f32 v164, v164, v8
    v_mul_f32 v165, v165, v8
    v_cvt_pk_bf16_f32 v162, v162, v163
    v_mul_f32 v158, v158, v8
    v_mul_f32 v159, v159, v8
    v_mul_f32 v160, v160, v8
    v_mul_f32 v161, v161, v8
    v_cvt_pk_bf16_f32 v155, v156, v157
    v_mul_f32 v166, v166, v8
    v_mul_f32 v167, v167, v8
    v_mul_f32 v168, v168, v8
    v_mul_f32 v169, v169, v8
    v_cvt_pk_bf16_f32 v163, v164, v165
    v_mfma_f32_16x16x32_bf16 v[202:205], a[200:203], v[246:249], v[202:205]
    v_cvt_pk_bf16_f32 v156, v158, v159
    v_exp_f32 v222, v222
    v_cvt_pk_bf16_f32 v157, v160, v161
    v_cvt_pk_bf16_f32 v164, v166, v167
    v_cvt_pk_bf16_f32 v165, v168, v169
    v_mfma_f32_16x16x32_bf16 v[206:209], a[204:207], v[246:249], v[206:209]
    v_permlane16_swap_b32 v154, v156
    v_permlane16_swap_b32 v155, v157
    v_permlane16_swap_b32 v162, v164
    v_permlane16_swap_b32 v163, v165
    v_mfma_f32_16x16x32_bf16 v[210:213], a[208:211], v[246:249], v[210:213]
    buffer_store_dwordx4 v[154:157], v0, s[28:31], s44 offen offset:0 sc0 sc1
    v_cvt_pk_bf16_f32 v234, v218, v219
    v_mfma_f32_16x16x32_bf16 v[214:217], a[212:215], v[246:249], v[214:217]
    buffer_store_dwordx4 v[162:165], v0, s[28:31], s44 offen offset:64 sc0 sc1
    v_cvt_pk_bf16_f32 v235, v220, v221
    v_mfma_f32_16x16x32_bf16 v[226:229], a[152:155], v[74:77], v[22:25]
    v_exp_f32 v223, v223
    v_mfma_f32_16x16x32_bf16 v[226:229], a[156:159], v[78:81], v[226:229]
    v_exp_f32 v224, v224
    v_mfma_f32_16x16x32_bf16 v[226:229], a[160:163], v[82:85], v[226:229]
    v_exp_f32 v225, v225
    v_mfma_f32_16x16x32_bf16 v[226:229], a[164:167], v[86:89], v[226:229]
    v_cvt_pk_bf16_f32 v236, v222, v223
    v_cvt_pk_bf16_f32 v237, v224, v225
    v_mfma_f32_16x16x32_bf16 v[230:233], a[168:171], v[74:77], v[22:25]
    v_mul_f32 v170, v170, v8
    v_mul_f32 v171, v171, v8
    v_mfma_f32_16x16x32_bf16 v[230:233], a[172:175], v[78:81], v[230:233]
    v_mul_f32 v178, v178, v8
    v_mul_f32 v179, v179, v8
    v_mfma_f32_16x16x32_bf16 v[230:233], a[176:179], v[82:85], v[230:233]
    v_mul_f32 v172, v172, v8
    v_mul_f32 v173, v173, v8
    v_mfma_f32_16x16x32_bf16 v[230:233], a[180:183], v[86:89], v[230:233]
    v_cvt_pk_bf16_f32 v170, v170, v171
    v_mul_f32 v180, v180, v8
    v_mfma_f32_16x16x32_bf16 v[90:93], a[240:243], v[234:237], v[90:93]
    v_mul_f32 v181, v181, v8
    v_cvt_pk_bf16_f32 v178, v178, v179
    v_mfma_f32_16x16x32_bf16 v[94:97], a[244:247], v[234:237], v[94:97]
    v_mul_f32 v174, v174, v8
    v_mul_f32 v175, v175, v8
    v_mfma_f32_16x16x32_bf16 v[98:101], a[248:251], v[234:237], v[98:101]
    v_mul_f32 v176, v176, v8
    v_mul_f32 v177, v177, v8
    v_cvt_pk_bf16_f32 v171, v172, v173
    v_mul_f32 v182, v182, v8
    v_mul_f32 v183, v183, v8
    v_mul_f32 v184, v184, v8
    v_mul_f32 v185, v185, v8
    v_cvt_pk_bf16_f32 v179, v180, v181
    v_mfma_f32_16x16x32_bf16 v[102:105], a[252:255], v[234:237], v[102:105]
    ds_read_b128 a[196:199], v1 offset:35008
    v_cvt_pk_bf16_f32 v172, v174, v175
    v_cvt_pk_bf16_f32 v173, v176, v177
    v_cvt_pk_bf16_f32 v180, v182, v183
    v_cvt_pk_bf16_f32 v181, v184, v185
    v_mfma_f32_16x16x32_bf16 v[106:109], a[200:203], v[234:237], v[106:109]
    ds_read_b128 a[148:151], v1 offset:39168
    v_permlane16_swap_b32 v170, v172
    v_permlane16_swap_b32 v171, v173
    v_permlane16_swap_b32 v178, v180
    v_permlane16_swap_b32 v179, v181
    v_mfma_f32_16x16x32_bf16 v[110:113], a[204:207], v[234:237], v[110:113]
    ds_read_b128 a[152:155], v1 offset:39232
    buffer_store_dwordx4 v[170:173], v0, s[28:31], s44 offen offset:128 sc0 sc1
    v_mfma_f32_16x16x32_bf16 v[114:117], a[208:211], v[234:237], v[114:117]
    ds_read_b128 a[156:159], v1 offset:39296
    buffer_store_dwordx4 v[178:181], v0, s[28:31], s44 offen offset:192 sc0 sc1
    v_mfma_f32_16x16x32_bf16 v[118:121], a[212:215], v[234:237], v[118:121]
    s_waitcnt lgkmcnt(4)
    ds_read_b128 a[160:163], v1 offset:39360
    v_exp_f32 v226, v226
    v_mfma_f32_16x16x32_bf16 v[218:221], a[184:187], v[42:45], v[14:17]
    v_exp_f32 v227, v227
    v_mfma_f32_16x16x32_bf16 v[218:221], a[188:191], v[46:49], v[218:221]
    v_exp_f32 v228, v228
    v_mfma_f32_16x16x32_bf16 v[218:221], a[192:195], v[50:53], v[218:221]
    s_waitcnt lgkmcnt(4)
    v_exp_f32 v229, v229
    v_mfma_f32_16x16x32_bf16 v[218:221], a[196:199], v[54:57], v[218:221]
    s_waitcnt lgkmcnt(3)
    v_exp_f32 v230, v230
    v_mfma_f32_16x16x32_bf16 v[222:225], a[148:151], v[42:45], v[14:17]
    s_waitcnt lgkmcnt(2)
    v_exp_f32 v231, v231
    v_mfma_f32_16x16x32_bf16 v[222:225], a[152:155], v[46:49], v[222:225]
    s_waitcnt lgkmcnt(1)
    v_exp_f32 v232, v232
    v_mfma_f32_16x16x32_bf16 v[222:225], a[156:159], v[50:53], v[222:225]
    s_waitcnt lgkmcnt(0)
    v_cvt_pk_bf16_f32 v238, v226, v227
    v_exp_f32 v233, v233
    v_mfma_f32_16x16x32_bf16 v[222:225], a[160:163], v[54:57], v[222:225]
    v_cvt_pk_bf16_f32 v239, v228, v229
    v_cvt_pk_bf16_f32 v240, v230, v231
    v_cvt_pk_bf16_f32 v241, v232, v233
    v_exp_f32 v218, v218
    s_nop 0
    v_smfmac_f32_16x16x64_bf16 a[108:111], a[116:119], v[234:241], v7
    ds_read_b64_tr_b16 a[216:217], v2 offset:0
    v_mfma_f32_16x16x32_bf16 v[122:125], a[240:243], v[238:241], v[122:125]
    v_exp_f32 v219, v219
    v_mfma_f32_16x16x32_bf16 v[126:129], a[244:247], v[238:241], v[126:129]
    v_exp_f32 v220, v220
    v_mfma_f32_16x16x32_bf16 v[130:133], a[248:251], v[238:241], v[130:133]
    ds_read_b64_tr_b16 a[218:219], v2 offset:512
    ds_read_b64_tr_b16 a[220:221], v2 offset:32
    v_mfma_f32_16x16x32_bf16 v[134:137], a[252:255], v[238:241], v[134:137]
    v_exp_f32 v221, v221
    v_mfma_f32_16x16x32_bf16 v[138:141], a[200:203], v[238:241], v[138:141]
    ds_read_b64_tr_b16 a[222:223], v2 offset:544
    ds_read_b64_tr_b16 a[224:225], v2 offset:64
    v_mfma_f32_16x16x32_bf16 v[142:145], a[204:207], v[238:241], v[142:145]
    v_exp_f32 v222, v222
    v_mfma_f32_16x16x32_bf16 v[146:149], a[208:211], v[238:241], v[146:149]
    ds_read_b64_tr_b16 a[226:227], v2 offset:576
    ds_read_b64_tr_b16 a[228:229], v2 offset:96
    v_mfma_f32_16x16x32_bf16 v[150:153], a[212:215], v[238:241], v[150:153]
    v_exp_f32 v223, v223
    v_mfma_f32_16x16x32_bf16 v[226:229], a[184:187], v[58:61], v[18:21]
    ds_read_b64_tr_b16 a[230:231], v2 offset:608
    ds_read_b64_tr_b16 a[232:233], v2 offset:128
    v_mfma_f32_16x16x32_bf16 v[226:229], a[188:191], v[62:65], v[226:229]
    v_exp_f32 v224, v224
    v_mfma_f32_16x16x32_bf16 v[226:229], a[192:195], v[66:69], v[226:229]
    ds_read_b64_tr_b16 a[234:235], v2 offset:640
    v_cvt_pk_bf16_f32 v242, v218, v219
    v_mfma_f32_16x16x32_bf16 v[226:229], a[196:199], v[70:73], v[226:229]
    ds_read_b64_tr_b16 a[236:237], v2 offset:160
    v_cvt_pk_bf16_f32 v243, v220, v221
    v_mfma_f32_16x16x32_bf16 v[230:233], a[148:151], v[58:61], v[18:21]
    v_exp_f32 v225, v225
    v_mfma_f32_16x16x32_bf16 v[230:233], a[152:155], v[62:65], v[230:233]
    ds_read_b64_tr_b16 a[238:239], v2 offset:672
    v_cvt_pk_bf16_f32 v244, v222, v223
    v_mfma_f32_16x16x32_bf16 v[230:233], a[156:159], v[66:69], v[230:233]
    ds_read_b64_tr_b16 a[240:241], v2 offset:192
    v_cvt_pk_bf16_f32 v245, v224, v225
    v_mfma_f32_16x16x32_bf16 v[230:233], a[160:163], v[70:73], v[230:233]
    ds_read_b64_tr_b16 a[242:243], v2 offset:704
    ds_read_b64_tr_b16 a[244:245], v2 offset:224
    v_mfma_f32_16x16x32_bf16 a[104:107], a[112:115], v[242:245], a[104:107]
    s_waitcnt lgkmcnt(6)
    ds_read_b64_tr_b16 a[246:247], v2 offset:736
    ds_read_b128 a[164:167], v1 offset:43520
    v_mfma_f32_16x16x32_bf16 v[186:189], a[216:219], v[242:245], v[186:189]
    v_exp_f32 v226, v226
    v_mfma_f32_16x16x32_bf16 v[190:193], a[220:223], v[242:245], v[190:193]
    v_exp_f32 v227, v227
    v_mfma_f32_16x16x32_bf16 v[194:197], a[224:227], v[242:245], v[194:197]
    v_exp_f32 v228, v228
    v_mfma_f32_16x16x32_bf16 v[198:201], a[228:231], v[242:245], v[198:201]
    s_waitcnt lgkmcnt(6)
    v_exp_f32 v229, v229
    v_mfma_f32_16x16x32_bf16 v[202:205], a[232:235], v[242:245], v[202:205]
    s_waitcnt lgkmcnt(5)
    v_exp_f32 v230, v230
    v_mfma_f32_16x16x32_bf16 v[206:209], a[236:239], v[242:245], v[206:209]
    s_waitcnt lgkmcnt(3)
    v_exp_f32 v231, v231
    v_mfma_f32_16x16x32_bf16 v[210:213], a[240:243], v[242:245], v[210:213]
    s_waitcnt lgkmcnt(1)
    v_exp_f32 v232, v232
    v_mfma_f32_16x16x32_bf16 v[214:217], a[244:247], v[242:245], v[214:217]
    v_cvt_pk_bf16_f32 v234, v226, v227
    v_cvt_pk_bf16_f32 v235, v228, v229
    v_mfma_f32_16x16x32_bf16 v[218:221], a[184:187], v[74:77], v[22:25]
    v_exp_f32 v233, v233
    v_mfma_f32_16x16x32_bf16 v[218:221], a[188:191], v[78:81], v[218:221]
    v_cvt_pk_bf16_f32 v236, v230, v231
    v_cvt_pk_bf16_f32 v237, v232, v233
    v_mfma_f32_16x16x32_bf16 v[218:221], a[192:195], v[82:85], v[218:221]
    ds_read_b128 a[168:171], v1 offset:43584
    ds_read_b128 a[172:175], v1 offset:43648
    v_mfma_f32_16x16x32_bf16 v[218:221], a[196:199], v[86:89], v[218:221]
    ds_read_b128 a[176:179], v1 offset:43712
    ds_read_b128 a[180:183], v1 offset:47872
    v_mfma_f32_16x16x32_bf16 v[222:225], a[148:151], v[74:77], v[22:25]
    ds_read_b128 a[184:187], v1 offset:47936
    ds_read_b128 a[188:191], v1 offset:48000
    v_mfma_f32_16x16x32_bf16 v[222:225], a[152:155], v[78:81], v[222:225]
    ds_read_b128 a[192:195], v1 offset:48064
    ds_read_b64_tr_b16 a[248:249], v2 offset:8448
    v_mfma_f32_16x16x32_bf16 v[222:225], a[156:159], v[82:85], v[222:225]
    v_exp_f32 v218, v218
    v_mfma_f32_16x16x32_bf16 v[222:225], a[160:163], v[86:89], v[222:225]
    v_exp_f32 v219, v219
    v_mfma_f32_16x16x32_bf16 v[90:93], a[216:219], v[234:237], v[90:93]
    v_exp_f32 v220, v220
    v_mfma_f32_16x16x32_bf16 v[94:97], a[220:223], v[234:237], v[94:97]
    v_exp_f32 v221, v221
    v_mfma_f32_16x16x32_bf16 v[98:101], a[224:227], v[234:237], v[98:101]
    v_cvt_pk_bf16_f32 v238, v218, v219
    v_cvt_pk_bf16_f32 v239, v220, v221
    v_mfma_f32_16x16x32_bf16 v[102:105], a[228:231], v[234:237], v[102:105]
    v_exp_f32 v222, v222
    v_mfma_f32_16x16x32_bf16 v[106:109], a[232:235], v[234:237], v[106:109]
    v_exp_f32 v223, v223
    v_mfma_f32_16x16x32_bf16 v[110:113], a[236:239], v[234:237], v[110:113]
    v_exp_f32 v224, v224
    v_mfma_f32_16x16x32_bf16 v[114:117], a[240:243], v[234:237], v[114:117]
    v_exp_f32 v225, v225
    v_mfma_f32_16x16x32_bf16 v[118:121], a[244:247], v[234:237], v[118:121]
    s_waitcnt lgkmcnt(0)
    v_cvt_pk_bf16_f32 v240, v222, v223
    v_cvt_pk_bf16_f32 v241, v224, v225
    v_mfma_f32_16x16x32_bf16 v[226:229], a[164:167], v[42:45], v[14:17]
    ds_read_b64_tr_b16 a[250:251], v2 offset:8960
    ds_read_b64_tr_b16 a[252:253], v2 offset:8480
    v_mfma_f32_16x16x32_bf16 v[226:229], a[168:171], v[46:49], v[226:229]
    ds_read_b64_tr_b16 a[254:255], v2 offset:8992
    ds_read_b64_tr_b16 a[200:201], v2 offset:8512
    v_mfma_f32_16x16x32_bf16 v[226:229], a[172:175], v[50:53], v[226:229]
    ds_read_b64_tr_b16 a[202:203], v2 offset:9024
    ds_read_b64_tr_b16 a[204:205], v2 offset:8544
    v_mfma_f32_16x16x32_bf16 v[226:229], a[176:179], v[54:57], v[226:229]
    ds_read_b64_tr_b16 a[206:207], v2 offset:9056
    ds_read_b64_tr_b16 a[208:209], v2 offset:8576
    v_mfma_f32_16x16x32_bf16 v[230:233], a[180:183], v[42:45], v[14:17]
    ds_read_b64_tr_b16 a[210:211], v2 offset:9088
    ds_read_b64_tr_b16 a[212:213], v2 offset:8608
    v_mfma_f32_16x16x32_bf16 v[230:233], a[184:187], v[46:49], v[230:233]
    ds_read_b64_tr_b16 a[214:215], v2 offset:9120
    ds_read_b128 a[196:199], v1 offset:52224
    v_mfma_f32_16x16x32_bf16 v[230:233], a[188:191], v[50:53], v[230:233]
    v_exp_f32 v226, v226
    v_mfma_f32_16x16x32_bf16 v[230:233], a[192:195], v[54:57], v[230:233]
    v_exp_f32 v227, v227
    v_smfmac_f32_16x16x64_bf16 a[108:111], a[116:119], v[234:241], v7
    v_cvt_pk_bf16_f32 v242, v226, v227
    v_mfma_f32_16x16x32_bf16 v[122:125], a[216:219], v[238:241], v[122:125]
    v_exp_f32 v228, v228
    v_mfma_f32_16x16x32_bf16 v[126:129], a[220:223], v[238:241], v[126:129]
    v_exp_f32 v229, v229
    v_mfma_f32_16x16x32_bf16 v[130:133], a[224:227], v[238:241], v[130:133]
    v_exp_f32 v230, v230
    v_mfma_f32_16x16x32_bf16 v[134:137], a[228:231], v[238:241], v[134:137]
    v_exp_f32 v231, v231
    v_mfma_f32_16x16x32_bf16 v[138:141], a[232:235], v[238:241], v[138:141]
    v_exp_f32 v232, v232
    v_mfma_f32_16x16x32_bf16 v[142:145], a[236:239], v[238:241], v[142:145]
    v_exp_f32 v233, v233
    v_mfma_f32_16x16x32_bf16 v[146:149], a[240:243], v[238:241], v[146:149]
    v_cvt_pk_bf16_f32 v243, v228, v229
    v_cvt_pk_bf16_f32 v244, v230, v231
    v_mfma_f32_16x16x32_bf16 v[150:153], a[244:247], v[238:241], v[150:153]
    ds_read_b64_tr_b16 a[216:217], v2 offset:8640
    v_cvt_pk_bf16_f32 v245, v232, v233
    v_mfma_f32_16x16x32_bf16 v[218:221], a[164:167], v[58:61], v[18:21]
    ds_read_b64_tr_b16 a[218:219], v2 offset:9152
    ds_read_b64_tr_b16 a[220:221], v2 offset:8672
    v_mfma_f32_16x16x32_bf16 v[218:221], a[168:171], v[62:65], v[218:221]
    ds_read_b64_tr_b16 a[222:223], v2 offset:9184
    ds_read_b128 a[148:151], v1 offset:52288
    v_mfma_f32_16x16x32_bf16 v[218:221], a[172:175], v[66:69], v[218:221]
    ds_read_b128 a[152:155], v1 offset:52352
    ds_read_b128 a[156:159], v1 offset:52416
    v_mfma_f32_16x16x32_bf16 v[218:221], a[176:179], v[70:73], v[218:221]
    ds_read_b128 a[160:163], v1 offset:56576
    v_mfma_f32_16x16x32_bf16 v[222:225], a[180:183], v[58:61], v[18:21]
    v_mfma_f32_16x16x32_bf16 v[222:225], a[184:187], v[62:65], v[222:225]
    v_mfma_f32_16x16x32_bf16 v[222:225], a[188:191], v[66:69], v[222:225]
    v_mfma_f32_16x16x32_bf16 v[222:225], a[192:195], v[70:73], v[222:225]
    v_mfma_f32_16x16x32_bf16 a[104:107], a[112:115], v[242:245], a[104:107]
    s_waitcnt lgkmcnt(5)
    v_mfma_f32_16x16x32_bf16 v[186:189], a[248:251], v[242:245], v[186:189]
    v_exp_f32 v218, v218
    v_mfma_f32_16x16x32_bf16 v[190:193], a[252:255], v[242:245], v[190:193]
    v_exp_f32 v219, v219
    v_mfma_f32_16x16x32_bf16 v[194:197], a[200:203], v[242:245], v[194:197]
    v_exp_f32 v220, v220
    v_mfma_f32_16x16x32_bf16 v[198:201], a[204:207], v[242:245], v[198:201]
    v_exp_f32 v221, v221
    v_mfma_f32_16x16x32_bf16 v[202:205], a[208:211], v[242:245], v[202:205]
    v_exp_f32 v222, v222
    v_mfma_f32_16x16x32_bf16 v[206:209], a[212:215], v[242:245], v[206:209]
    v_exp_f32 v223, v223
    v_mfma_f32_16x16x32_bf16 v[210:213], a[216:219], v[242:245], v[210:213]
    s_waitcnt lgkmcnt(0)
    v_accvgpr_read_b32 v9, a106
    v_exp_f32 v224, v224
    v_mfma_f32_16x16x32_bf16 v[214:217], a[220:223], v[242:245], v[214:217]
    v_accvgpr_read_b32 v255, a107
    v_exp_f32 v225, v225
    v_mfma_f32_16x16x32_bf16 v[226:229], a[164:167], v[74:77], v[22:25]
    v_add_f32 v9, v9, v255
    v_cmp_nle_f32_e64 s[48:49], v9, s35
    v_mfma_f32_16x16x32_bf16 v[226:229], a[168:171], v[78:81], v[226:229]
    v_cvt_pk_bf16_f32 v234, v218, v219
    v_rcp_f32 v9, v9
    v_mfma_f32_16x16x32_bf16 v[226:229], a[172:175], v[82:85], v[226:229]
    s_or_b64 s[36:37], s[36:37], s[48:49]
    v_cvt_pk_bf16_f32 v235, v220, v221
    v_cvt_pk_bf16_f32 v236, v222, v223
    v_mfma_f32_16x16x32_bf16 v[226:229], a[176:179], v[86:89], v[226:229]
    v_cvt_pk_bf16_f32 v237, v224, v225
    v_mul_f32 v186, v186, v9
    v_mfma_f32_16x16x32_bf16 v[230:233], a[180:183], v[74:77], v[22:25]
    v_mul_f32 v187, v187, v9
    v_mul_f32 v194, v194, v9
    v_mfma_f32_16x16x32_bf16 v[230:233], a[184:187], v[78:81], v[230:233]
    v_mul_f32 v195, v195, v9
    v_mul_f32 v188, v188, v9
    v_mfma_f32_16x16x32_bf16 v[230:233], a[188:191], v[82:85], v[230:233]
    v_mul_f32 v189, v189, v9
    v_cvt_pk_bf16_f32 v186, v186, v187
    v_mfma_f32_16x16x32_bf16 v[230:233], a[192:195], v[86:89], v[230:233]
    v_mul_f32 v196, v196, v9
    v_mul_f32 v197, v197, v9
    v_cvt_pk_bf16_f32 v194, v194, v195
    v_mfma_f32_16x16x32_bf16 v[90:93], a[248:251], v[234:237], v[90:93]
    v_mul_f32 v190, v190, v9
    v_mul_f32 v191, v191, v9
    v_mul_f32 v192, v192, v9
    v_mul_f32 v193, v193, v9
    v_cvt_pk_bf16_f32 v187, v188, v189
    v_mul_f32 v198, v198, v9
    v_mul_f32 v199, v199, v9
    v_mul_f32 v200, v200, v9
    v_mul_f32 v201, v201, v9
    v_cvt_pk_bf16_f32 v195, v196, v197
    v_cvt_pk_bf16_f32 v188, v190, v191
    v_cvt_pk_bf16_f32 v189, v192, v193
    v_cvt_pk_bf16_f32 v196, v198, v199
    v_cvt_pk_bf16_f32 v197, v200, v201
    v_mfma_f32_16x16x32_bf16 v[94:97], a[252:255], v[234:237], v[94:97]
    v_permlane16_swap_b32 v186, v188
    v_mfma_f32_16x16x32_bf16 v[98:101], a[200:203], v[234:237], v[98:101]
    v_permlane16_swap_b32 v187, v189
    v_permlane16_swap_b32 v194, v196
    v_permlane16_swap_b32 v195, v197
    v_mfma_f32_16x16x32_bf16 v[102:105], a[204:207], v[234:237], v[102:105]
    buffer_store_dwordx4 v[186:189], v0, s[28:31], s45 offen offset:0 sc0 sc1
    v_mul_f32 v202, v202, v9
    v_mfma_f32_16x16x32_bf16 v[106:109], a[208:211], v[234:237], v[106:109]
    buffer_store_dwordx4 v[194:197], v0, s[28:31], s45 offen offset:64 sc0 sc1
    v_mul_f32 v203, v203, v9
    v_mfma_f32_16x16x32_bf16 v[110:113], a[212:215], v[234:237], v[110:113]
    v_mul_f32 v210, v210, v9
    v_mul_f32 v211, v211, v9
    v_mfma_f32_16x16x32_bf16 v[114:117], a[216:219], v[234:237], v[114:117]
    ds_read_b128 a[164:167], v1 offset:56640
    v_mul_f32 v204, v204, v9
    v_mfma_f32_16x16x32_bf16 v[118:121], a[220:223], v[234:237], v[118:121]
    ds_read_b128 a[168:171], v1 offset:56704
    v_mul_f32 v205, v205, v9
    s_waitcnt vmcnt(6)
    s_barrier
    ds_read_b128 a[172:175], v1 offset:56768
    v_cvt_pk_bf16_f32 v202, v202, v203
    v_mfma_f32_16x16x32_bf16 v[218:221], a[196:199], v[58:61], v[18:21]
    v_mul_f32 v212, v212, v9
    v_exp_f32 v226, v226
    v_mfma_f32_16x16x32_bf16 v[218:221], a[148:151], v[62:65], v[218:221]
    v_mul_f32 v213, v213, v9
    v_exp_f32 v227, v227
    v_mfma_f32_16x16x32_bf16 v[218:221], a[152:155], v[66:69], v[218:221]
    v_cvt_pk_bf16_f32 v210, v210, v211
    v_exp_f32 v228, v228
    v_mfma_f32_16x16x32_bf16 v[218:221], a[156:159], v[70:73], v[218:221]
    v_mul_f32 v206, v206, v9
    v_exp_f32 v229, v229
    v_mul_f32 v207, v207, v9
    v_mul_f32 v208, v208, v9
    v_mul_f32 v209, v209, v9
    v_cvt_pk_bf16_f32 v203, v204, v205
    v_mul_f32 v214, v214, v9
    v_mul_f32 v215, v215, v9
    v_mul_f32 v216, v216, v9
    v_mul_f32 v217, v217, v9
    v_cvt_pk_bf16_f32 v211, v212, v213
    v_cvt_pk_bf16_f32 v204, v206, v207
    v_cvt_pk_bf16_f32 v205, v208, v209
    v_cvt_pk_bf16_f32 v212, v214, v215
    v_cvt_pk_bf16_f32 v213, v216, v217
    v_mfma_f32_16x16x32_bf16 v[222:225], a[160:163], v[58:61], v[18:21]
    s_waitcnt lgkmcnt(2)
    v_exp_f32 v230, v230
    v_mfma_f32_16x16x32_bf16 v[222:225], a[164:167], v[62:65], v[222:225]
    s_waitcnt lgkmcnt(1)
    v_permlane16_swap_b32 v202, v204
    v_permlane16_swap_b32 v203, v205
    v_permlane16_swap_b32 v210, v212
    v_permlane16_swap_b32 v211, v213
    v_mfma_f32_16x16x32_bf16 v[222:225], a[168:171], v[66:69], v[222:225]
    s_waitcnt lgkmcnt(0)
    buffer_store_dwordx4 v[202:205], v0, s[28:31], s45 offen offset:128 sc0 sc1
    v_cvt_pk_bf16_f32 v238, v226, v227
    v_exp_f32 v231, v231
    v_exp_f32 v232, v232
    v_exp_f32 v233, v233
    v_mfma_f32_16x16x32_bf16 v[222:225], a[172:175], v[70:73], v[222:225]
    buffer_store_dwordx4 v[210:213], v0, s[28:31], s45 offen offset:192 sc0 sc1
    v_cvt_pk_bf16_f32 v239, v228, v229
    v_cvt_pk_bf16_f32 v240, v230, v231
    v_cvt_pk_bf16_f32 v241, v232, v233
    v_exp_f32 v218, v218
    s_nop 0
    v_smfmac_f32_16x16x64_bf16 a[108:111], a[116:119], v[234:241], v7
    ds_read_b64_tr_b16 a[224:225], v2 offset:16896
    v_mfma_f32_16x16x32_bf16 v[122:125], a[248:251], v[238:241], v[122:125]
    v_exp_f32 v219, v219
    v_mfma_f32_16x16x32_bf16 v[126:129], a[252:255], v[238:241], v[126:129]
    ds_read_b64_tr_b16 a[226:227], v2 offset:17408
    ds_read_b64_tr_b16 a[228:229], v2 offset:16928
    v_mfma_f32_16x16x32_bf16 v[130:133], a[200:203], v[238:241], v[130:133]
    v_exp_f32 v220, v220
    v_mfma_f32_16x16x32_bf16 v[134:137], a[204:207], v[238:241], v[134:137]
    ds_read_b64_tr_b16 a[230:231], v2 offset:17440
    ds_read_b64_tr_b16 a[232:233], v2 offset:16960
    v_mfma_f32_16x16x32_bf16 v[138:141], a[208:211], v[238:241], v[138:141]
    v_exp_f32 v221, v221
    v_mfma_f32_16x16x32_bf16 v[142:145], a[212:215], v[238:241], v[142:145]
    ds_read_b64_tr_b16 a[234:235], v2 offset:17472
    ds_read_b64_tr_b16 a[236:237], v2 offset:16992
    v_mfma_f32_16x16x32_bf16 v[146:149], a[216:219], v[238:241], v[146:149]
    v_exp_f32 v222, v222
    v_mfma_f32_16x16x32_bf16 v[150:153], a[220:223], v[238:241], v[150:153]
    ds_read_b64_tr_b16 a[238:239], v2 offset:17504
    ds_read_b64_tr_b16 a[240:241], v2 offset:17024
    v_mfma_f32_16x16x32_bf16 v[226:229], a[196:199], v[74:77], v[22:25]
    v_exp_f32 v223, v223
    v_mfma_f32_16x16x32_bf16 v[226:229], a[148:151], v[78:81], v[226:229]
    ds_read_b64_tr_b16 a[242:243], v2 offset:17536
    ds_read_b64_tr_b16 a[244:245], v2 offset:17056
    v_mfma_f32_16x16x32_bf16 v[226:229], a[152:155], v[82:85], v[226:229]
    v_exp_f32 v224, v224
    v_mfma_f32_16x16x32_bf16 v[226:229], a[156:159], v[86:89], v[226:229]
    ds_read_b64_tr_b16 a[246:247], v2 offset:17568
    v_cvt_pk_bf16_f32 v242, v218, v219
    v_mfma_f32_16x16x32_bf16 v[230:233], a[160:163], v[74:77], v[22:25]
    ds_read_b64_tr_b16 a[248:249], v2 offset:17088
    v_cvt_pk_bf16_f32 v243, v220, v221
    v_mfma_f32_16x16x32_bf16 v[230:233], a[164:167], v[78:81], v[230:233]
    v_exp_f32 v225, v225
    v_mfma_f32_16x16x32_bf16 v[230:233], a[168:171], v[82:85], v[230:233]
    ds_read_b64_tr_b16 a[250:251], v2 offset:17600
    v_cvt_pk_bf16_f32 v244, v222, v223
    v_mfma_f32_16x16x32_bf16 v[230:233], a[172:175], v[86:89], v[230:233]
    s_waitcnt lgkmcnt(5)
    ds_read_b64_tr_b16 a[252:253], v2 offset:17120
    ds_read_b64_tr_b16 a[254:255], v2 offset:17632
    v_cvt_pk_bf16_f32 v245, v224, v225
    v_exp_f32 v226, v226
    s_nop 0
    v_mfma_f32_16x16x32_bf16 v[90:93], a[224:227], v[242:245], v[90:93]
    ds_read_b128 a[176:179], v1 offset:0
    ds_read_b128 a[180:183], v1 offset:64
    v_mfma_f32_16x16x32_bf16 v[94:97], a[228:231], v[242:245], v[94:97]
    v_exp_f32 v227, v227
    v_mfma_f32_16x16x32_bf16 v[98:101], a[232:235], v[242:245], v[98:101]
    ds_read_b128 a[184:187], v1 offset:128
    v_exp_f32 v228, v228
    v_mfma_f32_16x16x32_bf16 v[102:105], a[236:239], v[242:245], v[102:105]
    s_waitcnt lgkmcnt(7)
    ds_read_b128 a[188:191], v1 offset:192
    v_exp_f32 v229, v229
    v_mfma_f32_16x16x32_bf16 v[106:109], a[240:243], v[242:245], v[106:109]
    ds_read_b128 a[192:195], v1 offset:4352
    v_exp_f32 v230, v230
    v_mfma_f32_16x16x32_bf16 v[110:113], a[244:247], v[242:245], v[110:113]
    s_waitcnt lgkmcnt(7)
    ds_read_b128 a[196:199], v1 offset:4416
    v_exp_f32 v231, v231
    v_mfma_f32_16x16x32_bf16 v[114:117], a[248:251], v[242:245], v[114:117]
    s_waitcnt lgkmcnt(6)
    ds_read_b128 a[148:151], v1 offset:4480
    v_exp_f32 v232, v232
    v_mfma_f32_16x16x32_bf16 v[118:121], a[252:255], v[242:245], v[118:121]
    s_waitcnt lgkmcnt(6)
    ds_read_b128 a[152:155], v1 offset:4544
    v_exp_f32 v233, v233
    v_mfma_f32_16x16x32_bf16 v[218:221], a[176:179], v[58:61], v[18:21]
    s_waitcnt lgkmcnt(6)
    v_cvt_pk_bf16_f32 v246, v226, v227
    v_cvt_pk_bf16_f32 v247, v228, v229
    v_mfma_f32_16x16x32_bf16 v[218:221], a[180:183], v[62:65], v[218:221]
    s_waitcnt lgkmcnt(5)
    v_cvt_pk_bf16_f32 v248, v230, v231
    v_cvt_pk_bf16_f32 v249, v232, v233
    v_mfma_f32_16x16x32_bf16 v[218:221], a[184:187], v[66:69], v[218:221]
    s_waitcnt lgkmcnt(4)
    ds_read_b64_tr_b16 a[200:201], v2 offset:25344
    ds_read_b64_tr_b16 a[202:203], v2 offset:25856
    v_mfma_f32_16x16x32_bf16 v[218:221], a[188:191], v[70:73], v[218:221]
    s_waitcnt lgkmcnt(5)
    ds_read_b64_tr_b16 a[204:205], v2 offset:25376
    ds_read_b64_tr_b16 a[206:207], v2 offset:25888
    v_mfma_f32_16x16x32_bf16 v[222:225], a[192:195], v[58:61], v[18:21]
    s_waitcnt lgkmcnt(6)
    ds_read_b64_tr_b16 a[208:209], v2 offset:25408
    ds_read_b64_tr_b16 a[210:211], v2 offset:25920
    v_mfma_f32_16x16x32_bf16 v[222:225], a[196:199], v[62:65], v[222:225]
    s_waitcnt lgkmcnt(7)
    v_exp_f32 v218, v218
    v_mfma_f32_16x16x32_bf16 v[222:225], a[148:151], v[66:69], v[222:225]
    s_waitcnt lgkmcnt(6)
    v_exp_f32 v219, v219
    v_mfma_f32_16x16x32_bf16 v[222:225], a[152:155], v[70:73], v[222:225]
    v_exp_f32 v220, v220
    v_smfmac_f32_16x16x64_bf16 a[108:111], a[116:119], v[242:249], v7
    v_exp_f32 v221, v221
    v_mfma_f32_16x16x32_bf16 v[122:125], a[224:227], v[246:249], v[122:125]
    v_cvt_pk_bf16_f32 v234, v218, v219
    v_cvt_pk_bf16_f32 v235, v220, v221
    v_mfma_f32_16x16x32_bf16 v[126:129], a[228:231], v[246:249], v[126:129]
    ds_read_b64_tr_b16 a[212:213], v2 offset:25440
    v_exp_f32 v222, v222
    v_mfma_f32_16x16x32_bf16 v[130:133], a[232:235], v[246:249], v[130:133]
    v_exp_f32 v223, v223
    v_mfma_f32_16x16x32_bf16 v[134:137], a[236:239], v[246:249], v[134:137]
    v_exp_f32 v224, v224
    v_mfma_f32_16x16x32_bf16 v[138:141], a[240:243], v[246:249], v[138:141]
    v_exp_f32 v225, v225
    v_mfma_f32_16x16x32_bf16 v[142:145], a[244:247], v[246:249], v[142:145]
    v_cvt_pk_bf16_f32 v236, v222, v223
    v_cvt_pk_bf16_f32 v237, v224, v225
    v_mfma_f32_16x16x32_bf16 v[146:149], a[248:251], v[246:249], v[146:149]
    ds_read_b64_tr_b16 a[214:215], v2 offset:25952
    ds_read_b64_tr_b16 a[216:217], v2 offset:25472
    v_mfma_f32_16x16x32_bf16 v[150:153], a[252:255], v[246:249], v[150:153]
    ds_read_b64_tr_b16 a[218:219], v2 offset:25984
    ds_read_b64_tr_b16 a[220:221], v2 offset:25504
    v_mfma_f32_16x16x32_bf16 v[226:229], a[176:179], v[74:77], v[22:25]
    ds_read_b64_tr_b16 a[222:223], v2 offset:26016
    ds_read_b64_tr_b16 a[224:225], v2 offset:25536
    v_mfma_f32_16x16x32_bf16 v[226:229], a[180:183], v[78:81], v[226:229]
    ds_read_b64_tr_b16 a[226:227], v2 offset:26048
    ds_read_b64_tr_b16 a[228:229], v2 offset:25568
    v_mfma_f32_16x16x32_bf16 v[226:229], a[184:187], v[82:85], v[226:229]
    ds_read_b64_tr_b16 a[230:231], v2 offset:26080
    ds_read_b128 a[156:159], v1 offset:8704
    v_mfma_f32_16x16x32_bf16 v[226:229], a[188:191], v[86:89], v[226:229]
    ds_read_b128 a[160:163], v1 offset:8768
    ds_read_b128 a[164:167], v1 offset:8832
    v_mfma_f32_16x16x32_bf16 v[230:233], a[192:195], v[74:77], v[22:25]
    ds_read_b128 a[168:171], v1 offset:8896
    ds_read_b128 a[172:175], v1 offset:13056
    v_mfma_f32_16x16x32_bf16 v[230:233], a[196:199], v[78:81], v[230:233]
    ds_read_b128 a[176:179], v1 offset:13120
    ds_read_b128 a[180:183], v1 offset:13184
    v_mfma_f32_16x16x32_bf16 v[230:233], a[148:151], v[82:85], v[230:233]
    v_exp_f32 v226, v226
    v_mfma_f32_16x16x32_bf16 v[230:233], a[152:155], v[86:89], v[230:233]
    ds_read_b128 a[184:187], v1 offset:13248
    ds_read_b128 a[188:191], v1 offset:17408
    v_mfma_f32_16x16x32_bf16 a[108:111], a[128:131], v[234:237], a[108:111]
    s_waitcnt lgkmcnt(12)
    v_exp_f32 v227, v227
    v_mfma_f32_16x16x32_bf16 v[90:93], a[200:203], v[234:237], v[90:93]
    v_exp_f32 v228, v228
    v_mfma_f32_16x16x32_bf16 v[94:97], a[204:207], v[234:237], v[94:97]
    v_exp_f32 v229, v229
    v_mfma_f32_16x16x32_bf16 v[98:101], a[208:211], v[234:237], v[98:101]
    v_exp_f32 v230, v230
    v_mfma_f32_16x16x32_bf16 v[102:105], a[212:215], v[234:237], v[102:105]
    v_accvgpr_read_b32 v8, a108
    v_accvgpr_read_b32 v255, a109
    v_mfma_f32_16x16x32_bf16 v[106:109], a[216:219], v[234:237], v[106:109]
L_pad10:
    s_cbranch_vccnz L_warm
    v_add_f32 v8, v8, v255
    v_cmp_nle_f32_e64 s[38:39], v8, s35
    v_mfma_f32_16x16x32_bf16 v[110:113], a[220:223], v[234:237], v[110:113]
    s_waitcnt lgkmcnt(2)
    v_rcp_f32 v8, v8
    v_mfma_f32_16x16x32_bf16 v[114:117], a[224:227], v[234:237], v[114:117]
    s_or_b64 s[36:37], s[36:37], s[38:39]
    v_mul_f32 v90, v90, v8
    v_mul_f32 v91, v91, v8
    v_mfma_f32_16x16x32_bf16 v[118:121], a[228:231], v[234:237], v[118:121]
    v_mul_f32 v92, v92, v8
    v_mul_f32 v93, v93, v8
    v_cvt_pk_bf16_f32 v90, v90, v91
    v_mul_f32 v94, v94, v8
    v_mul_f32 v95, v95, v8
    v_mul_f32 v96, v96, v8
    v_mul_f32 v97, v97, v8
    v_cvt_pk_bf16_f32 v91, v92, v93
    v_mul_f32 v98, v98, v8
    v_mul_f32 v99, v99, v8
    v_mfma_f32_16x16x32_bf16 v[218:221], a[156:159], v[74:77], v[22:25]
    ds_write_b64 v251, v[90:91] offset:0
    v_cvt_pk_bf16_f32 v92, v94, v95
    v_cvt_pk_bf16_f32 v93, v96, v97
    v_mul_f32 v100, v100, v8
    v_mul_f32 v101, v101, v8
    v_cvt_pk_bf16_f32 v98, v98, v99
    v_mul_f32 v102, v102, v8
    v_mul_f32 v103, v103, v8
    v_mul_f32 v104, v104, v8
    v_mul_f32 v105, v105, v8
    v_cvt_pk_bf16_f32 v99, v100, v101
    v_mul_f32 v106, v106, v8
    v_mul_f32 v107, v107, v8
    v_mfma_f32_16x16x32_bf16 v[218:221], a[160:163], v[78:81], v[218:221]
    ds_write_b64 v252, v[92:93] offset:0
    v_cvt_pk_bf16_f32 v100, v102, v103
    v_cvt_pk_bf16_f32 v101, v104, v105
    v_mul_f32 v108, v108, v8
    v_mul_f32 v109, v109, v8
    v_cvt_pk_bf16_f32 v106, v106, v107
    v_mul_f32 v110, v110, v8
    v_mul_f32 v111, v111, v8
    v_mul_f32 v112, v112, v8
    v_mul_f32 v113, v113, v8
    v_cvt_pk_bf16_f32 v107, v108, v109
    v_mul_f32 v114, v114, v8
    v_mul_f32 v115, v115, v8
    v_mfma_f32_16x16x32_bf16 v[218:221], a[164:167], v[82:85], v[218:221]
    ds_write_b64 v251, v[98:99] offset:64
    v_cvt_pk_bf16_f32 v108, v110, v111
    v_cvt_pk_bf16_f32 v109, v112, v113
    v_mul_f32 v116, v116, v8
    v_mul_f32 v117, v117, v8
    v_cvt_pk_bf16_f32 v114, v114, v115
    v_mul_f32 v118, v118, v8
    v_mul_f32 v119, v119, v8
    v_mul_f32 v120, v120, v8
    v_mul_f32 v121, v121, v8
    v_cvt_pk_bf16_f32 v115, v116, v117
    v_mfma_f32_16x16x32_bf16 v[218:221], a[168:171], v[86:89], v[218:221]
    ds_write_b64 v252, v[100:101] offset:64
    v_cvt_pk_bf16_f32 v116, v118, v119
    v_cvt_pk_bf16_f32 v117, v120, v121
    v_mfma_f32_16x16x32_bf16 v[222:225], a[172:175], v[74:77], v[22:25]
    ds_write_b64 v251, v[106:107] offset:128
    v_mfma_f32_16x16x32_bf16 v[222:225], a[176:179], v[78:81], v[222:225]
    ds_write_b64 v252, v[108:109] offset:128
    v_mfma_f32_16x16x32_bf16 v[222:225], a[180:183], v[82:85], v[222:225]
    s_waitcnt lgkmcnt(6)
    ds_write_b64 v251, v[114:115] offset:192
    v_exp_f32 v231, v231
    v_exp_f32 v232, v232
    v_exp_f32 v233, v233
    v_mfma_f32_16x16x32_bf16 v[222:225], a[184:187], v[86:89], v[222:225]
    ds_write_b64 v252, v[116:117] offset:192
    v_cvt_pk_bf16_f32 v238, v226, v227
    v_cvt_pk_bf16_f32 v239, v228, v229
    v_cvt_pk_bf16_f32 v240, v230, v231
    v_cvt_pk_bf16_f32 v241, v232, v233
    v_exp_f32 v218, v218
    s_nop 0
    v_mfma_f32_16x16x32_bf16 a[108:111], a[112:115], v[238:241], a[108:111]
    ds_read_b128 v[94:97], v250 offset:0
    ds_read_b128 v[102:105], v250 offset:1088
    v_mfma_f32_16x16x32_bf16 v[122:125], a[200:203], v[238:241], v[122:125]
    ds_read_b128 v[110:113], v250 offset:2176
    ds_read_b128 a[192:195], v1 offset:17472
    v_mfma_f32_16x16x32_bf16 v[126:129], a[204:207], v[238:241], v[126:129]
    ds_read_b128 a[196:199], v1 offset:17536
    ds_read_b128 a[148:151], v1 offset:17600
    v_mfma_f32_16x16x32_bf16 v[130:133], a[208:211], v[238:241], v[130:133]
    ds_read_b128 v[118:121], v250 offset:3264
    ds_read_b128 a[152:155], v1 offset:21760
    v_mfma_f32_16x16x32_bf16 v[134:137], a[212:215], v[238:241], v[134:137]
    ds_read_b128 a[156:159], v1 offset:21824
    ds_read_b128 a[160:163], v1 offset:21888
    v_mfma_f32_16x16x32_bf16 v[138:141], a[216:219], v[238:241], v[138:141]
    ds_read_b128 a[164:167], v1 offset:21952
    ds_read_b64_tr_b16 a[232:233], v2 offset:33792
    v_mfma_f32_16x16x32_bf16 v[142:145], a[220:223], v[238:241], v[142:145]
    v_exp_f32 v219, v219
    v_mfma_f32_16x16x32_bf16 v[146:149], a[224:227], v[238:241], v[146:149]
    v_exp_f32 v220, v220
    v_mfma_f32_16x16x32_bf16 v[150:153], a[228:231], v[238:241], v[150:153]
    s_waitcnt lgkmcnt(10)
    buffer_store_dwordx4 v[94:97], v5, s[28:31], s46 offen offset:0 sc0 sc1
    v_cvt_pk_bf16_f32 v242, v218, v219
    v_mfma_f32_16x16x32_bf16 v[226:229], a[188:191], v[74:77], v[22:25]
    s_waitcnt lgkmcnt(8)
    buffer_store_dwordx4 v[102:105], v5, s[28:31], s46 offen offset:1024 sc0 sc1
    v_mfma_f32_16x16x32_bf16 v[226:229], a[192:195], v[78:81], v[226:229]
    s_waitcnt lgkmcnt(6)
    ds_read_b64_tr_b16 a[234:235], v2 offset:34304
    buffer_store_dwordx4 v[110:113], v5, s[28:31], s46 offen offset:2048 sc0 sc1
    v_mfma_f32_16x16x32_bf16 v[226:229], a[196:199], v[82:85], v[226:229]
    ds_read_b64_tr_b16 a[236:237], v2 offset:33824
    ds_read_b64_tr_b16 a[238:239], v2 offset:34336
    v_mfma_f32_16x16x32_bf16 v[226:229], a[148:151], v[86:89], v[226:229]
    s_waitcnt lgkmcnt(5)
    ds_read_b64_tr_b16 a[240:241], v2 offset:33856
    ds_read_b64_tr_b16 a[242:243], v2 offset:34368
    v_mfma_f32_16x16x32_bf16 v[230:233], a[152:155], v[74:77], v[22:25]
    ds_read_b64_tr_b16 a[244:245], v2 offset:33888
    ds_read_b64_tr_b16 a[246:247], v2 offset:34400
    buffer_store_dwordx4 v[118:121], v5, s[28:31], s46 offen offset:3072 sc0 sc1
    v_mfma_f32_16x16x32_bf16 v[230:233], a[156:159], v[78:81], v[230:233]
    ds_read_b64_tr_b16 a[248:249], v2 offset:33920
    ds_read_b64_tr_b16 a[250:251], v2 offset:34432
    v_mfma_f32_16x16x32_bf16 v[230:233], a[160:163], v[82:85], v[230:233]
    s_waitcnt lgkmcnt(9)
    ds_read_b64_tr_b16 a[252:253], v2 offset:33952
    ds_read_b64_tr_b16 a[254:255], v2 offset:34464
    v_exp_f32 v221, v221
    v_exp_f32 v222, v222
    v_exp_f32 v223, v223
    v_exp_f32 v224, v224
    v_exp_f32 v225, v225
    v_mfma_f32_16x16x32_bf16 v[230:233], a[164:167], v[86:89], v[230:233]
    ds_read_b64_tr_b16 a[200:201], v2 offset:33984
    ds_read_b64_tr_b16 a[202:203], v2 offset:34496
    v_cvt_pk_bf16_f32 v243, v220, v221
    v_cvt_pk_bf16_f32 v244, v222, v223
    v_cvt_pk_bf16_f32 v245, v224, v225
    v_exp_f32 v226, v226
    s_nop 0
    v_mfma_f32_16x16x32_bf16 a[108:111], a[112:115], v[242:245], a[108:111]
    s_waitcnt lgkmcnt(12)
    ds_read_b64_tr_b16 a[204:205], v2 offset:34016
    ds_read_b64_tr_b16 a[206:207], v2 offset:34528
    v_mfma_f32_16x16x32_bf16 v[122:125], a[232:235], v[242:245], v[122:125]
    s_waitcnt lgkmcnt(12)
    v_exp_f32 v227, v227
    v_mfma_f32_16x16x32_bf16 v[126:129], a[236:239], v[242:245], v[126:129]
    s_waitcnt lgkmcnt(10)
    ds_read_b64_tr_b16 a[208:209], v2 offset:42240
    ds_read_b64_tr_b16 a[210:211], v2 offset:42752
    v_mfma_f32_16x16x32_bf16 v[130:133], a[240:243], v[242:245], v[130:133]
    s_waitcnt lgkmcnt(10)
    ds_read_b64_tr_b16 a[212:213], v2 offset:42272
    ds_read_b64_tr_b16 a[214:215], v2 offset:42784
    v_mfma_f32_16x16x32_bf16 v[134:137], a[244:247], v[242:245], v[134:137]
    s_waitcnt lgkmcnt(10)
    ds_read_b64_tr_b16 a[216:217], v2 offset:42304
    ds_read_b64_tr_b16 a[218:219], v2 offset:42816
    v_mfma_f32_16x16x32_bf16 v[138:141], a[248:251], v[242:245], v[138:141]
    s_waitcnt lgkmcnt(10)
    ds_read_b64_tr_b16 a[220:221], v2 offset:42336
    ds_read_b64_tr_b16 a[222:223], v2 offset:42848
    v_mfma_f32_16x16x32_bf16 v[142:145], a[252:255], v[242:245], v[142:145]
    s_waitcnt lgkmcnt(10)
    ds_read_b64_tr_b16 a[224:225], v2 offset:42368
    ds_read_b64_tr_b16 a[226:227], v2 offset:42880
    v_mfma_f32_16x16x32_bf16 v[146:149], a[200:203], v[242:245], v[146:149]
    s_waitcnt lgkmcnt(10)
    ds_read_b64_tr_b16 a[228:229], v2 offset:42400
    ds_read_b64_tr_b16 a[230:231], v2 offset:42912
    v_exp_f32 v228, v228
    v_exp_f32 v229, v229
    v_exp_f32 v230, v230
    v_exp_f32 v231, v231
    v_exp_f32 v232, v232
    v_exp_f32 v233, v233
    v_mfma_f32_16x16x32_bf16 v[150:153], a[204:207], v[242:245], v[150:153]
    ds_read_b64_tr_b16 a[232:233], v2 offset:42432
    ds_read_b64_tr_b16 a[234:235], v2 offset:42944
    v_cvt_pk_bf16_f32 v246, v226, v227
    v_cvt_pk_bf16_f32 v247, v228, v229
    v_cvt_pk_bf16_f32 v248, v230, v231
    v_cvt_pk_bf16_f32 v249, v232, v233
    s_nop 1
    v_mfma_f32_16x16x32_bf16 a[108:111], a[112:115], v[246:249], a[108:111]
    s_waitcnt lgkmcnt(12)
    ds_read_b64_tr_b16 a[236:237], v2 offset:42464
    ds_read_b64_tr_b16 a[238:239], v2 offset:42976
    v_mfma_f32_16x16x32_bf16 v[122:125], a[208:211], v[246:249], v[122:125]
    s_waitcnt lgkmcnt(12)
    v_mfma_f32_16x16x32_bf16 v[126:129], a[212:215], v[246:249], v[126:129]
    s_waitcnt lgkmcnt(10)
    v_mfma_f32_16x16x32_bf16 v[130:133], a[216:219], v[246:249], v[130:133]
    s_waitcnt lgkmcnt(8)
    v_accvgpr_read_b32 v9, a110
    v_accvgpr_read_b32 v255, a111
    v_mfma_f32_16x16x32_bf16 v[134:137], a[220:223], v[246:249], v[134:137]
    s_waitcnt lgkmcnt(6)
    v_add_f32 v9, v9, v255
    v_cmp_nle_f32_e64 s[48:49], v9, s35
    v_mfma_f32_16x16x32_bf16 v[138:141], a[224:227], v[246:249], v[138:141]
    s_waitcnt lgkmcnt(4)
    v_rcp_f32 v9, v9
    v_mfma_f32_16x16x32_bf16 v[142:145], a[228:231], v[246:249], v[142:145]
    s_waitcnt lgkmcnt(2)
    v_mul_f32 v122, v122, v9
    v_mul_f32 v123, v123, v9
    v_mfma_f32_16x16x32_bf16 v[146:149], a[232:235], v[246:249], v[146:149]
    s_waitcnt lgkmcnt(0)
    v_mul_f32 v124, v124, v9
    v_mul_f32 v125, v125, v9
    v_mfma_f32_16x16x32_bf16 v[150:153], a[236:239], v[246:249], v[150:153]
    s_or_b64 s[36:37], s[36:37], s[48:49]
    v_cvt_pk_bf16_f32 v122, v122, v123
    v_mul_f32 v126, v126, v9
    v_mul_f32 v127, v127, v9
    v_mul_f32 v128, v128, v9
    v_mul_f32 v129, v129, v9
    v_cvt_pk_bf16_f32 v123, v124, v125
    v_cvt_pk_bf16_f32 v124, v126, v127
    v_cvt_pk_bf16_f32 v125, v128, v129
    ds_write_b64 v251, v[122:123] offset:4352
    ds_write_b64 v252, v[124:125] offset:4352
    v_pk_mul_f32 v[130:131], v[130:131], v[8:9] op_sel:[0,1] op_sel_hi:[1,1]
    v_pk_mul_f32 v[132:133], v[132:133], v[8:9] op_sel:[0,1] op_sel_hi:[1,1]
    v_cvt_pk_bf16_f32 v130, v130, v131
    v_pk_mul_f32 v[134:135], v[134:135], v[8:9] op_sel:[0,1] op_sel_hi:[1,1]
    v_pk_mul_f32 v[136:137], v[136:137], v[8:9] op_sel:[0,1] op_sel_hi:[1,1]
    v_cvt_pk_bf16_f32 v131, v132, v133
    v_cvt_pk_bf16_f32 v132, v134, v135
    v_cvt_pk_bf16_f32 v133, v136, v137
    ds_write_b64 v251, v[130:131] offset:4416
    ds_write_b64 v252, v[132:133] offset:4416
    v_pk_mul_f32 v[138:139], v[138:139], v[8:9] op_sel:[0,1] op_sel_hi:[1,1]
    v_pk_mul_f32 v[140:141], v[140:141], v[8:9] op_sel:[0,1] op_sel_hi:[1,1]
    v_cvt_pk_bf16_f32 v138, v138, v139
    v_pk_mul_f32 v[142:143], v[142:143], v[8:9] op_sel:[0,1] op_sel_hi:[1,1]
    v_pk_mul_f32 v[144:145], v[144:145], v[8:9] op_sel:[0,1] op_sel_hi:[1,1]
    v_cvt_pk_bf16_f32 v139, v140, v141
    v_cvt_pk_bf16_f32 v140, v142, v143
    v_cvt_pk_bf16_f32 v141, v144, v145
    ds_write_b64 v251, v[138:139] offset:4480
    ds_write_b64 v252, v[140:141] offset:4480
    v_pk_mul_f32 v[146:147], v[146:147], v[8:9] op_sel:[0,1] op_sel_hi:[1,1]
    v_pk_mul_f32 v[148:149], v[148:149], v[8:9] op_sel:[0,1] op_sel_hi:[1,1]
    v_cvt_pk_bf16_f32 v146, v146, v147
    v_pk_mul_f32 v[150:151], v[150:151], v[8:9] op_sel:[0,1] op_sel_hi:[1,1]
    v_pk_mul_f32 v[152:153], v[152:153], v[8:9] op_sel:[0,1] op_sel_hi:[1,1]
    v_cvt_pk_bf16_f32 v147, v148, v149
    v_cvt_pk_bf16_f32 v148, v150, v151
    v_cvt_pk_bf16_f32 v149, v152, v153
    ds_write_b64 v251, v[146:147] offset:4544
    ds_write_b64 v252, v[148:149] offset:4544
    ds_read_b128 v[126:129], v250 offset:4352
    ds_read_b128 v[134:137], v250 offset:5440
    ds_read_b128 v[142:145], v250 offset:6528
    ds_read_b128 v[150:153], v250 offset:7616
    s_waitcnt lgkmcnt(3)
    buffer_store_dwordx4 v[126:129], v5, s[28:31], s47 offen offset:0 sc0 sc1
    s_waitcnt lgkmcnt(2)
    buffer_store_dwordx4 v[134:137], v5, s[28:31], s47 offen offset:1024 sc0 sc1
    s_waitcnt lgkmcnt(1)
    buffer_store_dwordx4 v[142:145], v5, s[28:31], s47 offen offset:2048 sc0 sc1
    s_waitcnt lgkmcnt(0)
    buffer_store_dwordx4 v[150:153], v5, s[28:31], s47 offen offset:3072 sc0 sc1
    s_cmp_eq_u64 s[36:37], 0
    s_cbranch_scc0 L_fallback
L_end:
    s_endpgm
L_fallback:
    s_waitcnt vmcnt(0)
    v_and_b32 v6, 0xfff, v0
    s_lshl_b32 s3, s32, 9
    v_subrev_u32 v7, s3, v4
    s_mul_i32 s4, s32, 8704
    s_add_u32 s4, s4, 128512
    s_sub_u32 s3, s4, 60928
    v_add_u32 v8, s3, v2
    s_mov_b32 s5, 0
L_fb_q:
    buffer_load_dwordx2 a[64:65], v0, s[16:19], s5 offen offset:0
    buffer_load_dwordx2 a[66:67], v0, s[16:19], s5 offen offset:0
    buffer_load_dwordx2 a[68:69], v0, s[16:19], s5 offen offset:8
    buffer_load_dwordx2 a[70:71], v0, s[16:19], s5 offen offset:8
    buffer_load_dwordx2 a[72:73], v0, s[16:19], s5 offen offset:64
    buffer_load_dwordx2 a[74:75], v0, s[16:19], s5 offen offset:64
    buffer_load_dwordx2 a[76:77], v0, s[16:19], s5 offen offset:72
    buffer_load_dwordx2 a[78:79], v0, s[16:19], s5 offen offset:72
    buffer_load_dwordx2 a[80:81], v0, s[16:19], s5 offen offset:128
    buffer_load_dwordx2 a[82:83], v0, s[16:19], s5 offen offset:128
    buffer_load_dwordx2 a[84:85], v0, s[16:19], s5 offen offset:136
    buffer_load_dwordx2 a[86:87], v0, s[16:19], s5 offen offset:136
    buffer_load_dwordx2 a[88:89], v0, s[16:19], s5 offen offset:192
    buffer_load_dwordx2 a[90:91], v0, s[16:19], s5 offen offset:192
    buffer_load_dwordx2 a[92:93], v0, s[16:19], s5 offen offset:200
    buffer_load_dwordx2 a[94:95], v0, s[16:19], s5 offen offset:200
    s_waitcnt vmcnt(0)
    v_mfma_f32_16x16x32_bf16 v[218:221], a[138:141], a[64:67], 0
    s_nop 7
    v_cvt_pk_bf16_f32 v26, v218, v219
    v_cvt_pk_bf16_f32 v27, v220, v221
    v_mfma_f32_16x16x32_bf16 v[218:221], a[138:141], a[68:71], 0
    s_nop 7
    v_cvt_pk_bf16_f32 v28, v218, v219
    v_cvt_pk_bf16_f32 v29, v220, v221
    v_mfma_f32_16x16x32_bf16 v[218:221], a[138:141], a[72:75], 0
    s_nop 7
    v_cvt_pk_bf16_f32 v30, v218, v219
    v_cvt_pk_bf16_f32 v31, v220, v221
    v_mfma_f32_16x16x32_bf16 v[218:221], a[138:141], a[76:79], 0
    s_nop 7
    v_cvt_pk_bf16_f32 v32, v218, v219
    v_cvt_pk_bf16_f32 v33, v220, v221
    v_mfma_f32_16x16x32_bf16 v[218:221], a[138:141], a[80:83], 0
    s_nop 7
    v_cvt_pk_bf16_f32 v34, v218, v219
    v_cvt_pk_bf16_f32 v35, v220, v221
    v_mfma_f32_16x16x32_bf16 v[218:221], a[138:141], a[84:87], 0
    s_nop 7
    v_cvt_pk_bf16_f32 v36, v218, v219
    v_cvt_pk_bf16_f32 v37, v220, v221
    v_mfma_f32_16x16x32_bf16 v[218:221], a[138:141], a[88:91], 0
    s_nop 7
    v_cvt_pk_bf16_f32 v38, v218, v219
    v_cvt_pk_bf16_f32 v39, v220, v221
    v_mfma_f32_16x16x32_bf16 v[218:221], a[138:141], a[92:95], 0
    s_nop 7
    v_cvt_pk_bf16_f32 v40, v218, v219
    v_cvt_pk_bf16_f32 v41, v220, v221
    v_mov_b32 v10, 0xff800000
    s_mov_b32 s6, 0
L_fb_max:
    buffer_load_dwordx4 v[154:157], v6, s[20:23], s6 offen offset:0
    buffer_load_dwordx4 v[158:161], v6, s[20:23], s6 offen offset:64
    buffer_load_dwordx4 v[162:165], v6, s[20:23], s6 offen offset:128
    buffer_load_dwordx4 v[166:169], v6, s[20:23], s6 offen offset:192
    s_waitcnt vmcnt(0)
    v_mfma_f32_16x16x32_bf16 v[218:221], v[154:157], v[26:29], 0
    v_mfma_f32_16x16x32_bf16 v[218:221], v[158:161], v[30:33], v[218:221]
    v_mfma_f32_16x16x32_bf16 v[218:221], v[162:165], v[34:37], v[218:221]
    v_mfma_f32_16x16x32_bf16 v[218:221], v[166:169], v[38:41], v[218:221]
    s_nop 7
    v_max3_f32 v10, v10, v218, v219
    v_max3_f32 v10, v10, v220, v221
    s_add_u32 s6, s6, 4096
    s_cmp_lt_u32 s6, 0x20000
    s_cbranch_scc1 L_fb_max
    v_mov_b32 v11, v10
    s_nop 1
    v_permlane16_swap_b32 v10, v11
    v_max_f32 v12, v10, v11
    v_max_f32 v13, v10, v11
    s_nop 1
    v_permlane32_swap_b32 v12, v13
    v_min_f32_e64 v10, -v12, -v13
    v_mov_b32 v11, v10
    v_mov_b32 v12, v10
    v_mov_b32 v13, v10
    v_mov_b32 v90, 0
    v_mov_b32 v91, 0
    v_mov_b32 v92, 0
    v_mov_b32 v93, 0
    v_mov_b32 v94, 0
    v_mov_b32 v95, 0
    v_mov_b32 v96, 0
    v_mov_b32 v97, 0
    v_mov_b32 v98, 0
    v_mov_b32 v99, 0
    v_mov_b32 v100, 0
    v_mov_b32 v101, 0
    v_mov_b32 v102, 0
    v_mov_b32 v103, 0
    v_mov_b32 v104, 0
    v_mov_b32 v105, 0
    v_mov_b32 v106, 0
    v_mov_b32 v107, 0
    v_mov_b32 v108, 0
    v_mov_b32 v109, 0
    v_mov_b32 v110, 0
    v_mov_b32 v111, 0
    v_mov_b32 v112, 0
    v_mov_b32 v113, 0
    v_mov_b32 v114, 0
    v_mov_b32 v115, 0
    v_mov_b32 v116, 0
    v_mov_b32 v117, 0
    v_mov_b32 v118, 0
    v_mov_b32 v119, 0
    v_mov_b32 v120, 0
    v_mov_b32 v121, 0
    v_accvgpr_write_b32 a96, 0
    v_accvgpr_write_b32 a97, 0
    v_accvgpr_write_b32 a98, 0
    v_accvgpr_write_b32 a99, 0
    s_mov_b32 s6, 0
L_fb_pv:
    s_add_u32 s7, s6, 4096
    s_add_u32 m0, s4, 0
    s_nop 0
    buffer_load_dwordx4 v7, s[24:27], s6 offen offset:0 lds
    s_add_u32 m0, s4, 800
    s_nop 0
    buffer_load_dwordx4 v7, s[24:27], s6 offen offset:256 lds
    s_add_u32 m0, s4, 1600
    s_nop 0
    buffer_load_dwordx4 v7, s[24:27], s6 offen offset:512 lds
    s_add_u32 m0, s4, 2400
    s_nop 0
    buffer_load_dwordx4 v7, s[24:27], s6 offen offset:768 lds
    s_add_u32 m0, s4, 3200
    s_nop 0
    buffer_load_dwordx4 v7, s[24:27], s6 offen offset:1024 lds
    s_add_u32 m0, s4, 4000
    s_nop 0
    buffer_load_dwordx4 v7, s[24:27], s6 offen offset:1280 lds
    s_add_u32 m0, s4, 4800
    s_nop 0
    buffer_load_dwordx4 v7, s[24:27], s6 offen offset:1536 lds
    s_add_u32 m0, s4, 5600
    s_nop 0
    buffer_load_dwordx4 v7, s[24:27], s6 offen offset:1792 lds
    buffer_load_dwordx4 v[154:157], v6, s[20:23], s6 offen offset:0
    buffer_load_dwordx4 v[158:161], v6, s[20:23], s6 offen offset:64
    buffer_load_dwordx4 v[162:165], v6, s[20:23], s6 offen offset:128
    buffer_load_dwordx4 v[166:169], v6, s[20:23], s6 offen offset:192
    buffer_load_dwordx4 v[170:173], v6, s[20:23], s7 offen offset:0
    buffer_load_dwordx4 v[174:177], v6, s[20:23], s7 offen offset:64
    buffer_load_dwordx4 v[178:181], v6, s[20:23], s7 offen offset:128
    buffer_load_dwordx4 v[182:185], v6, s[20:23], s7 offen offset:192
    s_waitcnt vmcnt(0)
    ds_read_b64_tr_b16 a[200:201], v8 offset:0
    ds_read_b64_tr_b16 a[202:203], v8 offset:512
    ds_read_b64_tr_b16 a[204:205], v8 offset:32
    ds_read_b64_tr_b16 a[206:207], v8 offset:544
    ds_read_b64_tr_b16 a[208:209], v8 offset:64
    ds_read_b64_tr_b16 a[210:211], v8 offset:576
    ds_read_b64_tr_b16 a[212:213], v8 offset:96
    ds_read_b64_tr_b16 a[214:215], v8 offset:608
    ds_read_b64_tr_b16 a[216:217], v8 offset:128
    ds_read_b64_tr_b16 a[218:219], v8 offset:640
    ds_read_b64_tr_b16 a[220:221], v8 offset:160
    ds_read_b64_tr_b16 a[222:223], v8 offset:672
    ds_read_b64_tr_b16 a[224:225], v8 offset:192
    ds_read_b64_tr_b16 a[226:227], v8 offset:704
    ds_read_b64_tr_b16 a[228:229], v8 offset:224
    ds_read_b64_tr_b16 a[230:231], v8 offset:736
    v_mfma_f32_16x16x32_bf16 v[218:221], v[154:157], v[26:29], v[10:13]
    v_mfma_f32_16x16x32_bf16 v[218:221], v[158:161], v[30:33], v[218:221]
    v_mfma_f32_16x16x32_bf16 v[218:221], v[162:165], v[34:37], v[218:221]
    v_mfma_f32_16x16x32_bf16 v[218:221], v[166:169], v[38:41], v[218:221]
    v_mfma_f32_16x16x32_bf16 v[222:225], v[170:173], v[26:29], v[10:13]
    v_mfma_f32_16x16x32_bf16 v[222:225], v[174:177], v[30:33], v[222:225]
    v_mfma_f32_16x16x32_bf16 v[222:225], v[178:181], v[34:37], v[222:225]
    v_mfma_f32_16x16x32_bf16 v[222:225], v[182:185], v[38:41], v[222:225]
    s_nop 7
    v_exp_f32 v218, v218
    v_exp_f32 v219, v219
    v_exp_f32 v220, v220
    v_exp_f32 v221, v221
    v_exp_f32 v222, v222
    v_exp_f32 v223, v223
    v_exp_f32 v224, v224
    v_exp_f32 v225, v225
    s_nop 0
    v_cvt_pk_bf16_f32 v234, v218, v219
    v_cvt_pk_bf16_f32 v235, v220, v221
    v_cvt_pk_bf16_f32 v236, v222, v223
    v_cvt_pk_bf16_f32 v237, v224, v225
    s_waitcnt lgkmcnt(0)
    s_nop 1
    v_mfma_f32_16x16x32_bf16 a[96:99], a[128:131], v[234:237], a[96:99]
    v_mfma_f32_16x16x32_bf16 v[90:93], a[200:203], v[234:237], v[90:93]
    v_mfma_f32_16x16x32_bf16 v[94:97], a[204:207], v[234:237], v[94:97]
    v_mfma_f32_16x16x32_bf16 v[98:101], a[208:211], v[234:237], v[98:101]
    v_mfma_f32_16x16x32_bf16 v[102:105], a[212:215], v[234:237], v[102:105]
    v_mfma_f32_16x16x32_bf16 v[106:109], a[216:219], v[234:237], v[106:109]
    v_mfma_f32_16x16x32_bf16 v[110:113], a[220:223], v[234:237], v[110:113]
    v_mfma_f32_16x16x32_bf16 v[114:117], a[224:227], v[234:237], v[114:117]
    v_mfma_f32_16x16x32_bf16 v[118:121], a[228:231], v[234:237], v[118:121]
    s_add_u32 s6, s6, 8192
    s_cmp_lt_u32 s6, 0x20000
    s_cbranch_scc1 L_fb_pv
    s_nop 7
    v_accvgpr_read_b32 v9, a96
    v_rcp_f32 v9, v9
    s_nop 0
    v_mul_f32 v90, v90, v9
    v_mul_f32 v91, v91, v9
    v_mul_f32 v92, v92, v9
    v_mul_f32 v93, v93, v9
    v_mul_f32 v94, v94, v9
    v_mul_f32 v95, v95, v9
    v_mul_f32 v96, v96, v9
    v_mul_f32 v97, v97, v9
    v_cvt_pk_bf16_f32 v90, v90, v91
    v_cvt_pk_bf16_f32 v91, v92, v93
    v_cvt_pk_bf16_f32 v92, v94, v95
    v_cvt_pk_bf16_f32 v93, v96, v97
    s_nop 1
    v_permlane16_swap_b32 v90, v92
    v_permlane16_swap_b32 v91, v93
    buffer_store_dwordx4 v[90:93], v0, s[28:31], s5 offen offset:0
    v_mul_f32 v98, v98, v9
    v_mul_f32 v99, v99, v9
    v_mul_f32 v100, v100, v9
    v_mul_f32 v101, v101, v9
    v_mul_f32 v102, v102, v9
    v_mul_f32 v103, v103, v9
    v_mul_f32 v104, v104, v9
    v_mul_f32 v105, v105, v9
    v_cvt_pk_bf16_f32 v98, v98, v99
    v_cvt_pk_bf16_f32 v99, v100, v101
    v_cvt_pk_bf16_f32 v100, v102, v103
    v_cvt_pk_bf16_f32 v101, v104, v105
    s_nop 1
    v_permlane16_swap_b32 v98, v100
    v_permlane16_swap_b32 v99, v101
    buffer_store_dwordx4 v[98:101], v0, s[28:31], s5 offen offset:64
    v_mul_f32 v106, v106, v9
    v_mul_f32 v107, v107, v9
    v_mul_f32 v108, v108, v9
    v_mul_f32 v109, v109, v9
    v_mul_f32 v110, v110, v9
    v_mul_f32 v111, v111, v9
    v_mul_f32 v112, v112, v9
    v_mul_f32 v113, v113, v9
    v_cvt_pk_bf16_f32 v106, v106, v107
    v_cvt_pk_bf16_f32 v107, v108, v109
    v_cvt_pk_bf16_f32 v108, v110, v111
    v_cvt_pk_bf16_f32 v109, v112, v113
    s_nop 1
    v_permlane16_swap_b32 v106, v108
    v_permlane16_swap_b32 v107, v109
    buffer_store_dwordx4 v[106:109], v0, s[28:31], s5 offen offset:128
    v_mul_f32 v114, v114, v9
    v_mul_f32 v115, v115, v9
    v_mul_f32 v116, v116, v9
    v_mul_f32 v117, v117, v9
    v_mul_f32 v118, v118, v9
    v_mul_f32 v119, v119, v9
    v_mul_f32 v120, v120, v9
    v_mul_f32 v121, v121, v9
    v_cvt_pk_bf16_f32 v114, v114, v115
    v_cvt_pk_bf16_f32 v115, v116, v117
    v_cvt_pk_bf16_f32 v116, v118, v119
    v_cvt_pk_bf16_f32 v117, v120, v121
    s_nop 1
    v_permlane16_swap_b32 v114, v116
    v_permlane16_swap_b32 v115, v117
    buffer_store_dwordx4 v[114:117], v0, s[28:31], s5 offen offset:192
    s_add_u32 s5, s5, 4096
    s_cmp_lt_u32 s5, 0x8000
    s_cbranch_scc1 L_fb_q
    s_endpgm
.section .rodata,"a"
.p2align 6
.amdhsa_kernel standalone__gqa_softmax__near_ridge_kernel
  .amdhsa_next_free_vgpr 512
  .amdhsa_next_free_sgpr 102
  .amdhsa_accum_offset 256
  .amdhsa_group_segment_fixed_size 0
  .amdhsa_kernarg_size 48
  .amdhsa_user_sgpr_count 2
  .amdhsa_user_sgpr_kernarg_segment_ptr 1
  .amdhsa_system_sgpr_workgroup_id_x 1
.end_amdhsa_kernel
```
